```python
import torch

def _softmax(x, axis=-1):
    return torch.softmax(x, dim=axis)
def _gelu(x):
    return torch.nn.functional.gelu(x, approximate="tanh")
def _silu(x):
    return torch.nn.functional.silu(x)
def _sigmoid(x):
    return torch.sigmoid(x)
def _layernorm(x, axis=-1, eps=1e-5):
    m = x.mean(dim=axis, keepdim=True)
    v = x.var(dim=axis, keepdim=True, unbiased=False)
    return (x - m) / torch.sqrt(v + eps)
def _scatter_add(tgt, idx, src, axis=0):
    return tgt.clone().index_add_(axis, idx, src)
def _segment_sum(src, seg, n):
    out = torch.zeros((n,) + src.shape[1:], dtype=src.dtype)
    return out.index_add_(0, seg, src)
def _pad(x, pw):
    flat = tuple(v for pair in reversed(pw) for v in pair)
    return torch.nn.functional.pad(x, flat)

kernel_name = 'parallel_sum__gqa_block_cached__mixer_channel_mlp__decode'

def setup_inputs():

    _w = (lambda a: (lambda t: t.to(torch.bfloat16) if t.is_floating_point() else t)(torch.as_tensor(a)))
    def _A_setup():
        B, Sq, D = 8, 1, 640
        Hq, Hkv, Sk, Dh = 32, 32, 4096, 128
        assert Hq % Hkv == 0, (Hq, Hkv)
        return {
            "x": _w((lambda *s: torch.randn(*s, dtype=torch.bfloat16) * 0.05)(B, Sq, D)),
            "k_cache": _w((lambda *s: torch.randn(*s, dtype=torch.bfloat16) * 3.2)(B, Hkv, Sk, Dh)),
            "v_cache": _w((lambda *s: torch.randn(*s, dtype=torch.bfloat16) * 0.4)(B, Hkv, Sk, Dh)),
            "wq": _w((lambda *s: torch.randn(*s, dtype=torch.bfloat16) * 3.2)(D, Hq * Dh) * (D ** -0.5)),
            "wo": _w((lambda *s: torch.randn(*s, dtype=torch.bfloat16) * 0.4)(Hq * Dh, D) * ((Hq * Dh) ** -0.5)),
        }
    _A_in = _A_setup()

    def _B_setup():
        B, S, D, F = 8, 1, 640, 1728
        return {
            "x": _w((lambda *s: torch.randn(*s, dtype=torch.bfloat16) * 0.05)(B, S, D)),
            "w1": _w((lambda *s: torch.randn(*s, dtype=torch.bfloat16) * 1.6)(D, F) * (D ** -0.5)),
            "b1": _w((lambda *s: torch.randn(*s, dtype=torch.bfloat16) * 1.6)(F)),
            "w2": _w((lambda *s: torch.randn(*s, dtype=torch.bfloat16) * 0.1)(F, D) * (F ** -0.5)),
            "b2": _w((lambda *s: torch.randn(*s, dtype=torch.bfloat16) * 0.1)(D)),
        }
    _B_in = _B_setup()

    return {
        "A_x": _A_in["x"],
        "A_k_cache": _A_in["k_cache"],
        "A_v_cache": _A_in["v_cache"],
        "A_wq": _A_in["wq"],
        "A_wo": _A_in["wo"],
        "B_x": _B_in["x"],
        "B_w1": _B_in["w1"],
        "B_b1": _B_in["b1"],
        "B_w2": _B_in["w2"],
        "B_b2": _B_in["b2"],
    }

def reference(A_x, A_k_cache, A_v_cache, A_wq, A_wo, B_x, B_w1, B_b1, B_w2, B_b2):
    def _A_ref(x, k_cache, v_cache, wq, wo):
        B, Sq, D = x.shape
        Hq, Dh = 32, 128
        Hkv = k_cache.shape[1]
        rep = Hq // Hkv
        q = (lambda x, *d: x.permute(*d))((x @ wq).reshape(B, Sq, Hq, Dh), 0, 2, 1, 3)
        k = (lambda x, n, axis: torch.repeat_interleave(x, n, dim=axis))(k_cache, rep, axis=1)
        v = (lambda x, n, axis: torch.repeat_interleave(x, n, dim=axis))(v_cache, rep, axis=1)
        scores = torch.einsum("bhqd,bhkd->bhqk", q, k) * (Dh ** -0.5)
        p = _softmax(scores, axis=-1)
        o = torch.einsum("bhqk,bhkd->bhqd", p, v)
        return (lambda x, *d: x.permute(*d))(o, 0, 2, 1, 3).reshape(B, Sq, Hq * Dh) @ wo

    def _B_ref(x, w1, b1, w2, b2):
        y = _layernorm(x, axis=-1)
        h = _gelu(torch.einsum("bsd,df->bsf", y, w1) + b1)
        return torch.einsum("bsf,fd->bsd", h, w2) + b2

    x = A_x
    xn = _layernorm(x, axis=-1)
    return x + _A_ref(xn, A_k_cache, A_v_cache, A_wq, A_wo) + _B_ref(xn, B_w1, B_b1, B_w2, B_b2)
```

```asm
; @launch grid=(256,1,1) block=(512,1,1) lds=22784
.amdgcn_target "amdgcn-amd-amdhsa--gfx950"
.text
.globl parallel_sum__gqa_block_cached__mixer_channel_mlp__decode_kernel
.p2align 8
.type parallel_sum__gqa_block_cached__mixer_channel_mlp__decode_kernel,@function
parallel_sum__gqa_block_cached__mixer_channel_mlp__decode_kernel:
    s_cmp_ge_u32 s2, 256
    s_cbranch_scc1 L_end
    s_load_dwordx16 s[16:31], s[0:1], 0
    s_load_dwordx8 s[32:39], s[0:1], 64
    s_load_dwordx2 s[40:41], s[0:1], 96
    v_lshrrev_b32 v1, 6, v0
    v_and_b32 v0, 63, v0
    v_readfirstlane_b32 s3, v1
    v_and_b32 v2, 15, v0
    v_lshrrev_b32 v3, 4, v0
    s_lshr_b32 s4, s2, 5
    s_and_b32 s5, s2, 31
    s_lshl_b32 s66, s4, 5
    s_add_u32 s66, s66, s5
    s_cmp_ge_u32 s3, 4
    s_cbranch_scc1 L_aux
    s_setprio 1
    v_bfe_u32 v6, v2, 1, 1
    v_lshlrev_b32 v6, 10, v6
    v_lshrrev_b32 v7, 2, v2
    v_lshl_add_u32 v6, v7, 8, v6
    v_and_b32 v7, 1, v2
    v_lshl_add_u32 v6, v7, 6, v6
    v_lshl_add_u32 v4, v3, 4, v6
    v_lshlrev_b32 v5, 4, v0
    s_lshl_b32 s6, s66, 20
    s_lshr_b32 s7, s66, 12
    s_mul_i32 s42, s3, 8192
    s_lshr_b32 s45, s2, 3
    s_and_b32 s45, s45, 31
    s_mul_i32 s45, s45, 32768
    s_add_u32 s42, s42, s45
    s_waitcnt lgkmcnt(0)
    s_add_u32 s8, s18, s6
    s_addc_u32 s9, s19, s7
    s_mov_b32 s10, 0x100000
    s_mov_b32 s11, 0x20000
    s_add_u32 s12, s20, s6
    s_addc_u32 s13, s21, s7
    s_mov_b32 s14, 0x100000
    s_mov_b32 s15, 0x20000
    s_add_u32 s43, s42, 0
    s_and_b32 s43, s43, 0xfffff
    buffer_load_dwordx4 v[128:131], v4, s[8:11], s43 offen offset:0 nt
    buffer_load_dwordx4 v[132:135], v4, s[8:11], s43 offen offset:128 nt
    v_and_b32 v6, 1, v2
    v_lshlrev_b32 v6, 4, v6
    v_mov_b32 v7, 0xffff
    v_lshlrev_b32 v7, v6, v7
    v_bfe_u32 v6, v2, 1, 2
    v_cmp_eq_u32 vcc, 0, v6
    s_nop 1
    v_cndmask_b32 v8, 0, v7, vcc
    v_cmp_eq_u32 vcc, 1, v6
    s_nop 1
    v_cndmask_b32 v9, 0, v7, vcc
    v_cmp_eq_u32 vcc, 2, v6
    s_nop 1
    v_cndmask_b32 v10, 0, v7, vcc
    v_cmp_eq_u32 vcc, 3, v6
    s_nop 1
    v_cndmask_b32 v11, 0, v7, vcc
    v_lshrrev_b32 v6, 1, v2
    v_cmp_eq_u32 s[48:49], 0, v6
    v_cmp_eq_u32 s[50:51], 1, v6
    v_cmp_eq_u32 s[52:53], 2, v6
    v_cmp_eq_u32 s[54:55], 3, v6
    v_cmp_eq_u32 s[56:57], 4, v6
    v_cmp_eq_u32 s[58:59], 5, v6
    v_cmp_eq_u32 s[60:61], 6, v6
    v_cmp_eq_u32 s[62:63], 7, v6
    v_and_b32 v6, 1, v2
    v_cmp_eq_u32 s[64:65], 0, v6
    v_lshl_add_u32 v6, v6, 2, v3
    v_lshlrev_b32 v6, 5, v6
    s_barrier
    buffer_load_dwordx4 v[136:139], v4, s[8:11], s43 offen offset:2048 nt
    buffer_load_dwordx4 v[140:143], v4, s[8:11], s43 offen offset:2176 nt
    s_add_u32 s43, s42, 4096
    s_and_b32 s43, s43, 0xfffff
    buffer_load_dwordx4 v[144:147], v4, s[8:11], s43 offen offset:0 nt
    s_waitcnt vmcnt(4)
    buffer_load_dwordx4 v[148:151], v4, s[8:11], s43 offen offset:128 nt
    s_waitcnt vmcnt(4)
    buffer_load_dwordx4 v[152:155], v4, s[8:11], s43 offen offset:2048 nt
    s_waitcnt vmcnt(4)
    buffer_load_dwordx4 v[156:159], v4, s[8:11], s43 offen offset:2176 nt
    s_waitcnt vmcnt(4)
    s_add_u32 s43, s42, 32768
    s_and_b32 s43, s43, 0xfffff
    buffer_load_dwordx4 v[160:163], v4, s[8:11], s43 offen offset:0 nt
    s_waitcnt vmcnt(4)
    buffer_load_dwordx4 v[164:167], v4, s[8:11], s43 offen offset:128 nt
    s_waitcnt vmcnt(4)
    buffer_load_dwordx4 v[168:171], v4, s[8:11], s43 offen offset:2048 nt
    s_waitcnt vmcnt(4)
    buffer_load_dwordx4 v[172:175], v4, s[8:11], s43 offen offset:2176 nt
    s_barrier
    ds_read_b128 v[64:67], v6 offset:6400
    ds_read_b128 v[68:71], v6 offset:6416
    ds_read_b128 v[72:75], v6 offset:6656
    ds_read_b128 v[76:79], v6 offset:6672
    ds_read_b128 v[80:83], v6 offset:6912
    ds_read_b128 v[84:87], v6 offset:6928
    ds_read_b128 v[88:91], v6 offset:7168
    ds_read_b128 v[92:95], v6 offset:7184
    ds_read_b128 v[96:99], v6 offset:7424
    ds_read_b128 v[100:103], v6 offset:7440
    ds_read_b128 v[104:107], v6 offset:7680
    ds_read_b128 v[108:111], v6 offset:7696
    ds_read_b128 v[112:115], v6 offset:7936
    ds_read_b128 v[116:119], v6 offset:7952
    ds_read_b128 v[120:123], v6 offset:8192
    ds_read_b128 v[124:127], v6 offset:8208
    s_waitcnt vmcnt(4)
    s_add_u32 s43, s42, 36864
    s_and_b32 s43, s43, 0xfffff
    buffer_load_dwordx4 v[176:179], v4, s[8:11], s43 offen offset:0 nt
    s_waitcnt lgkmcnt(0)
    v_add_f32 v32, v64, v80
    v_add_f32 v96, v96, v112
    v_add_f32 v33, v65, v81
    v_add_f32 v97, v97, v113
    v_add_f32 v34, v66, v82
    v_add_f32 v98, v98, v114
    v_add_f32 v35, v67, v83
    v_add_f32 v99, v99, v115
    v_add_f32 v36, v68, v84
    v_add_f32 v100, v100, v116
    v_add_f32 v37, v69, v85
    v_add_f32 v101, v101, v117
    v_add_f32 v38, v70, v86
    v_add_f32 v102, v102, v118
    v_add_f32 v39, v71, v87
    v_add_f32 v103, v103, v119
    v_add_f32 v40, v72, v88
    v_add_f32 v104, v104, v120
    v_add_f32 v41, v73, v89
    v_add_f32 v105, v105, v121
    v_add_f32 v42, v74, v90
    v_add_f32 v106, v106, v122
    v_add_f32 v43, v75, v91
    v_add_f32 v107, v107, v123
    v_add_f32 v44, v76, v92
    v_add_f32 v108, v108, v124
    v_add_f32 v45, v77, v93
    v_add_f32 v109, v109, v125
    v_add_f32 v46, v78, v94
    v_add_f32 v110, v110, v126
    v_add_f32 v47, v79, v95
    v_add_f32 v111, v111, v127
    s_waitcnt vmcnt(4)
    buffer_load_dwordx4 v[180:183], v4, s[8:11], s43 offen offset:128 nt
    v_add_f32 v32, v32, v96
    v_add_f32 v33, v33, v97
    v_add_f32 v34, v34, v98
    v_add_f32 v35, v35, v99
    v_add_f32 v36, v36, v100
    v_add_f32 v37, v37, v101
    v_add_f32 v38, v38, v102
    v_add_f32 v39, v39, v103
    v_add_f32 v40, v40, v104
    v_add_f32 v41, v41, v105
    v_add_f32 v42, v42, v106
    v_add_f32 v43, v43, v107
    v_add_f32 v44, v44, v108
    v_add_f32 v45, v45, v109
    v_add_f32 v46, v46, v110
    v_add_f32 v47, v47, v111
    v_cvt_pk_bf16_f32 v48, v32, v33
    v_cvt_pk_bf16_f32 v49, v34, v35
    v_cvt_pk_bf16_f32 v50, v36, v37
    v_cvt_pk_bf16_f32 v51, v38, v39
    v_cvt_pk_bf16_f32 v52, v40, v41
    v_cvt_pk_bf16_f32 v53, v42, v43
    v_cvt_pk_bf16_f32 v54, v44, v45
    v_cvt_pk_bf16_f32 v55, v46, v47
    s_waitcnt vmcnt(4)
    buffer_load_dwordx4 v[184:187], v4, s[8:11], s43 offen offset:2048 nt
    v_cndmask_b32 v64, 0, v48, s[48:49]
    v_cndmask_b32 v65, 0, v49, s[48:49]
    v_cndmask_b32 v66, 0, v50, s[48:49]
    v_cndmask_b32 v67, 0, v51, s[48:49]
    v_cndmask_b32 v68, 0, v52, s[48:49]
    v_cndmask_b32 v69, 0, v53, s[48:49]
    v_cndmask_b32 v70, 0, v54, s[48:49]
    v_cndmask_b32 v71, 0, v55, s[48:49]
    v_cndmask_b32 v72, 0, v48, s[50:51]
    v_cndmask_b32 v73, 0, v49, s[50:51]
    v_cndmask_b32 v74, 0, v50, s[50:51]
    v_cndmask_b32 v75, 0, v51, s[50:51]
    v_cndmask_b32 v76, 0, v52, s[50:51]
    v_cndmask_b32 v77, 0, v53, s[50:51]
    v_cndmask_b32 v78, 0, v54, s[50:51]
    v_cndmask_b32 v79, 0, v55, s[50:51]
    s_waitcnt vmcnt(4)
    buffer_load_dwordx4 v[188:191], v4, s[8:11], s43 offen offset:2176 nt
    v_cndmask_b32 v80, 0, v48, s[52:53]
    v_cndmask_b32 v81, 0, v49, s[52:53]
    v_cndmask_b32 v82, 0, v50, s[52:53]
    v_cndmask_b32 v83, 0, v51, s[52:53]
    v_cndmask_b32 v84, 0, v52, s[52:53]
    v_cndmask_b32 v85, 0, v53, s[52:53]
    v_cndmask_b32 v86, 0, v54, s[52:53]
    v_cndmask_b32 v87, 0, v55, s[52:53]
    v_cndmask_b32 v88, 0, v48, s[54:55]
    v_cndmask_b32 v89, 0, v49, s[54:55]
    v_cndmask_b32 v90, 0, v50, s[54:55]
    v_cndmask_b32 v91, 0, v51, s[54:55]
    v_cndmask_b32 v92, 0, v52, s[54:55]
    v_cndmask_b32 v93, 0, v53, s[54:55]
    v_cndmask_b32 v94, 0, v54, s[54:55]
    v_cndmask_b32 v95, 0, v55, s[54:55]
    s_waitcnt vmcnt(4)
    s_add_u32 s43, s42, 65536
    s_and_b32 s43, s43, 0xfffff
    buffer_load_dwordx4 v[192:195], v4, s[8:11], s43 offen offset:0 nt
    v_cndmask_b32 v96, 0, v48, s[56:57]
    v_cndmask_b32 v97, 0, v49, s[56:57]
    v_cndmask_b32 v98, 0, v50, s[56:57]
    v_cndmask_b32 v99, 0, v51, s[56:57]
    v_cndmask_b32 v100, 0, v52, s[56:57]
    v_cndmask_b32 v101, 0, v53, s[56:57]
    v_cndmask_b32 v102, 0, v54, s[56:57]
    v_cndmask_b32 v103, 0, v55, s[56:57]
    v_cndmask_b32 v104, 0, v48, s[58:59]
    v_cndmask_b32 v105, 0, v49, s[58:59]
    v_cndmask_b32 v106, 0, v50, s[58:59]
    v_cndmask_b32 v107, 0, v51, s[58:59]
    v_cndmask_b32 v108, 0, v52, s[58:59]
    v_cndmask_b32 v109, 0, v53, s[58:59]
    v_cndmask_b32 v110, 0, v54, s[58:59]
    v_cndmask_b32 v111, 0, v55, s[58:59]
    s_waitcnt vmcnt(4)
    buffer_load_dwordx4 v[196:199], v4, s[8:11], s43 offen offset:128 nt
    v_cndmask_b32 v112, 0, v48, s[60:61]
    v_cndmask_b32 v113, 0, v49, s[60:61]
    v_cndmask_b32 v114, 0, v50, s[60:61]
    v_cndmask_b32 v115, 0, v51, s[60:61]
    v_cndmask_b32 v116, 0, v52, s[60:61]
    v_cndmask_b32 v117, 0, v53, s[60:61]
    v_cndmask_b32 v118, 0, v54, s[60:61]
    v_cndmask_b32 v119, 0, v55, s[60:61]
    v_cndmask_b32 v120, 0, v48, s[62:63]
    v_cndmask_b32 v121, 0, v49, s[62:63]
    v_cndmask_b32 v122, 0, v50, s[62:63]
    v_cndmask_b32 v123, 0, v51, s[62:63]
    v_cndmask_b32 v124, 0, v52, s[62:63]
    v_cndmask_b32 v125, 0, v53, s[62:63]
    v_cndmask_b32 v126, 0, v54, s[62:63]
    v_cndmask_b32 v127, 0, v55, s[62:63]
    s_waitcnt vmcnt(4)
    buffer_load_dwordx4 v[200:203], v4, s[8:11], s43 offen offset:2048 nt
    s_mov_b64 vcc, 0
    s_lshl_b32 s67, s3, 2
    v_mov_b32 v60, s67
    v_mov_b32 v62, 0
    s_waitcnt vmcnt(4)
    buffer_load_dwordx4 v[204:207], v4, s[8:11], s43 offen offset:2176 nt
    v_mov_b32 v59, 0
    ds_write_b32 v60, v59 offset:22528
    v_mfma_f32_16x16x32_bf16 v[20:23], v[128:131], v[64:67], 0
    v_mfma_f32_16x16x32_bf16 v[20:23], v[132:135], v[68:71], v[20:23]
    s_waitcnt vmcnt(4)
    s_add_u32 s43, s42, 69632
    s_and_b32 s43, s43, 0xfffff
    buffer_load_dwordx4 v[208:211], v4, s[8:11], s43 offen offset:0 nt
    ds_read_b32 v61, v62 offset:22544
    v_mfma_f32_16x16x32_bf16 v[20:23], v[136:139], v[72:75], v[20:23]
    v_mfma_f32_16x16x32_bf16 v[20:23], v[140:143], v[76:79], v[20:23]
    s_waitcnt vmcnt(4)
    buffer_load_dwordx4 v[212:215], v4, s[8:11], s43 offen offset:128 nt
    v_mov_b32 v59, 1
    ds_write_b32 v60, v59 offset:22528
    v_mfma_f32_16x16x32_bf16 v[20:23], v[144:147], v[80:83], v[20:23]
    v_mfma_f32_16x16x32_bf16 v[20:23], v[148:151], v[84:87], v[20:23]
    s_waitcnt vmcnt(4)
    buffer_load_dwordx4 v[216:219], v4, s[8:11], s43 offen offset:2048 nt
    s_waitcnt lgkmcnt(0)
    v_readfirstlane_b32 s67, v61
    s_cmp_lg_u32 s67, 0
    s_cselect_b64 vcc, -1, 0
    v_mfma_f32_16x16x32_bf16 v[20:23], v[152:155], v[88:91], v[20:23]
    v_mfma_f32_16x16x32_bf16 v[20:23], v[156:159], v[92:95], v[20:23]
    s_waitcnt vmcnt(4)
    buffer_load_dwordx4 v[220:223], v4, s[8:11], s43 offen offset:2176 nt
    v_mov_b32 v59, 2
    ds_write_b32 v60, v59 offset:22528
    v_mfma_f32_16x16x32_bf16 v[20:23], v[160:163], v[96:99], v[20:23]
    v_mfma_f32_16x16x32_bf16 v[20:23], v[164:167], v[100:103], v[20:23]
    s_waitcnt vmcnt(4)
    s_add_u32 s43, s42, 98304
    s_and_b32 s43, s43, 0xfffff
    buffer_load_dwordx4 v[224:227], v4, s[8:11], s43 offen offset:0 nt
    ds_read_b32 v61, v62 offset:22544
    v_mfma_f32_16x16x32_bf16 v[20:23], v[168:171], v[104:107], v[20:23]
    v_mfma_f32_16x16x32_bf16 v[20:23], v[172:175], v[108:111], v[20:23]
    s_waitcnt vmcnt(4)
    buffer_load_dwordx4 v[228:231], v4, s[8:11], s43 offen offset:128 nt
    v_mov_b32 v59, 3
    ds_write_b32 v60, v59 offset:22528
    v_mfma_f32_16x16x32_bf16 v[20:23], v[176:179], v[112:115], v[20:23]
    v_mfma_f32_16x16x32_bf16 v[20:23], v[180:183], v[116:119], v[20:23]
    s_waitcnt vmcnt(4)
    buffer_load_dwordx4 v[232:235], v4, s[8:11], s43 offen offset:2048 nt
    s_waitcnt lgkmcnt(0)
    v_readfirstlane_b32 s67, v61
    s_cmp_lg_u32 s67, 0
    s_cselect_b64 vcc, -1, 0
    v_mfma_f32_16x16x32_bf16 v[20:23], v[184:187], v[120:123], v[20:23]
    v_mfma_f32_16x16x32_bf16 v[20:23], v[188:191], v[124:127], v[20:23]
    s_waitcnt vmcnt(4)
    buffer_load_dwordx4 v[236:239], v4, s[8:11], s43 offen offset:2176 nt
    v_mov_b32 v59, 4
    ds_write_b32 v60, v59 offset:22528
    v_mfma_f32_16x16x32_bf16 v[24:27], v[192:195], v[64:67], 0
    v_mfma_f32_16x16x32_bf16 v[24:27], v[196:199], v[68:71], v[24:27]
    s_waitcnt vmcnt(4)
    s_add_u32 s43, s42, 102400
    s_and_b32 s43, s43, 0xfffff
    buffer_load_dwordx4 v[240:243], v4, s[8:11], s43 offen offset:0 nt
    ds_read_b32 v61, v62 offset:22544
    v_mfma_f32_16x16x32_bf16 v[24:27], v[200:203], v[72:75], v[24:27]
    v_mfma_f32_16x16x32_bf16 v[24:27], v[204:207], v[76:79], v[24:27]
    s_waitcnt vmcnt(4)
    buffer_load_dwordx4 v[244:247], v4, s[8:11], s43 offen offset:128 nt
    v_mov_b32 v59, 5
    ds_write_b32 v60, v59 offset:22528
    v_mfma_f32_16x16x32_bf16 v[24:27], v[208:211], v[80:83], v[24:27]
    v_mfma_f32_16x16x32_bf16 v[24:27], v[212:215], v[84:87], v[24:27]
    s_waitcnt vmcnt(4)
    buffer_load_dwordx4 v[248:251], v4, s[8:11], s43 offen offset:2048 nt
    s_waitcnt lgkmcnt(0)
    v_readfirstlane_b32 s67, v61
    s_cmp_lg_u32 s67, 0
    s_cselect_b64 vcc, -1, 0
    v_mfma_f32_16x16x32_bf16 v[24:27], v[216:219], v[88:91], v[24:27]
    v_mfma_f32_16x16x32_bf16 v[24:27], v[220:223], v[92:95], v[24:27]
    v_cndmask_b32 v56, v23, v20, s[64:65]
    v_cndmask_b32 v57, v21, v22, s[64:65]
    s_nop 1
    v_add_f32_dpp v56, v57, v56 quad_perm:[1,0,3,2] row_mask:0xf bank_mask:0xf
    v_cvt_pk_bf16_f32 v56, v56, v56
    v_and_b32 v56, 0xffff0000, v56
    v_mul_f32 v56, 0x3db504f3, v56
    v_cvt_pk_bf16_f32 v32, v56, v56
    v_and_b32 v32, 0xffff0000, v32
    s_waitcnt vmcnt(4)
    buffer_load_dwordx4 v[252:255], v4, s[8:11], s43 offen offset:2176 nt
    v_mov_b32 v59, 6
    ds_write_b32 v60, v59 offset:22528
    v_mfma_f32_16x16x32_bf16 v[24:27], v[224:227], v[96:99], v[24:27]
    v_mfma_f32_16x16x32_bf16 v[24:27], v[228:231], v[100:103], v[24:27]
    s_cbranch_vccnz Lw32
    s_waitcnt vmcnt(4)
Lw32:
    s_add_u32 s43, s42, 131072
    s_and_b32 s43, s43, 0xfffff
    buffer_load_dwordx4 v[128:131], v4, s[8:11], s43 offen offset:0 nt
    ds_read_b32 v61, v62 offset:22544
    v_mfma_f32_16x16x32_bf16 v[24:27], v[232:235], v[104:107], v[24:27]
    s_cbranch_vccnz Lw33
    s_waitcnt vmcnt(4)
Lw33:
    buffer_load_dwordx4 v[132:135], v4, s[8:11], s43 offen offset:128 nt
    s_waitcnt vmcnt(6)
    v_mfma_f32_16x16x32_bf16 v[24:27], v[236:239], v[108:111], v[24:27]
    s_cbranch_vccnz Lw34
    s_waitcnt vmcnt(4)
Lw34:
    buffer_load_dwordx4 v[136:139], v4, s[8:11], s43 offen offset:2048 nt
    v_mov_b32 v59, 7
    ds_write_b32 v60, v59 offset:22528
    s_waitcnt vmcnt(6)
    v_mfma_f32_16x16x32_bf16 v[24:27], v[240:243], v[112:115], v[24:27]
    s_cbranch_vccnz Lw35
    s_waitcnt vmcnt(4)
Lw35:
    buffer_load_dwordx4 v[140:143], v4, s[8:11], s43 offen offset:2176 nt
    s_waitcnt vmcnt(6)
    v_mfma_f32_16x16x32_bf16 v[24:27], v[244:247], v[116:119], v[24:27]
    s_cbranch_vccnz Lw36
    s_waitcnt vmcnt(4)
Lw36:
    s_add_u32 s43, s42, 135168
    s_and_b32 s43, s43, 0xfffff
    buffer_load_dwordx4 v[144:147], v4, s[8:11], s43 offen offset:0 nt
    s_waitcnt lgkmcnt(0)
    v_readfirstlane_b32 s67, v61
    s_cmp_lg_u32 s67, 0
    s_cselect_b64 vcc, -1, 0
    s_waitcnt vmcnt(6)
    v_mfma_f32_16x16x32_bf16 v[24:27], v[248:251], v[120:123], v[24:27]
    s_cbranch_vccnz Lw37
    s_waitcnt vmcnt(4)
Lw37:
    buffer_load_dwordx4 v[148:151], v4, s[8:11], s43 offen offset:128 nt
    s_waitcnt vmcnt(6)
    v_mfma_f32_16x16x32_bf16 v[24:27], v[252:255], v[124:127], v[24:27]
    s_cbranch_vccnz Lw38
    s_waitcnt vmcnt(4)
Lw38:
    buffer_load_dwordx4 v[152:155], v4, s[8:11], s43 offen offset:2048 nt
    v_mov_b32 v59, 8
    ds_write_b32 v60, v59 offset:22528
    s_waitcnt vmcnt(6)
    v_mfma_f32_16x16x32_bf16 v[20:23], v[128:131], v[64:67], 0
    s_cbranch_vccnz Lw39
    s_waitcnt vmcnt(4)
Lw39:
    buffer_load_dwordx4 v[156:159], v4, s[8:11], s43 offen offset:2176 nt
    s_waitcnt vmcnt(6)
    v_mfma_f32_16x16x32_bf16 v[20:23], v[132:135], v[68:71], v[20:23]
    s_cbranch_vccnz Lw40
    s_waitcnt vmcnt(4)
Lw40:
    s_add_u32 s43, s42, 163840
    s_and_b32 s43, s43, 0xfffff
    buffer_load_dwordx4 v[160:163], v4, s[8:11], s43 offen offset:0 nt
    ds_read_b32 v61, v62 offset:22544
    s_waitcnt vmcnt(6)
    v_mfma_f32_16x16x32_bf16 v[20:23], v[136:139], v[72:75], v[20:23]
    s_cbranch_vccnz Lw41
    s_waitcnt vmcnt(4)
Lw41:
    buffer_load_dwordx4 v[164:167], v4, s[8:11], s43 offen offset:128 nt
    s_waitcnt vmcnt(6)
    v_mfma_f32_16x16x32_bf16 v[20:23], v[140:143], v[76:79], v[20:23]
    s_cbranch_vccnz Lw42
    s_waitcnt vmcnt(4)
Lw42:
    buffer_load_dwordx4 v[168:171], v4, s[8:11], s43 offen offset:2048 nt
    v_mov_b32 v59, 9
    ds_write_b32 v60, v59 offset:22528
    s_waitcnt vmcnt(6)
    v_mfma_f32_16x16x32_bf16 v[20:23], v[144:147], v[80:83], v[20:23]
    s_cbranch_vccnz Lw43
    s_waitcnt vmcnt(4)
Lw43:
    buffer_load_dwordx4 v[172:175], v4, s[8:11], s43 offen offset:2176 nt
    s_waitcnt vmcnt(6)
    v_mfma_f32_16x16x32_bf16 v[20:23], v[148:151], v[84:87], v[20:23]
    s_cbranch_vccnz Lw44
    s_waitcnt vmcnt(4)
Lw44:
    s_add_u32 s43, s42, 167936
    s_and_b32 s43, s43, 0xfffff
    buffer_load_dwordx4 v[176:179], v4, s[8:11], s43 offen offset:0 nt
    s_waitcnt lgkmcnt(0)
    v_readfirstlane_b32 s67, v61
    s_cmp_lg_u32 s67, 0
    s_cselect_b64 vcc, -1, 0
    s_waitcnt vmcnt(6)
    v_mfma_f32_16x16x32_bf16 v[20:23], v[152:155], v[88:91], v[20:23]
    s_cbranch_vccnz Lw45
    s_waitcnt vmcnt(4)
Lw45:
    buffer_load_dwordx4 v[180:183], v4, s[8:11], s43 offen offset:128 nt
    s_waitcnt vmcnt(6)
    v_mfma_f32_16x16x32_bf16 v[20:23], v[156:159], v[92:95], v[20:23]
    v_cndmask_b32 v56, v27, v24, s[64:65]
    v_cndmask_b32 v57, v25, v26, s[64:65]
    s_nop 1
    v_add_f32_dpp v56, v57, v56 quad_perm:[1,0,3,2] row_mask:0xf bank_mask:0xf
    v_cvt_pk_bf16_f32 v56, v56, v56
    v_and_b32 v56, 0xffff0000, v56
    v_mul_f32 v56, 0x3db504f3, v56
    v_cvt_pk_bf16_f32 v33, v56, v56
    v_and_b32 v33, 0xffff0000, v33
    s_cbranch_vccnz Lw46
    s_waitcnt vmcnt(4)
Lw46:
    buffer_load_dwordx4 v[184:187], v4, s[8:11], s43 offen offset:2048 nt
    v_mov_b32 v59, 10
    ds_write_b32 v60, v59 offset:22528
    s_waitcnt vmcnt(6)
    v_mfma_f32_16x16x32_bf16 v[20:23], v[160:163], v[96:99], v[20:23]
    s_cbranch_vccnz Lw47
    s_waitcnt vmcnt(4)
Lw47:
    buffer_load_dwordx4 v[188:191], v4, s[8:11], s43 offen offset:2176 nt
    s_waitcnt vmcnt(6)
    v_mfma_f32_16x16x32_bf16 v[20:23], v[164:167], v[100:103], v[20:23]
    s_cbranch_vccnz Lw48
    s_waitcnt vmcnt(4)
Lw48:
    s_add_u32 s43, s42, 196608
    s_and_b32 s43, s43, 0xfffff
    buffer_load_dwordx4 v[192:195], v4, s[8:11], s43 offen offset:0 nt
    ds_read_b32 v61, v62 offset:22544
    s_waitcnt vmcnt(6)
    v_mfma_f32_16x16x32_bf16 v[20:23], v[168:171], v[104:107], v[20:23]
    s_cbranch_vccnz Lw49
    s_waitcnt vmcnt(4)
Lw49:
    buffer_load_dwordx4 v[196:199], v4, s[8:11], s43 offen offset:128 nt
    s_waitcnt vmcnt(6)
    v_mfma_f32_16x16x32_bf16 v[20:23], v[172:175], v[108:111], v[20:23]
    s_cbranch_vccnz Lw50
    s_waitcnt vmcnt(4)
Lw50:
    buffer_load_dwordx4 v[200:203], v4, s[8:11], s43 offen offset:2048 nt
    v_mov_b32 v59, 11
    ds_write_b32 v60, v59 offset:22528
    s_waitcnt vmcnt(6)
    v_mfma_f32_16x16x32_bf16 v[20:23], v[176:179], v[112:115], v[20:23]
    s_cbranch_vccnz Lw51
    s_waitcnt vmcnt(4)
Lw51:
    buffer_load_dwordx4 v[204:207], v4, s[8:11], s43 offen offset:2176 nt
    s_waitcnt vmcnt(6)
    v_mfma_f32_16x16x32_bf16 v[20:23], v[180:183], v[116:119], v[20:23]
    s_cbranch_vccnz Lw52
    s_waitcnt vmcnt(4)
Lw52:
    s_add_u32 s43, s42, 200704
    s_and_b32 s43, s43, 0xfffff
    buffer_load_dwordx4 v[208:211], v4, s[8:11], s43 offen offset:0 nt
    s_waitcnt lgkmcnt(0)
    v_readfirstlane_b32 s67, v61
    s_cmp_lg_u32 s67, 0
    s_cselect_b64 vcc, -1, 0
    s_waitcnt vmcnt(6)
    v_mfma_f32_16x16x32_bf16 v[20:23], v[184:187], v[120:123], v[20:23]
    s_cbranch_vccnz Lw53
    s_waitcnt vmcnt(4)
Lw53:
    buffer_load_dwordx4 v[212:215], v4, s[8:11], s43 offen offset:128 nt
    s_waitcnt vmcnt(6)
    v_mfma_f32_16x16x32_bf16 v[20:23], v[188:191], v[124:127], v[20:23]
    s_cbranch_vccnz Lw54
    s_waitcnt vmcnt(4)
Lw54:
    buffer_load_dwordx4 v[216:219], v4, s[8:11], s43 offen offset:2048 nt
    v_mov_b32 v59, 12
    ds_write_b32 v60, v59 offset:22528
    s_waitcnt vmcnt(6)
    v_mfma_f32_16x16x32_bf16 v[24:27], v[192:195], v[64:67], 0
    s_cbranch_vccnz Lw55
    s_waitcnt vmcnt(4)
Lw55:
    buffer_load_dwordx4 v[220:223], v4, s[8:11], s43 offen offset:2176 nt
    s_waitcnt vmcnt(6)
    v_mfma_f32_16x16x32_bf16 v[24:27], v[196:199], v[68:71], v[24:27]
    s_cbranch_vccnz Lw56
    s_waitcnt vmcnt(4)
Lw56:
    s_add_u32 s43, s42, 229376
    s_and_b32 s43, s43, 0xfffff
    buffer_load_dwordx4 v[224:227], v4, s[8:11], s43 offen offset:0 nt
    ds_read_b32 v61, v62 offset:22544
    s_waitcnt vmcnt(6)
    v_mfma_f32_16x16x32_bf16 v[24:27], v[200:203], v[72:75], v[24:27]
    s_cbranch_vccnz Lw57
    s_waitcnt vmcnt(4)
Lw57:
    buffer_load_dwordx4 v[228:231], v4, s[8:11], s43 offen offset:128 nt
    s_waitcnt vmcnt(6)
    v_mfma_f32_16x16x32_bf16 v[24:27], v[204:207], v[76:79], v[24:27]
    s_cbranch_vccnz Lw58
    s_waitcnt vmcnt(4)
Lw58:
    buffer_load_dwordx4 v[232:235], v4, s[8:11], s43 offen offset:2048 nt
    v_mov_b32 v59, 13
    ds_write_b32 v60, v59 offset:22528
    s_waitcnt vmcnt(6)
    v_mfma_f32_16x16x32_bf16 v[24:27], v[208:211], v[80:83], v[24:27]
    s_cbranch_vccnz Lw59
    s_waitcnt vmcnt(4)
Lw59:
    buffer_load_dwordx4 v[236:239], v4, s[8:11], s43 offen offset:2176 nt
    s_waitcnt vmcnt(6)
    v_mfma_f32_16x16x32_bf16 v[24:27], v[212:215], v[84:87], v[24:27]
    s_cbranch_vccnz Lw60
    s_waitcnt vmcnt(4)
Lw60:
    s_add_u32 s43, s42, 233472
    s_and_b32 s43, s43, 0xfffff
    buffer_load_dwordx4 v[240:243], v4, s[8:11], s43 offen offset:0 nt
    s_waitcnt lgkmcnt(0)
    v_readfirstlane_b32 s67, v61
    s_cmp_lg_u32 s67, 0
    s_cselect_b64 vcc, -1, 0
    s_waitcnt vmcnt(6)
    v_mfma_f32_16x16x32_bf16 v[24:27], v[216:219], v[88:91], v[24:27]
    s_cbranch_vccnz Lw61
    s_waitcnt vmcnt(4)
Lw61:
    buffer_load_dwordx4 v[244:247], v4, s[8:11], s43 offen offset:128 nt
    s_waitcnt vmcnt(6)
    v_mfma_f32_16x16x32_bf16 v[24:27], v[220:223], v[92:95], v[24:27]
    v_cndmask_b32 v56, v23, v20, s[64:65]
    v_cndmask_b32 v57, v21, v22, s[64:65]
    s_nop 1
    v_add_f32_dpp v56, v57, v56 quad_perm:[1,0,3,2] row_mask:0xf bank_mask:0xf
    v_cvt_pk_bf16_f32 v56, v56, v56
    v_and_b32 v56, 0xffff0000, v56
    v_mul_f32 v56, 0x3db504f3, v56
    v_cvt_pk_bf16_f32 v34, v56, v56
    v_and_b32 v34, 0xffff0000, v34
    s_cbranch_vccnz Lw62
    s_waitcnt vmcnt(4)
Lw62:
    buffer_load_dwordx4 v[248:251], v4, s[8:11], s43 offen offset:2048 nt
    v_mov_b32 v59, 14
    ds_write_b32 v60, v59 offset:22528
    s_waitcnt vmcnt(6)
    v_mfma_f32_16x16x32_bf16 v[24:27], v[224:227], v[96:99], v[24:27]
    s_cbranch_vccnz Lw63
    s_waitcnt vmcnt(4)
Lw63:
    buffer_load_dwordx4 v[252:255], v4, s[8:11], s43 offen offset:2176 nt
    s_waitcnt vmcnt(6)
    v_mfma_f32_16x16x32_bf16 v[24:27], v[228:231], v[100:103], v[24:27]
    s_cbranch_vccnz Lw64
    s_waitcnt vmcnt(4)
Lw64:
    s_add_u32 s43, s42, 262144
    s_and_b32 s43, s43, 0xfffff
    buffer_load_dwordx4 v[128:131], v4, s[8:11], s43 offen offset:0 nt
    ds_read_b32 v61, v62 offset:22544
    s_waitcnt vmcnt(6)
    v_mfma_f32_16x16x32_bf16 v[24:27], v[232:235], v[104:107], v[24:27]
    s_cbranch_vccnz Lw65
    s_waitcnt vmcnt(4)
Lw65:
    buffer_load_dwordx4 v[132:135], v4, s[8:11], s43 offen offset:128 nt
    s_waitcnt vmcnt(6)
    v_mfma_f32_16x16x32_bf16 v[24:27], v[236:239], v[108:111], v[24:27]
    s_cbranch_vccnz Lw66
    s_waitcnt vmcnt(4)
Lw66:
    buffer_load_dwordx4 v[136:139], v4, s[8:11], s43 offen offset:2048 nt
    v_mov_b32 v59, 15
    ds_write_b32 v60, v59 offset:22528
    s_waitcnt vmcnt(6)
    v_mfma_f32_16x16x32_bf16 v[24:27], v[240:243], v[112:115], v[24:27]
    s_cbranch_vccnz Lw67
    s_waitcnt vmcnt(4)
Lw67:
    buffer_load_dwordx4 v[140:143], v4, s[8:11], s43 offen offset:2176 nt
    s_waitcnt vmcnt(6)
    v_mfma_f32_16x16x32_bf16 v[24:27], v[244:247], v[116:119], v[24:27]
    s_cbranch_vccnz Lw68
    s_waitcnt vmcnt(4)
Lw68:
    s_add_u32 s43, s42, 266240
    s_and_b32 s43, s43, 0xfffff
    buffer_load_dwordx4 v[144:147], v4, s[8:11], s43 offen offset:0 nt
    s_waitcnt lgkmcnt(0)
    v_readfirstlane_b32 s67, v61
    s_cmp_lg_u32 s67, 0
    s_cselect_b64 vcc, -1, 0
    s_waitcnt vmcnt(6)
    v_mfma_f32_16x16x32_bf16 v[24:27], v[248:251], v[120:123], v[24:27]
    s_cbranch_vccnz Lw69
    s_waitcnt vmcnt(4)
Lw69:
    buffer_load_dwordx4 v[148:151], v4, s[8:11], s43 offen offset:128 nt
    s_waitcnt vmcnt(6)
    v_mfma_f32_16x16x32_bf16 v[24:27], v[252:255], v[124:127], v[24:27]
    s_cbranch_vccnz Lw70
    s_waitcnt vmcnt(4)
Lw70:
    buffer_load_dwordx4 v[152:155], v4, s[8:11], s43 offen offset:2048 nt
    v_mov_b32 v59, 16
    ds_write_b32 v60, v59 offset:22528
    s_waitcnt vmcnt(6)
    v_mfma_f32_16x16x32_bf16 v[20:23], v[128:131], v[64:67], 0
    s_cbranch_vccnz Lw71
    s_waitcnt vmcnt(4)
Lw71:
    buffer_load_dwordx4 v[156:159], v4, s[8:11], s43 offen offset:2176 nt
    s_waitcnt vmcnt(6)
    v_mfma_f32_16x16x32_bf16 v[20:23], v[132:135], v[68:71], v[20:23]
    s_cbranch_vccnz Lw72
    s_waitcnt vmcnt(4)
Lw72:
    s_add_u32 s43, s42, 294912
    s_and_b32 s43, s43, 0xfffff
    buffer_load_dwordx4 v[160:163], v4, s[8:11], s43 offen offset:0 nt
    ds_read_b32 v61, v62 offset:22544
    s_waitcnt vmcnt(6)
    v_mfma_f32_16x16x32_bf16 v[20:23], v[136:139], v[72:75], v[20:23]
    s_cbranch_vccnz Lw73
    s_waitcnt vmcnt(4)
Lw73:
    buffer_load_dwordx4 v[164:167], v4, s[8:11], s43 offen offset:128 nt
    s_waitcnt vmcnt(6)
    v_mfma_f32_16x16x32_bf16 v[20:23], v[140:143], v[76:79], v[20:23]
    s_cbranch_vccnz Lw74
    s_waitcnt vmcnt(4)
Lw74:
    buffer_load_dwordx4 v[168:171], v4, s[8:11], s43 offen offset:2048 nt
    v_mov_b32 v59, 17
    ds_write_b32 v60, v59 offset:22528
    s_waitcnt vmcnt(6)
    v_mfma_f32_16x16x32_bf16 v[20:23], v[144:147], v[80:83], v[20:23]
    s_cbranch_vccnz Lw75
    s_waitcnt vmcnt(4)
Lw75:
    buffer_load_dwordx4 v[172:175], v4, s[8:11], s43 offen offset:2176 nt
    s_waitcnt vmcnt(6)
    v_mfma_f32_16x16x32_bf16 v[20:23], v[148:151], v[84:87], v[20:23]
    s_cbranch_vccnz Lw76
    s_waitcnt vmcnt(4)
Lw76:
    s_add_u32 s43, s42, 299008
    s_and_b32 s43, s43, 0xfffff
    buffer_load_dwordx4 v[176:179], v4, s[8:11], s43 offen offset:0 nt
    s_waitcnt lgkmcnt(0)
    v_readfirstlane_b32 s67, v61
    s_cmp_lg_u32 s67, 0
    s_cselect_b64 vcc, -1, 0
    s_waitcnt vmcnt(6)
    v_mfma_f32_16x16x32_bf16 v[20:23], v[152:155], v[88:91], v[20:23]
    s_cbranch_vccnz Lw77
    s_waitcnt vmcnt(4)
Lw77:
    buffer_load_dwordx4 v[180:183], v4, s[8:11], s43 offen offset:128 nt
    s_waitcnt vmcnt(6)
    v_mfma_f32_16x16x32_bf16 v[20:23], v[156:159], v[92:95], v[20:23]
    v_cndmask_b32 v56, v27, v24, s[64:65]
    v_cndmask_b32 v57, v25, v26, s[64:65]
    s_nop 1
    v_add_f32_dpp v56, v57, v56 quad_perm:[1,0,3,2] row_mask:0xf bank_mask:0xf
    v_cvt_pk_bf16_f32 v56, v56, v56
    v_and_b32 v56, 0xffff0000, v56
    v_mul_f32 v56, 0x3db504f3, v56
    v_cvt_pk_bf16_f32 v35, v56, v56
    v_and_b32 v35, 0xffff0000, v35
    s_cbranch_vccnz Lw78
    s_waitcnt vmcnt(4)
Lw78:
    buffer_load_dwordx4 v[184:187], v4, s[8:11], s43 offen offset:2048 nt
    v_mov_b32 v59, 18
    ds_write_b32 v60, v59 offset:22528
    s_waitcnt vmcnt(6)
    v_mfma_f32_16x16x32_bf16 v[20:23], v[160:163], v[96:99], v[20:23]
    s_cbranch_vccnz Lw79
    s_waitcnt vmcnt(4)
Lw79:
    buffer_load_dwordx4 v[188:191], v4, s[8:11], s43 offen offset:2176 nt
    s_waitcnt vmcnt(6)
    v_mfma_f32_16x16x32_bf16 v[20:23], v[164:167], v[100:103], v[20:23]
    s_cbranch_vccnz Lw80
    s_waitcnt vmcnt(4)
Lw80:
    s_add_u32 s43, s42, 327680
    s_and_b32 s43, s43, 0xfffff
    buffer_load_dwordx4 v[192:195], v4, s[8:11], s43 offen offset:0 nt
    ds_read_b32 v61, v62 offset:22544
    s_waitcnt vmcnt(6)
    v_mfma_f32_16x16x32_bf16 v[20:23], v[168:171], v[104:107], v[20:23]
    s_cbranch_vccnz Lw81
    s_waitcnt vmcnt(4)
Lw81:
    buffer_load_dwordx4 v[196:199], v4, s[8:11], s43 offen offset:128 nt
    s_waitcnt vmcnt(6)
    v_mfma_f32_16x16x32_bf16 v[20:23], v[172:175], v[108:111], v[20:23]
    s_cbranch_vccnz Lw82
    s_waitcnt vmcnt(4)
Lw82:
    buffer_load_dwordx4 v[200:203], v4, s[8:11], s43 offen offset:2048 nt
    v_mov_b32 v59, 19
    ds_write_b32 v60, v59 offset:22528
    s_waitcnt vmcnt(6)
    v_mfma_f32_16x16x32_bf16 v[20:23], v[176:179], v[112:115], v[20:23]
    s_cbranch_vccnz Lw83
    s_waitcnt vmcnt(4)
Lw83:
    buffer_load_dwordx4 v[204:207], v4, s[8:11], s43 offen offset:2176 nt
    s_waitcnt vmcnt(6)
    v_mfma_f32_16x16x32_bf16 v[20:23], v[180:183], v[116:119], v[20:23]
    s_cbranch_vccnz Lw84
    s_waitcnt vmcnt(4)
Lw84:
    s_add_u32 s43, s42, 331776
    s_and_b32 s43, s43, 0xfffff
    buffer_load_dwordx4 v[208:211], v4, s[8:11], s43 offen offset:0 nt
    s_waitcnt lgkmcnt(0)
    v_readfirstlane_b32 s67, v61
    s_cmp_lg_u32 s67, 0
    s_cselect_b64 vcc, -1, 0
    s_waitcnt vmcnt(6)
    v_mfma_f32_16x16x32_bf16 v[20:23], v[184:187], v[120:123], v[20:23]
    s_cbranch_vccnz Lw85
    s_waitcnt vmcnt(4)
Lw85:
    buffer_load_dwordx4 v[212:215], v4, s[8:11], s43 offen offset:128 nt
    s_waitcnt vmcnt(6)
    v_mfma_f32_16x16x32_bf16 v[20:23], v[188:191], v[124:127], v[20:23]
    s_cbranch_vccnz Lw86
    s_waitcnt vmcnt(4)
Lw86:
    buffer_load_dwordx4 v[216:219], v4, s[8:11], s43 offen offset:2048 nt
    v_mov_b32 v59, 20
    ds_write_b32 v60, v59 offset:22528
    s_waitcnt vmcnt(6)
    v_mfma_f32_16x16x32_bf16 v[24:27], v[192:195], v[64:67], 0
    s_cbranch_vccnz Lw87
    s_waitcnt vmcnt(4)
Lw87:
    buffer_load_dwordx4 v[220:223], v4, s[8:11], s43 offen offset:2176 nt
    s_waitcnt vmcnt(6)
    v_mfma_f32_16x16x32_bf16 v[24:27], v[196:199], v[68:71], v[24:27]
    s_cbranch_vccnz Lw88
    s_waitcnt vmcnt(4)
Lw88:
    s_add_u32 s43, s42, 360448
    s_and_b32 s43, s43, 0xfffff
    buffer_load_dwordx4 v[224:227], v4, s[8:11], s43 offen offset:0 nt
    ds_read_b32 v61, v62 offset:22544
    s_waitcnt vmcnt(6)
    v_mfma_f32_16x16x32_bf16 v[24:27], v[200:203], v[72:75], v[24:27]
    s_cbranch_vccnz Lw89
    s_waitcnt vmcnt(4)
Lw89:
    buffer_load_dwordx4 v[228:231], v4, s[8:11], s43 offen offset:128 nt
    s_waitcnt vmcnt(6)
    v_mfma_f32_16x16x32_bf16 v[24:27], v[204:207], v[76:79], v[24:27]
    s_cbranch_vccnz Lw90
    s_waitcnt vmcnt(4)
Lw90:
    buffer_load_dwordx4 v[232:235], v4, s[8:11], s43 offen offset:2048 nt
    v_mov_b32 v59, 21
    ds_write_b32 v60, v59 offset:22528
    s_waitcnt vmcnt(6)
    v_mfma_f32_16x16x32_bf16 v[24:27], v[208:211], v[80:83], v[24:27]
    s_cbranch_vccnz Lw91
    s_waitcnt vmcnt(4)
Lw91:
    buffer_load_dwordx4 v[236:239], v4, s[8:11], s43 offen offset:2176 nt
    s_waitcnt vmcnt(6)
    v_mfma_f32_16x16x32_bf16 v[24:27], v[212:215], v[84:87], v[24:27]
    s_cbranch_vccnz Lw92
    s_waitcnt vmcnt(4)
Lw92:
    s_add_u32 s43, s42, 364544
    s_and_b32 s43, s43, 0xfffff
    buffer_load_dwordx4 v[240:243], v4, s[8:11], s43 offen offset:0 nt
    s_waitcnt lgkmcnt(0)
    v_readfirstlane_b32 s67, v61
    s_cmp_lg_u32 s67, 0
    s_cselect_b64 vcc, -1, 0
    s_waitcnt vmcnt(6)
    v_mfma_f32_16x16x32_bf16 v[24:27], v[216:219], v[88:91], v[24:27]
    s_cbranch_vccnz Lw93
    s_waitcnt vmcnt(4)
Lw93:
    buffer_load_dwordx4 v[244:247], v4, s[8:11], s43 offen offset:128 nt
    s_waitcnt vmcnt(6)
    v_mfma_f32_16x16x32_bf16 v[24:27], v[220:223], v[92:95], v[24:27]
    v_cndmask_b32 v56, v23, v20, s[64:65]
    v_cndmask_b32 v57, v21, v22, s[64:65]
    s_nop 1
    v_add_f32_dpp v56, v57, v56 quad_perm:[1,0,3,2] row_mask:0xf bank_mask:0xf
    v_cvt_pk_bf16_f32 v56, v56, v56
    v_and_b32 v56, 0xffff0000, v56
    v_mul_f32 v56, 0x3db504f3, v56
    v_cvt_pk_bf16_f32 v36, v56, v56
    v_and_b32 v36, 0xffff0000, v36
    s_cbranch_vccnz Lw94
    s_waitcnt vmcnt(4)
Lw94:
    buffer_load_dwordx4 v[248:251], v4, s[8:11], s43 offen offset:2048 nt
    v_mov_b32 v59, 22
    ds_write_b32 v60, v59 offset:22528
    s_waitcnt vmcnt(6)
    v_mfma_f32_16x16x32_bf16 v[24:27], v[224:227], v[96:99], v[24:27]
    s_cbranch_vccnz Lw95
    s_waitcnt vmcnt(4)
Lw95:
    buffer_load_dwordx4 v[252:255], v4, s[8:11], s43 offen offset:2176 nt
    s_waitcnt vmcnt(6)
    v_mfma_f32_16x16x32_bf16 v[24:27], v[228:231], v[100:103], v[24:27]
    s_cbranch_vccnz Lw96
    s_waitcnt vmcnt(4)
Lw96:
    s_add_u32 s43, s42, 393216
    s_and_b32 s43, s43, 0xfffff
    buffer_load_dwordx4 v[128:131], v4, s[8:11], s43 offen offset:0 nt
    ds_read_b32 v61, v62 offset:22544
    s_waitcnt vmcnt(6)
    v_mfma_f32_16x16x32_bf16 v[24:27], v[232:235], v[104:107], v[24:27]
    s_cbranch_vccnz Lw97
    s_waitcnt vmcnt(4)
Lw97:
    buffer_load_dwordx4 v[132:135], v4, s[8:11], s43 offen offset:128 nt
    s_waitcnt vmcnt(6)
    v_mfma_f32_16x16x32_bf16 v[24:27], v[236:239], v[108:111], v[24:27]
    s_cbranch_vccnz Lw98
    s_waitcnt vmcnt(4)
Lw98:
    buffer_load_dwordx4 v[136:139], v4, s[8:11], s43 offen offset:2048 nt
    v_mov_b32 v59, 23
    ds_write_b32 v60, v59 offset:22528
    s_waitcnt vmcnt(6)
    v_mfma_f32_16x16x32_bf16 v[24:27], v[240:243], v[112:115], v[24:27]
    s_cbranch_vccnz Lw99
    s_waitcnt vmcnt(4)
Lw99:
    buffer_load_dwordx4 v[140:143], v4, s[8:11], s43 offen offset:2176 nt
    s_waitcnt vmcnt(6)
    v_mfma_f32_16x16x32_bf16 v[24:27], v[244:247], v[116:119], v[24:27]
    s_cbranch_vccnz Lw100
    s_waitcnt vmcnt(4)
Lw100:
    s_add_u32 s43, s42, 397312
    s_and_b32 s43, s43, 0xfffff
    buffer_load_dwordx4 v[144:147], v4, s[8:11], s43 offen offset:0 nt
    s_waitcnt lgkmcnt(0)
    v_readfirstlane_b32 s67, v61
    s_cmp_lg_u32 s67, 0
    s_cselect_b64 vcc, -1, 0
    s_waitcnt vmcnt(6)
    v_mfma_f32_16x16x32_bf16 v[24:27], v[248:251], v[120:123], v[24:27]
    s_cbranch_vccnz Lw101
    s_waitcnt vmcnt(4)
Lw101:
    buffer_load_dwordx4 v[148:151], v4, s[8:11], s43 offen offset:128 nt
    s_waitcnt vmcnt(6)
    v_mfma_f32_16x16x32_bf16 v[24:27], v[252:255], v[124:127], v[24:27]
    s_cbranch_vccnz Lw102
    s_waitcnt vmcnt(4)
Lw102:
    buffer_load_dwordx4 v[152:155], v4, s[8:11], s43 offen offset:2048 nt
    v_mov_b32 v59, 24
    ds_write_b32 v60, v59 offset:22528
    s_waitcnt vmcnt(6)
    v_mfma_f32_16x16x32_bf16 v[20:23], v[128:131], v[64:67], 0
    s_cbranch_vccnz Lw103
    s_waitcnt vmcnt(4)
Lw103:
    buffer_load_dwordx4 v[156:159], v4, s[8:11], s43 offen offset:2176 nt
    s_waitcnt vmcnt(6)
    v_mfma_f32_16x16x32_bf16 v[20:23], v[132:135], v[68:71], v[20:23]
    s_cbranch_vccnz Lw104
    s_waitcnt vmcnt(4)
Lw104:
    s_add_u32 s43, s42, 425984
    s_and_b32 s43, s43, 0xfffff
    buffer_load_dwordx4 v[160:163], v4, s[8:11], s43 offen offset:0 nt
    ds_read_b32 v61, v62 offset:22544
    s_waitcnt vmcnt(6)
    v_mfma_f32_16x16x32_bf16 v[20:23], v[136:139], v[72:75], v[20:23]
    s_cbranch_vccnz Lw105
    s_waitcnt vmcnt(4)
Lw105:
    buffer_load_dwordx4 v[164:167], v4, s[8:11], s43 offen offset:128 nt
    s_waitcnt vmcnt(6)
    v_mfma_f32_16x16x32_bf16 v[20:23], v[140:143], v[76:79], v[20:23]
    s_cbranch_vccnz Lw106
    s_waitcnt vmcnt(4)
Lw106:
    buffer_load_dwordx4 v[168:171], v4, s[8:11], s43 offen offset:2048 nt
    v_mov_b32 v59, 25
    ds_write_b32 v60, v59 offset:22528
    s_waitcnt vmcnt(6)
    v_mfma_f32_16x16x32_bf16 v[20:23], v[144:147], v[80:83], v[20:23]
    s_cbranch_vccnz Lw107
    s_waitcnt vmcnt(4)
Lw107:
    buffer_load_dwordx4 v[172:175], v4, s[8:11], s43 offen offset:2176 nt
    s_waitcnt vmcnt(6)
    v_mfma_f32_16x16x32_bf16 v[20:23], v[148:151], v[84:87], v[20:23]
    s_cbranch_vccnz Lw108
    s_waitcnt vmcnt(4)
Lw108:
    s_add_u32 s43, s42, 430080
    s_and_b32 s43, s43, 0xfffff
    buffer_load_dwordx4 v[176:179], v4, s[8:11], s43 offen offset:0 nt
    s_waitcnt lgkmcnt(0)
    v_readfirstlane_b32 s67, v61
    s_cmp_lg_u32 s67, 0
    s_cselect_b64 vcc, -1, 0
    s_waitcnt vmcnt(6)
    v_mfma_f32_16x16x32_bf16 v[20:23], v[152:155], v[88:91], v[20:23]
    s_cbranch_vccnz Lw109
    s_waitcnt vmcnt(4)
Lw109:
    buffer_load_dwordx4 v[180:183], v4, s[8:11], s43 offen offset:128 nt
    s_waitcnt vmcnt(6)
    v_mfma_f32_16x16x32_bf16 v[20:23], v[156:159], v[92:95], v[20:23]
    v_cndmask_b32 v56, v27, v24, s[64:65]
    v_cndmask_b32 v57, v25, v26, s[64:65]
    s_nop 1
    v_add_f32_dpp v56, v57, v56 quad_perm:[1,0,3,2] row_mask:0xf bank_mask:0xf
    v_cvt_pk_bf16_f32 v56, v56, v56
    v_and_b32 v56, 0xffff0000, v56
    v_mul_f32 v56, 0x3db504f3, v56
    v_cvt_pk_bf16_f32 v37, v56, v56
    v_and_b32 v37, 0xffff0000, v37
    s_cbranch_vccnz Lw110
    s_waitcnt vmcnt(4)
Lw110:
    buffer_load_dwordx4 v[184:187], v4, s[8:11], s43 offen offset:2048 nt
    v_mov_b32 v59, 26
    ds_write_b32 v60, v59 offset:22528
    s_waitcnt vmcnt(6)
    v_mfma_f32_16x16x32_bf16 v[20:23], v[160:163], v[96:99], v[20:23]
    s_cbranch_vccnz Lw111
    s_waitcnt vmcnt(4)
Lw111:
    buffer_load_dwordx4 v[188:191], v4, s[8:11], s43 offen offset:2176 nt
    s_waitcnt vmcnt(6)
    v_mfma_f32_16x16x32_bf16 v[20:23], v[164:167], v[100:103], v[20:23]
    s_cbranch_vccnz Lw112
    s_waitcnt vmcnt(4)
Lw112:
    s_add_u32 s43, s42, 458752
    s_and_b32 s43, s43, 0xfffff
    buffer_load_dwordx4 v[192:195], v4, s[8:11], s43 offen offset:0 nt
    ds_read_b32 v61, v62 offset:22544
    s_waitcnt vmcnt(6)
    v_mfma_f32_16x16x32_bf16 v[20:23], v[168:171], v[104:107], v[20:23]
    s_cbranch_vccnz Lw113
    s_waitcnt vmcnt(4)
Lw113:
    buffer_load_dwordx4 v[196:199], v4, s[8:11], s43 offen offset:128 nt
    s_waitcnt vmcnt(6)
    v_mfma_f32_16x16x32_bf16 v[20:23], v[172:175], v[108:111], v[20:23]
    s_cbranch_vccnz Lw114
    s_waitcnt vmcnt(4)
Lw114:
    buffer_load_dwordx4 v[200:203], v4, s[8:11], s43 offen offset:2048 nt
    v_mov_b32 v59, 27
    ds_write_b32 v60, v59 offset:22528
    s_waitcnt vmcnt(6)
    v_mfma_f32_16x16x32_bf16 v[20:23], v[176:179], v[112:115], v[20:23]
    s_cbranch_vccnz Lw115
    s_waitcnt vmcnt(4)
Lw115:
    buffer_load_dwordx4 v[204:207], v4, s[8:11], s43 offen offset:2176 nt
    s_waitcnt vmcnt(6)
    v_mfma_f32_16x16x32_bf16 v[20:23], v[180:183], v[116:119], v[20:23]
    s_cbranch_vccnz Lw116
    s_waitcnt vmcnt(4)
Lw116:
    s_add_u32 s43, s42, 462848
    s_and_b32 s43, s43, 0xfffff
    buffer_load_dwordx4 v[208:211], v4, s[8:11], s43 offen offset:0 nt
    s_waitcnt lgkmcnt(0)
    v_readfirstlane_b32 s67, v61
    s_cmp_lg_u32 s67, 0
    s_cselect_b64 vcc, -1, 0
    s_waitcnt vmcnt(6)
    v_mfma_f32_16x16x32_bf16 v[20:23], v[184:187], v[120:123], v[20:23]
    s_cbranch_vccnz Lw117
    s_waitcnt vmcnt(4)
Lw117:
    buffer_load_dwordx4 v[212:215], v4, s[8:11], s43 offen offset:128 nt
    s_waitcnt vmcnt(6)
    v_mfma_f32_16x16x32_bf16 v[20:23], v[188:191], v[124:127], v[20:23]
    s_cbranch_vccnz Lw118
    s_waitcnt vmcnt(4)
Lw118:
    buffer_load_dwordx4 v[216:219], v4, s[8:11], s43 offen offset:2048 nt
    v_mov_b32 v59, 28
    ds_write_b32 v60, v59 offset:22528
    s_waitcnt vmcnt(6)
    v_mfma_f32_16x16x32_bf16 v[24:27], v[192:195], v[64:67], 0
    s_cbranch_vccnz Lw119
    s_waitcnt vmcnt(4)
Lw119:
    buffer_load_dwordx4 v[220:223], v4, s[8:11], s43 offen offset:2176 nt
    s_waitcnt vmcnt(6)
    v_mfma_f32_16x16x32_bf16 v[24:27], v[196:199], v[68:71], v[24:27]
    s_cbranch_vccnz Lw120
    s_waitcnt vmcnt(4)
Lw120:
    s_add_u32 s43, s42, 491520
    s_and_b32 s43, s43, 0xfffff
    buffer_load_dwordx4 v[224:227], v4, s[8:11], s43 offen offset:0 nt
    ds_read_b32 v61, v62 offset:22544
    s_waitcnt vmcnt(6)
    v_mfma_f32_16x16x32_bf16 v[24:27], v[200:203], v[72:75], v[24:27]
    s_cbranch_vccnz Lw121
    s_waitcnt vmcnt(4)
Lw121:
    buffer_load_dwordx4 v[228:231], v4, s[8:11], s43 offen offset:128 nt
    s_waitcnt vmcnt(6)
    v_mfma_f32_16x16x32_bf16 v[24:27], v[204:207], v[76:79], v[24:27]
    s_cbranch_vccnz Lw122
    s_waitcnt vmcnt(4)
Lw122:
    buffer_load_dwordx4 v[232:235], v4, s[8:11], s43 offen offset:2048 nt
    v_mov_b32 v59, 29
    ds_write_b32 v60, v59 offset:22528
    s_waitcnt vmcnt(6)
    v_mfma_f32_16x16x32_bf16 v[24:27], v[208:211], v[80:83], v[24:27]
    s_cbranch_vccnz Lw123
    s_waitcnt vmcnt(4)
Lw123:
    buffer_load_dwordx4 v[236:239], v4, s[8:11], s43 offen offset:2176 nt
    s_waitcnt vmcnt(6)
    v_mfma_f32_16x16x32_bf16 v[24:27], v[212:215], v[84:87], v[24:27]
    s_cbranch_vccnz Lw124
    s_waitcnt vmcnt(4)
Lw124:
    s_add_u32 s43, s42, 495616
    s_and_b32 s43, s43, 0xfffff
    buffer_load_dwordx4 v[240:243], v4, s[8:11], s43 offen offset:0 nt
    s_waitcnt lgkmcnt(0)
    v_readfirstlane_b32 s67, v61
    s_cmp_lg_u32 s67, 0
    s_cselect_b64 vcc, -1, 0
    s_waitcnt vmcnt(6)
    v_mfma_f32_16x16x32_bf16 v[24:27], v[216:219], v[88:91], v[24:27]
    s_cbranch_vccnz Lw125
    s_waitcnt vmcnt(4)
Lw125:
    buffer_load_dwordx4 v[244:247], v4, s[8:11], s43 offen offset:128 nt
    s_waitcnt vmcnt(6)
    v_mfma_f32_16x16x32_bf16 v[24:27], v[220:223], v[92:95], v[24:27]
    v_cndmask_b32 v56, v23, v20, s[64:65]
    v_cndmask_b32 v57, v21, v22, s[64:65]
    s_nop 1
    v_add_f32_dpp v56, v57, v56 quad_perm:[1,0,3,2] row_mask:0xf bank_mask:0xf
    v_cvt_pk_bf16_f32 v56, v56, v56
    v_and_b32 v56, 0xffff0000, v56
    v_mul_f32 v56, 0x3db504f3, v56
    v_cvt_pk_bf16_f32 v38, v56, v56
    v_and_b32 v38, 0xffff0000, v38
    s_cbranch_vccnz Lw126
    s_waitcnt vmcnt(4)
Lw126:
    buffer_load_dwordx4 v[248:251], v4, s[8:11], s43 offen offset:2048 nt
    v_mov_b32 v59, 30
    ds_write_b32 v60, v59 offset:22528
    s_waitcnt vmcnt(6)
    v_mfma_f32_16x16x32_bf16 v[24:27], v[224:227], v[96:99], v[24:27]
    s_cbranch_vccnz Lw127
    s_waitcnt vmcnt(4)
Lw127:
    buffer_load_dwordx4 v[252:255], v4, s[8:11], s43 offen offset:2176 nt
    s_waitcnt vmcnt(6)
    v_mfma_f32_16x16x32_bf16 v[24:27], v[228:231], v[100:103], v[24:27]
    s_cbranch_vccnz Lw128
    s_waitcnt vmcnt(4)
Lw128:
    s_add_u32 s43, s42, 524288
    s_and_b32 s43, s43, 0xfffff
    buffer_load_dwordx4 v[128:131], v4, s[8:11], s43 offen offset:0 nt
    ds_read_b32 v61, v62 offset:22544
    s_waitcnt vmcnt(6)
    v_mfma_f32_16x16x32_bf16 v[24:27], v[232:235], v[104:107], v[24:27]
    s_cbranch_vccnz Lw129
    s_waitcnt vmcnt(4)
Lw129:
    buffer_load_dwordx4 v[132:135], v4, s[8:11], s43 offen offset:128 nt
    s_waitcnt vmcnt(6)
    v_mfma_f32_16x16x32_bf16 v[24:27], v[236:239], v[108:111], v[24:27]
    s_cbranch_vccnz Lw130
    s_waitcnt vmcnt(4)
Lw130:
    buffer_load_dwordx4 v[136:139], v4, s[8:11], s43 offen offset:2048 nt
    v_mov_b32 v59, 31
    ds_write_b32 v60, v59 offset:22528
    s_waitcnt vmcnt(6)
    v_mfma_f32_16x16x32_bf16 v[24:27], v[240:243], v[112:115], v[24:27]
    s_cbranch_vccnz Lw131
    s_waitcnt vmcnt(4)
Lw131:
    buffer_load_dwordx4 v[140:143], v4, s[8:11], s43 offen offset:2176 nt
    s_waitcnt vmcnt(6)
    v_mfma_f32_16x16x32_bf16 v[24:27], v[244:247], v[116:119], v[24:27]
    s_cbranch_vccnz Lw132
    s_waitcnt vmcnt(4)
Lw132:
    s_add_u32 s43, s42, 528384
    s_and_b32 s43, s43, 0xfffff
    buffer_load_dwordx4 v[144:147], v4, s[8:11], s43 offen offset:0 nt
    s_waitcnt lgkmcnt(0)
    v_readfirstlane_b32 s67, v61
    s_cmp_lg_u32 s67, 0
    s_cselect_b64 vcc, -1, 0
    s_waitcnt vmcnt(6)
    v_mfma_f32_16x16x32_bf16 v[24:27], v[248:251], v[120:123], v[24:27]
    s_cbranch_vccnz Lw133
    s_waitcnt vmcnt(4)
Lw133:
    buffer_load_dwordx4 v[148:151], v4, s[8:11], s43 offen offset:128 nt
    s_waitcnt vmcnt(6)
    v_mfma_f32_16x16x32_bf16 v[24:27], v[252:255], v[124:127], v[24:27]
    s_cbranch_vccnz Lw134
    s_waitcnt vmcnt(4)
Lw134:
    buffer_load_dwordx4 v[152:155], v4, s[8:11], s43 offen offset:2048 nt
    v_mov_b32 v59, 32
    ds_write_b32 v60, v59 offset:22528
    s_waitcnt vmcnt(6)
    v_mfma_f32_16x16x32_bf16 v[20:23], v[128:131], v[64:67], 0
    s_cbranch_vccnz Lw135
    s_waitcnt vmcnt(4)
Lw135:
    buffer_load_dwordx4 v[156:159], v4, s[8:11], s43 offen offset:2176 nt
    s_waitcnt vmcnt(6)
    v_mfma_f32_16x16x32_bf16 v[20:23], v[132:135], v[68:71], v[20:23]
    s_cbranch_vccnz Lw136
    s_waitcnt vmcnt(4)
Lw136:
    s_add_u32 s43, s42, 557056
    s_and_b32 s43, s43, 0xfffff
    buffer_load_dwordx4 v[160:163], v4, s[8:11], s43 offen offset:0 nt
    ds_read_b32 v61, v62 offset:22544
    s_waitcnt vmcnt(6)
    v_mfma_f32_16x16x32_bf16 v[20:23], v[136:139], v[72:75], v[20:23]
    s_cbranch_vccnz Lw137
    s_waitcnt vmcnt(4)
Lw137:
    buffer_load_dwordx4 v[164:167], v4, s[8:11], s43 offen offset:128 nt
    s_waitcnt vmcnt(6)
    v_mfma_f32_16x16x32_bf16 v[20:23], v[140:143], v[76:79], v[20:23]
    s_cbranch_vccnz Lw138
    s_waitcnt vmcnt(4)
Lw138:
    buffer_load_dwordx4 v[168:171], v4, s[8:11], s43 offen offset:2048 nt
    v_mov_b32 v59, 33
    ds_write_b32 v60, v59 offset:22528
    s_waitcnt vmcnt(6)
    v_mfma_f32_16x16x32_bf16 v[20:23], v[144:147], v[80:83], v[20:23]
    s_cbranch_vccnz Lw139
    s_waitcnt vmcnt(4)
Lw139:
    buffer_load_dwordx4 v[172:175], v4, s[8:11], s43 offen offset:2176 nt
    s_waitcnt vmcnt(6)
    v_mfma_f32_16x16x32_bf16 v[20:23], v[148:151], v[84:87], v[20:23]
    s_cbranch_vccnz Lw140
    s_waitcnt vmcnt(4)
Lw140:
    s_add_u32 s43, s42, 561152
    s_and_b32 s43, s43, 0xfffff
    buffer_load_dwordx4 v[176:179], v4, s[8:11], s43 offen offset:0 nt
    s_waitcnt lgkmcnt(0)
    v_readfirstlane_b32 s67, v61
    s_cmp_lg_u32 s67, 0
    s_cselect_b64 vcc, -1, 0
    s_waitcnt vmcnt(6)
    v_mfma_f32_16x16x32_bf16 v[20:23], v[152:155], v[88:91], v[20:23]
    s_cbranch_vccnz Lw141
    s_waitcnt vmcnt(4)
Lw141:
    buffer_load_dwordx4 v[180:183], v4, s[8:11], s43 offen offset:128 nt
    s_waitcnt vmcnt(6)
    v_mfma_f32_16x16x32_bf16 v[20:23], v[156:159], v[92:95], v[20:23]
    v_cndmask_b32 v56, v27, v24, s[64:65]
    v_cndmask_b32 v57, v25, v26, s[64:65]
    s_nop 1
    v_add_f32_dpp v56, v57, v56 quad_perm:[1,0,3,2] row_mask:0xf bank_mask:0xf
    v_cvt_pk_bf16_f32 v56, v56, v56
    v_and_b32 v56, 0xffff0000, v56
    v_mul_f32 v56, 0x3db504f3, v56
    v_cvt_pk_bf16_f32 v39, v56, v56
    v_and_b32 v39, 0xffff0000, v39
    s_cbranch_vccnz Lw142
    s_waitcnt vmcnt(4)
Lw142:
    buffer_load_dwordx4 v[184:187], v4, s[8:11], s43 offen offset:2048 nt
    v_mov_b32 v59, 34
    ds_write_b32 v60, v59 offset:22528
    s_waitcnt vmcnt(6)
    v_mfma_f32_16x16x32_bf16 v[20:23], v[160:163], v[96:99], v[20:23]
    s_cbranch_vccnz Lw143
    s_waitcnt vmcnt(4)
Lw143:
    buffer_load_dwordx4 v[188:191], v4, s[8:11], s43 offen offset:2176 nt
    s_waitcnt vmcnt(6)
    v_mfma_f32_16x16x32_bf16 v[20:23], v[164:167], v[100:103], v[20:23]
    s_cbranch_vccnz Lw144
    s_waitcnt vmcnt(4)
Lw144:
    s_add_u32 s43, s42, 589824
    s_and_b32 s43, s43, 0xfffff
    buffer_load_dwordx4 v[192:195], v4, s[8:11], s43 offen offset:0 nt
    ds_read_b32 v61, v62 offset:22544
    s_waitcnt vmcnt(6)
    v_mfma_f32_16x16x32_bf16 v[20:23], v[168:171], v[104:107], v[20:23]
    s_cbranch_vccnz Lw145
    s_waitcnt vmcnt(4)
Lw145:
    buffer_load_dwordx4 v[196:199], v4, s[8:11], s43 offen offset:128 nt
    s_waitcnt vmcnt(6)
    v_mfma_f32_16x16x32_bf16 v[20:23], v[172:175], v[108:111], v[20:23]
    s_cbranch_vccnz Lw146
    s_waitcnt vmcnt(4)
Lw146:
    buffer_load_dwordx4 v[200:203], v4, s[8:11], s43 offen offset:2048 nt
    v_mov_b32 v59, 35
    ds_write_b32 v60, v59 offset:22528
    s_waitcnt vmcnt(6)
    v_mfma_f32_16x16x32_bf16 v[20:23], v[176:179], v[112:115], v[20:23]
    s_cbranch_vccnz Lw147
    s_waitcnt vmcnt(4)
Lw147:
    buffer_load_dwordx4 v[204:207], v4, s[8:11], s43 offen offset:2176 nt
    s_waitcnt vmcnt(6)
    v_mfma_f32_16x16x32_bf16 v[20:23], v[180:183], v[116:119], v[20:23]
    s_cbranch_vccnz Lw148
    s_waitcnt vmcnt(4)
Lw148:
    s_add_u32 s43, s42, 593920
    s_and_b32 s43, s43, 0xfffff
    buffer_load_dwordx4 v[208:211], v4, s[8:11], s43 offen offset:0 nt
    s_waitcnt lgkmcnt(0)
    v_readfirstlane_b32 s67, v61
    s_cmp_lg_u32 s67, 0
    s_cselect_b64 vcc, -1, 0
    s_waitcnt vmcnt(6)
    v_mfma_f32_16x16x32_bf16 v[20:23], v[184:187], v[120:123], v[20:23]
    s_cbranch_vccnz Lw149
    s_waitcnt vmcnt(4)
Lw149:
    buffer_load_dwordx4 v[212:215], v4, s[8:11], s43 offen offset:128 nt
    s_waitcnt vmcnt(6)
    v_mfma_f32_16x16x32_bf16 v[20:23], v[188:191], v[124:127], v[20:23]
    s_cbranch_vccnz Lw150
    s_waitcnt vmcnt(4)
Lw150:
    buffer_load_dwordx4 v[216:219], v4, s[8:11], s43 offen offset:2048 nt
    v_mov_b32 v59, 36
    ds_write_b32 v60, v59 offset:22528
    s_waitcnt vmcnt(6)
    v_mfma_f32_16x16x32_bf16 v[24:27], v[192:195], v[64:67], 0
    s_cbranch_vccnz Lw151
    s_waitcnt vmcnt(4)
Lw151:
    buffer_load_dwordx4 v[220:223], v4, s[8:11], s43 offen offset:2176 nt
    s_waitcnt vmcnt(6)
    v_mfma_f32_16x16x32_bf16 v[24:27], v[196:199], v[68:71], v[24:27]
    s_cbranch_vccnz Lw152
    s_waitcnt vmcnt(4)
Lw152:
    s_add_u32 s43, s42, 622592
    s_and_b32 s43, s43, 0xfffff
    buffer_load_dwordx4 v[224:227], v4, s[8:11], s43 offen offset:0 nt
    ds_read_b32 v61, v62 offset:22544
    s_waitcnt vmcnt(6)
    v_mfma_f32_16x16x32_bf16 v[24:27], v[200:203], v[72:75], v[24:27]
    s_cbranch_vccnz Lw153
    s_waitcnt vmcnt(4)
Lw153:
    buffer_load_dwordx4 v[228:231], v4, s[8:11], s43 offen offset:128 nt
    s_waitcnt vmcnt(6)
    v_mfma_f32_16x16x32_bf16 v[24:27], v[204:207], v[76:79], v[24:27]
    s_cbranch_vccnz Lw154
    s_waitcnt vmcnt(4)
Lw154:
    buffer_load_dwordx4 v[232:235], v4, s[8:11], s43 offen offset:2048 nt
    v_mov_b32 v59, 37
    ds_write_b32 v60, v59 offset:22528
    s_waitcnt vmcnt(6)
    v_mfma_f32_16x16x32_bf16 v[24:27], v[208:211], v[80:83], v[24:27]
    s_cbranch_vccnz Lw155
    s_waitcnt vmcnt(4)
Lw155:
    buffer_load_dwordx4 v[236:239], v4, s[8:11], s43 offen offset:2176 nt
    s_waitcnt vmcnt(6)
    v_mfma_f32_16x16x32_bf16 v[24:27], v[212:215], v[84:87], v[24:27]
    s_cbranch_vccnz Lw156
    s_waitcnt vmcnt(4)
Lw156:
    s_add_u32 s43, s42, 626688
    s_and_b32 s43, s43, 0xfffff
    buffer_load_dwordx4 v[240:243], v4, s[8:11], s43 offen offset:0 nt
    s_waitcnt lgkmcnt(0)
    v_readfirstlane_b32 s67, v61
    s_cmp_lg_u32 s67, 0
    s_cselect_b64 vcc, -1, 0
    s_waitcnt vmcnt(6)
    v_mfma_f32_16x16x32_bf16 v[24:27], v[216:219], v[88:91], v[24:27]
    s_cbranch_vccnz Lw157
    s_waitcnt vmcnt(4)
Lw157:
    buffer_load_dwordx4 v[244:247], v4, s[8:11], s43 offen offset:128 nt
    s_waitcnt vmcnt(6)
    v_mfma_f32_16x16x32_bf16 v[24:27], v[220:223], v[92:95], v[24:27]
    v_cndmask_b32 v56, v23, v20, s[64:65]
    v_cndmask_b32 v57, v21, v22, s[64:65]
    s_nop 1
    v_add_f32_dpp v56, v57, v56 quad_perm:[1,0,3,2] row_mask:0xf bank_mask:0xf
    v_cvt_pk_bf16_f32 v56, v56, v56
    v_and_b32 v56, 0xffff0000, v56
    v_mul_f32 v56, 0x3db504f3, v56
    v_cvt_pk_bf16_f32 v40, v56, v56
    v_and_b32 v40, 0xffff0000, v40
    s_cbranch_vccnz Lw158
    s_waitcnt vmcnt(4)
Lw158:
    buffer_load_dwordx4 v[248:251], v4, s[8:11], s43 offen offset:2048 nt
    v_mov_b32 v59, 38
    ds_write_b32 v60, v59 offset:22528
    s_waitcnt vmcnt(6)
    v_mfma_f32_16x16x32_bf16 v[24:27], v[224:227], v[96:99], v[24:27]
    s_cbranch_vccnz Lw159
    s_waitcnt vmcnt(4)
Lw159:
    buffer_load_dwordx4 v[252:255], v4, s[8:11], s43 offen offset:2176 nt
    s_waitcnt vmcnt(6)
    v_mfma_f32_16x16x32_bf16 v[24:27], v[228:231], v[100:103], v[24:27]
    s_cbranch_vccnz Lw160
    s_waitcnt vmcnt(4)
Lw160:
    s_add_u32 s43, s42, 655360
    s_and_b32 s43, s43, 0xfffff
    buffer_load_dwordx4 v[128:131], v4, s[8:11], s43 offen offset:0 nt
    ds_read_b32 v61, v62 offset:22544
    s_waitcnt vmcnt(6)
    v_mfma_f32_16x16x32_bf16 v[24:27], v[232:235], v[104:107], v[24:27]
    s_cbranch_vccnz Lw161
    s_waitcnt vmcnt(4)
Lw161:
    buffer_load_dwordx4 v[132:135], v4, s[8:11], s43 offen offset:128 nt
    s_waitcnt vmcnt(6)
    v_mfma_f32_16x16x32_bf16 v[24:27], v[236:239], v[108:111], v[24:27]
    s_cbranch_vccnz Lw162
    s_waitcnt vmcnt(4)
Lw162:
    buffer_load_dwordx4 v[136:139], v4, s[8:11], s43 offen offset:2048 nt
    v_mov_b32 v59, 39
    ds_write_b32 v60, v59 offset:22528
    s_waitcnt vmcnt(6)
    v_mfma_f32_16x16x32_bf16 v[24:27], v[240:243], v[112:115], v[24:27]
    s_cbranch_vccnz Lw163
    s_waitcnt vmcnt(4)
Lw163:
    buffer_load_dwordx4 v[140:143], v4, s[8:11], s43 offen offset:2176 nt
    s_waitcnt vmcnt(6)
    v_mfma_f32_16x16x32_bf16 v[24:27], v[244:247], v[116:119], v[24:27]
    s_cbranch_vccnz Lw164
    s_waitcnt vmcnt(4)
Lw164:
    s_add_u32 s43, s42, 659456
    s_and_b32 s43, s43, 0xfffff
    buffer_load_dwordx4 v[144:147], v4, s[8:11], s43 offen offset:0 nt
    s_waitcnt lgkmcnt(0)
    v_readfirstlane_b32 s67, v61
    s_cmp_lg_u32 s67, 0
    s_cselect_b64 vcc, -1, 0
    s_waitcnt vmcnt(6)
    v_mfma_f32_16x16x32_bf16 v[24:27], v[248:251], v[120:123], v[24:27]
    s_cbranch_vccnz Lw165
    s_waitcnt vmcnt(4)
Lw165:
    buffer_load_dwordx4 v[148:151], v4, s[8:11], s43 offen offset:128 nt
    s_waitcnt vmcnt(6)
    v_mfma_f32_16x16x32_bf16 v[24:27], v[252:255], v[124:127], v[24:27]
    s_cbranch_vccnz Lw166
    s_waitcnt vmcnt(4)
Lw166:
    buffer_load_dwordx4 v[152:155], v4, s[8:11], s43 offen offset:2048 nt
    v_mov_b32 v59, 40
    ds_write_b32 v60, v59 offset:22528
    s_waitcnt vmcnt(6)
    v_mfma_f32_16x16x32_bf16 v[20:23], v[128:131], v[64:67], 0
    s_cbranch_vccnz Lw167
    s_waitcnt vmcnt(4)
Lw167:
    buffer_load_dwordx4 v[156:159], v4, s[8:11], s43 offen offset:2176 nt
    s_waitcnt vmcnt(6)
    v_mfma_f32_16x16x32_bf16 v[20:23], v[132:135], v[68:71], v[20:23]
    s_cbranch_vccnz Lw168
    s_waitcnt vmcnt(4)
Lw168:
    s_add_u32 s43, s42, 688128
    s_and_b32 s43, s43, 0xfffff
    buffer_load_dwordx4 v[160:163], v4, s[8:11], s43 offen offset:0 nt
    ds_read_b32 v61, v62 offset:22544
    s_waitcnt vmcnt(6)
    v_mfma_f32_16x16x32_bf16 v[20:23], v[136:139], v[72:75], v[20:23]
    s_cbranch_vccnz Lw169
    s_waitcnt vmcnt(4)
Lw169:
    buffer_load_dwordx4 v[164:167], v4, s[8:11], s43 offen offset:128 nt
    s_waitcnt vmcnt(6)
    v_mfma_f32_16x16x32_bf16 v[20:23], v[140:143], v[76:79], v[20:23]
    s_cbranch_vccnz Lw170
    s_waitcnt vmcnt(4)
Lw170:
    buffer_load_dwordx4 v[168:171], v4, s[8:11], s43 offen offset:2048 nt
    v_mov_b32 v59, 41
    ds_write_b32 v60, v59 offset:22528
    s_waitcnt vmcnt(6)
    v_mfma_f32_16x16x32_bf16 v[20:23], v[144:147], v[80:83], v[20:23]
    s_cbranch_vccnz Lw171
    s_waitcnt vmcnt(4)
Lw171:
    buffer_load_dwordx4 v[172:175], v4, s[8:11], s43 offen offset:2176 nt
    s_waitcnt vmcnt(6)
    v_mfma_f32_16x16x32_bf16 v[20:23], v[148:151], v[84:87], v[20:23]
    s_cbranch_vccnz Lw172
    s_waitcnt vmcnt(4)
Lw172:
    s_add_u32 s43, s42, 692224
    s_and_b32 s43, s43, 0xfffff
    buffer_load_dwordx4 v[176:179], v4, s[8:11], s43 offen offset:0 nt
    s_waitcnt lgkmcnt(0)
    v_readfirstlane_b32 s67, v61
    s_cmp_lg_u32 s67, 0
    s_cselect_b64 vcc, -1, 0
    s_waitcnt vmcnt(6)
    v_mfma_f32_16x16x32_bf16 v[20:23], v[152:155], v[88:91], v[20:23]
    s_cbranch_vccnz Lw173
    s_waitcnt vmcnt(4)
Lw173:
    buffer_load_dwordx4 v[180:183], v4, s[8:11], s43 offen offset:128 nt
    s_waitcnt vmcnt(6)
    v_mfma_f32_16x16x32_bf16 v[20:23], v[156:159], v[92:95], v[20:23]
    v_cndmask_b32 v56, v27, v24, s[64:65]
    v_cndmask_b32 v57, v25, v26, s[64:65]
    s_nop 1
    v_add_f32_dpp v56, v57, v56 quad_perm:[1,0,3,2] row_mask:0xf bank_mask:0xf
    v_cvt_pk_bf16_f32 v56, v56, v56
    v_and_b32 v56, 0xffff0000, v56
    v_mul_f32 v56, 0x3db504f3, v56
    v_cvt_pk_bf16_f32 v41, v56, v56
    v_and_b32 v41, 0xffff0000, v41
    s_cbranch_vccnz Lw174
    s_waitcnt vmcnt(4)
Lw174:
    buffer_load_dwordx4 v[184:187], v4, s[8:11], s43 offen offset:2048 nt
    v_mov_b32 v59, 42
    ds_write_b32 v60, v59 offset:22528
    s_waitcnt vmcnt(6)
    v_mfma_f32_16x16x32_bf16 v[20:23], v[160:163], v[96:99], v[20:23]
    s_cbranch_vccnz Lw175
    s_waitcnt vmcnt(4)
Lw175:
    buffer_load_dwordx4 v[188:191], v4, s[8:11], s43 offen offset:2176 nt
    s_waitcnt vmcnt(6)
    v_mfma_f32_16x16x32_bf16 v[20:23], v[164:167], v[100:103], v[20:23]
    s_cbranch_vccnz Lw176
    s_waitcnt vmcnt(4)
Lw176:
    s_add_u32 s43, s42, 720896
    s_and_b32 s43, s43, 0xfffff
    buffer_load_dwordx4 v[192:195], v4, s[8:11], s43 offen offset:0 nt
    ds_read_b32 v61, v62 offset:22544
    s_waitcnt vmcnt(6)
    v_mfma_f32_16x16x32_bf16 v[20:23], v[168:171], v[104:107], v[20:23]
    s_cbranch_vccnz Lw177
    s_waitcnt vmcnt(4)
Lw177:
    buffer_load_dwordx4 v[196:199], v4, s[8:11], s43 offen offset:128 nt
    s_waitcnt vmcnt(6)
    v_mfma_f32_16x16x32_bf16 v[20:23], v[172:175], v[108:111], v[20:23]
    s_cbranch_vccnz Lw178
    s_waitcnt vmcnt(4)
Lw178:
    buffer_load_dwordx4 v[200:203], v4, s[8:11], s43 offen offset:2048 nt
    v_mov_b32 v59, 43
    ds_write_b32 v60, v59 offset:22528
    s_waitcnt vmcnt(6)
    v_mfma_f32_16x16x32_bf16 v[20:23], v[176:179], v[112:115], v[20:23]
    s_cbranch_vccnz Lw179
    s_waitcnt vmcnt(4)
Lw179:
    buffer_load_dwordx4 v[204:207], v4, s[8:11], s43 offen offset:2176 nt
    s_waitcnt vmcnt(6)
    v_mfma_f32_16x16x32_bf16 v[20:23], v[180:183], v[116:119], v[20:23]
    s_cbranch_vccnz Lw180
    s_waitcnt vmcnt(4)
Lw180:
    s_add_u32 s43, s42, 724992
    s_and_b32 s43, s43, 0xfffff
    buffer_load_dwordx4 v[208:211], v4, s[8:11], s43 offen offset:0 nt
    s_waitcnt lgkmcnt(0)
    v_readfirstlane_b32 s67, v61
    s_cmp_lg_u32 s67, 0
    s_cselect_b64 vcc, -1, 0
    s_waitcnt vmcnt(6)
    v_mfma_f32_16x16x32_bf16 v[20:23], v[184:187], v[120:123], v[20:23]
    s_cbranch_vccnz Lw181
    s_waitcnt vmcnt(4)
Lw181:
    buffer_load_dwordx4 v[212:215], v4, s[8:11], s43 offen offset:128 nt
    s_waitcnt vmcnt(6)
    v_mfma_f32_16x16x32_bf16 v[20:23], v[188:191], v[124:127], v[20:23]
    s_cbranch_vccnz Lw182
    s_waitcnt vmcnt(4)
Lw182:
    buffer_load_dwordx4 v[216:219], v4, s[8:11], s43 offen offset:2048 nt
    v_mov_b32 v59, 44
    ds_write_b32 v60, v59 offset:22528
    s_waitcnt vmcnt(6)
    v_mfma_f32_16x16x32_bf16 v[24:27], v[192:195], v[64:67], 0
    s_cbranch_vccnz Lw183
    s_waitcnt vmcnt(4)
Lw183:
    buffer_load_dwordx4 v[220:223], v4, s[8:11], s43 offen offset:2176 nt
    s_waitcnt vmcnt(6)
    v_mfma_f32_16x16x32_bf16 v[24:27], v[196:199], v[68:71], v[24:27]
    s_cbranch_vccnz Lw184
    s_waitcnt vmcnt(4)
Lw184:
    s_add_u32 s43, s42, 753664
    s_and_b32 s43, s43, 0xfffff
    buffer_load_dwordx4 v[224:227], v4, s[8:11], s43 offen offset:0 nt
    ds_read_b32 v61, v62 offset:22544
    s_waitcnt vmcnt(6)
    v_mfma_f32_16x16x32_bf16 v[24:27], v[200:203], v[72:75], v[24:27]
    s_cbranch_vccnz Lw185
    s_waitcnt vmcnt(4)
Lw185:
    buffer_load_dwordx4 v[228:231], v4, s[8:11], s43 offen offset:128 nt
    s_waitcnt vmcnt(6)
    v_mfma_f32_16x16x32_bf16 v[24:27], v[204:207], v[76:79], v[24:27]
    s_cbranch_vccnz Lw186
    s_waitcnt vmcnt(4)
Lw186:
    buffer_load_dwordx4 v[232:235], v4, s[8:11], s43 offen offset:2048 nt
    v_mov_b32 v59, 45
    ds_write_b32 v60, v59 offset:22528
    s_waitcnt vmcnt(6)
    v_mfma_f32_16x16x32_bf16 v[24:27], v[208:211], v[80:83], v[24:27]
    s_cbranch_vccnz Lw187
    s_waitcnt vmcnt(4)
Lw187:
    buffer_load_dwordx4 v[236:239], v4, s[8:11], s43 offen offset:2176 nt
    s_waitcnt vmcnt(6)
    v_mfma_f32_16x16x32_bf16 v[24:27], v[212:215], v[84:87], v[24:27]
    s_cbranch_vccnz Lw188
    s_waitcnt vmcnt(4)
Lw188:
    s_add_u32 s43, s42, 757760
    s_and_b32 s43, s43, 0xfffff
    buffer_load_dwordx4 v[240:243], v4, s[8:11], s43 offen offset:0 nt
    s_waitcnt lgkmcnt(0)
    v_readfirstlane_b32 s67, v61
    s_cmp_lg_u32 s67, 0
    s_cselect_b64 vcc, -1, 0
    s_waitcnt vmcnt(6)
    v_mfma_f32_16x16x32_bf16 v[24:27], v[216:219], v[88:91], v[24:27]
    s_cbranch_vccnz Lw189
    s_waitcnt vmcnt(4)
Lw189:
    buffer_load_dwordx4 v[244:247], v4, s[8:11], s43 offen offset:128 nt
    s_waitcnt vmcnt(6)
    v_mfma_f32_16x16x32_bf16 v[24:27], v[220:223], v[92:95], v[24:27]
    v_cndmask_b32 v56, v23, v20, s[64:65]
    v_cndmask_b32 v57, v21, v22, s[64:65]
    s_nop 1
    v_add_f32_dpp v56, v57, v56 quad_perm:[1,0,3,2] row_mask:0xf bank_mask:0xf
    v_cvt_pk_bf16_f32 v56, v56, v56
    v_and_b32 v56, 0xffff0000, v56
    v_mul_f32 v56, 0x3db504f3, v56
    v_cvt_pk_bf16_f32 v42, v56, v56
    v_and_b32 v42, 0xffff0000, v42
    s_cbranch_vccnz Lw190
    s_waitcnt vmcnt(4)
Lw190:
    buffer_load_dwordx4 v[248:251], v4, s[8:11], s43 offen offset:2048 nt
    v_mov_b32 v59, 46
    ds_write_b32 v60, v59 offset:22528
    s_waitcnt vmcnt(6)
    v_mfma_f32_16x16x32_bf16 v[24:27], v[224:227], v[96:99], v[24:27]
    s_cbranch_vccnz Lw191
    s_waitcnt vmcnt(4)
Lw191:
    buffer_load_dwordx4 v[252:255], v4, s[8:11], s43 offen offset:2176 nt
    s_waitcnt vmcnt(6)
    v_mfma_f32_16x16x32_bf16 v[24:27], v[228:231], v[100:103], v[24:27]
    s_cbranch_vccnz Lw192
    s_waitcnt vmcnt(4)
Lw192:
    s_add_u32 s43, s42, 786432
    s_and_b32 s43, s43, 0xfffff
    buffer_load_dwordx4 v[128:131], v4, s[8:11], s43 offen offset:0 nt
    ds_read_b32 v61, v62 offset:22544
    s_waitcnt vmcnt(6)
    v_mfma_f32_16x16x32_bf16 v[24:27], v[232:235], v[104:107], v[24:27]
    s_cbranch_vccnz Lw193
    s_waitcnt vmcnt(4)
Lw193:
    buffer_load_dwordx4 v[132:135], v4, s[8:11], s43 offen offset:128 nt
    s_waitcnt vmcnt(6)
    v_mfma_f32_16x16x32_bf16 v[24:27], v[236:239], v[108:111], v[24:27]
    s_cbranch_vccnz Lw194
    s_waitcnt vmcnt(4)
Lw194:
    buffer_load_dwordx4 v[136:139], v4, s[8:11], s43 offen offset:2048 nt
    v_mov_b32 v59, 47
    ds_write_b32 v60, v59 offset:22528
    s_waitcnt vmcnt(6)
    v_mfma_f32_16x16x32_bf16 v[24:27], v[240:243], v[112:115], v[24:27]
    s_cbranch_vccnz Lw195
    s_waitcnt vmcnt(4)
Lw195:
    buffer_load_dwordx4 v[140:143], v4, s[8:11], s43 offen offset:2176 nt
    s_waitcnt vmcnt(6)
    v_mfma_f32_16x16x32_bf16 v[24:27], v[244:247], v[116:119], v[24:27]
    s_cbranch_vccnz Lw196
    s_waitcnt vmcnt(4)
Lw196:
    s_add_u32 s43, s42, 790528
    s_and_b32 s43, s43, 0xfffff
    buffer_load_dwordx4 v[144:147], v4, s[8:11], s43 offen offset:0 nt
    s_waitcnt lgkmcnt(0)
    v_readfirstlane_b32 s67, v61
    s_cmp_lg_u32 s67, 0
    s_cselect_b64 vcc, -1, 0
    s_waitcnt vmcnt(6)
    v_mfma_f32_16x16x32_bf16 v[24:27], v[248:251], v[120:123], v[24:27]
    s_cbranch_vccnz Lw197
    s_waitcnt vmcnt(4)
Lw197:
    buffer_load_dwordx4 v[148:151], v4, s[8:11], s43 offen offset:128 nt
    s_waitcnt vmcnt(6)
    v_mfma_f32_16x16x32_bf16 v[24:27], v[252:255], v[124:127], v[24:27]
    s_cbranch_vccnz Lw198
    s_waitcnt vmcnt(4)
Lw198:
    buffer_load_dwordx4 v[152:155], v4, s[8:11], s43 offen offset:2048 nt
    v_mov_b32 v59, 48
    ds_write_b32 v60, v59 offset:22528
    s_waitcnt vmcnt(6)
    v_mfma_f32_16x16x32_bf16 v[20:23], v[128:131], v[64:67], 0
    s_cbranch_vccnz Lw199
    s_waitcnt vmcnt(4)
Lw199:
    buffer_load_dwordx4 v[156:159], v4, s[8:11], s43 offen offset:2176 nt
    s_waitcnt vmcnt(6)
    v_mfma_f32_16x16x32_bf16 v[20:23], v[132:135], v[68:71], v[20:23]
    s_cbranch_vccnz Lw200
    s_waitcnt vmcnt(4)
Lw200:
    s_add_u32 s43, s42, 819200
    s_and_b32 s43, s43, 0xfffff
    buffer_load_dwordx4 v[160:163], v4, s[8:11], s43 offen offset:0 nt
    ds_read_b32 v61, v62 offset:22544
    s_waitcnt vmcnt(6)
    v_mfma_f32_16x16x32_bf16 v[20:23], v[136:139], v[72:75], v[20:23]
    s_cbranch_vccnz Lw201
    s_waitcnt vmcnt(4)
Lw201:
    buffer_load_dwordx4 v[164:167], v4, s[8:11], s43 offen offset:128 nt
    s_waitcnt vmcnt(6)
    v_mfma_f32_16x16x32_bf16 v[20:23], v[140:143], v[76:79], v[20:23]
    s_cbranch_vccnz Lw202
    s_waitcnt vmcnt(4)
Lw202:
    buffer_load_dwordx4 v[168:171], v4, s[8:11], s43 offen offset:2048 nt
    v_mov_b32 v59, 49
    ds_write_b32 v60, v59 offset:22528
    s_waitcnt vmcnt(6)
    v_mfma_f32_16x16x32_bf16 v[20:23], v[144:147], v[80:83], v[20:23]
    s_cbranch_vccnz Lw203
    s_waitcnt vmcnt(4)
Lw203:
    buffer_load_dwordx4 v[172:175], v4, s[8:11], s43 offen offset:2176 nt
    s_waitcnt vmcnt(6)
    v_mfma_f32_16x16x32_bf16 v[20:23], v[148:151], v[84:87], v[20:23]
    s_cbranch_vccnz Lw204
    s_waitcnt vmcnt(4)
Lw204:
    s_add_u32 s43, s42, 823296
    s_and_b32 s43, s43, 0xfffff
    buffer_load_dwordx4 v[176:179], v4, s[8:11], s43 offen offset:0 nt
    s_waitcnt lgkmcnt(0)
    v_readfirstlane_b32 s67, v61
    s_cmp_lg_u32 s67, 0
    s_cselect_b64 vcc, -1, 0
    s_waitcnt vmcnt(6)
    v_mfma_f32_16x16x32_bf16 v[20:23], v[152:155], v[88:91], v[20:23]
    s_cbranch_vccnz Lw205
    s_waitcnt vmcnt(4)
Lw205:
    buffer_load_dwordx4 v[180:183], v4, s[8:11], s43 offen offset:128 nt
    s_waitcnt vmcnt(6)
    v_mfma_f32_16x16x32_bf16 v[20:23], v[156:159], v[92:95], v[20:23]
    v_cndmask_b32 v56, v27, v24, s[64:65]
    v_cndmask_b32 v57, v25, v26, s[64:65]
    s_nop 1
    v_add_f32_dpp v56, v57, v56 quad_perm:[1,0,3,2] row_mask:0xf bank_mask:0xf
    v_cvt_pk_bf16_f32 v56, v56, v56
    v_and_b32 v56, 0xffff0000, v56
    v_mul_f32 v56, 0x3db504f3, v56
    v_cvt_pk_bf16_f32 v43, v56, v56
    v_and_b32 v43, 0xffff0000, v43
    s_cbranch_vccnz Lw206
    s_waitcnt vmcnt(4)
Lw206:
    buffer_load_dwordx4 v[184:187], v4, s[8:11], s43 offen offset:2048 nt
    v_mov_b32 v59, 50
    ds_write_b32 v60, v59 offset:22528
    s_waitcnt vmcnt(6)
    v_mfma_f32_16x16x32_bf16 v[20:23], v[160:163], v[96:99], v[20:23]
    s_cbranch_vccnz Lw207
    s_waitcnt vmcnt(4)
Lw207:
    buffer_load_dwordx4 v[188:191], v4, s[8:11], s43 offen offset:2176 nt
    s_waitcnt vmcnt(6)
    v_mfma_f32_16x16x32_bf16 v[20:23], v[164:167], v[100:103], v[20:23]
    s_cbranch_vccnz Lw208
    s_waitcnt vmcnt(4)
Lw208:
    s_add_u32 s43, s42, 851968
    s_and_b32 s43, s43, 0xfffff
    buffer_load_dwordx4 v[192:195], v4, s[8:11], s43 offen offset:0 nt
    ds_read_b32 v61, v62 offset:22544
    s_waitcnt vmcnt(6)
    v_mfma_f32_16x16x32_bf16 v[20:23], v[168:171], v[104:107], v[20:23]
    s_cbranch_vccnz Lw209
    s_waitcnt vmcnt(4)
Lw209:
    buffer_load_dwordx4 v[196:199], v4, s[8:11], s43 offen offset:128 nt
    s_waitcnt vmcnt(6)
    v_mfma_f32_16x16x32_bf16 v[20:23], v[172:175], v[108:111], v[20:23]
    s_cbranch_vccnz Lw210
    s_waitcnt vmcnt(4)
Lw210:
    buffer_load_dwordx4 v[200:203], v4, s[8:11], s43 offen offset:2048 nt
    v_mov_b32 v59, 51
    ds_write_b32 v60, v59 offset:22528
    s_waitcnt vmcnt(6)
    v_mfma_f32_16x16x32_bf16 v[20:23], v[176:179], v[112:115], v[20:23]
    s_cbranch_vccnz Lw211
    s_waitcnt vmcnt(4)
Lw211:
    buffer_load_dwordx4 v[204:207], v4, s[8:11], s43 offen offset:2176 nt
    s_waitcnt vmcnt(6)
    v_mfma_f32_16x16x32_bf16 v[20:23], v[180:183], v[116:119], v[20:23]
    s_cbranch_vccnz Lw212
    s_waitcnt vmcnt(4)
Lw212:
    s_add_u32 s43, s42, 856064
    s_and_b32 s43, s43, 0xfffff
    buffer_load_dwordx4 v[208:211], v4, s[8:11], s43 offen offset:0 nt
    s_waitcnt lgkmcnt(0)
    v_readfirstlane_b32 s67, v61
    s_cmp_lg_u32 s67, 0
    s_cselect_b64 vcc, -1, 0
    s_waitcnt vmcnt(6)
    v_mfma_f32_16x16x32_bf16 v[20:23], v[184:187], v[120:123], v[20:23]
    s_cbranch_vccnz Lw213
    s_waitcnt vmcnt(4)
Lw213:
    buffer_load_dwordx4 v[212:215], v4, s[8:11], s43 offen offset:128 nt
    s_waitcnt vmcnt(6)
    v_mfma_f32_16x16x32_bf16 v[20:23], v[188:191], v[124:127], v[20:23]
    s_cbranch_vccnz Lw214
    s_waitcnt vmcnt(4)
Lw214:
    buffer_load_dwordx4 v[216:219], v4, s[8:11], s43 offen offset:2048 nt
    v_mov_b32 v59, 52
    ds_write_b32 v60, v59 offset:22528
    s_waitcnt vmcnt(6)
    v_mfma_f32_16x16x32_bf16 v[24:27], v[192:195], v[64:67], 0
    s_cbranch_vccnz Lw215
    s_waitcnt vmcnt(4)
Lw215:
    buffer_load_dwordx4 v[220:223], v4, s[8:11], s43 offen offset:2176 nt
    s_waitcnt vmcnt(6)
    v_mfma_f32_16x16x32_bf16 v[24:27], v[196:199], v[68:71], v[24:27]
    s_cbranch_vccnz Lw216
    s_waitcnt vmcnt(4)
Lw216:
    s_add_u32 s43, s42, 884736
    s_and_b32 s43, s43, 0xfffff
    buffer_load_dwordx4 v[224:227], v4, s[8:11], s43 offen offset:0 nt
    ds_read_b32 v61, v62 offset:22544
    s_waitcnt vmcnt(6)
    v_mfma_f32_16x16x32_bf16 v[24:27], v[200:203], v[72:75], v[24:27]
    s_cbranch_vccnz Lw217
    s_waitcnt vmcnt(4)
Lw217:
    buffer_load_dwordx4 v[228:231], v4, s[8:11], s43 offen offset:128 nt
    s_waitcnt vmcnt(6)
    v_mfma_f32_16x16x32_bf16 v[24:27], v[204:207], v[76:79], v[24:27]
    s_cbranch_vccnz Lw218
    s_waitcnt vmcnt(4)
Lw218:
    buffer_load_dwordx4 v[232:235], v4, s[8:11], s43 offen offset:2048 nt
    v_mov_b32 v59, 53
    ds_write_b32 v60, v59 offset:22528
    s_waitcnt vmcnt(6)
    v_mfma_f32_16x16x32_bf16 v[24:27], v[208:211], v[80:83], v[24:27]
    s_cbranch_vccnz Lw219
    s_waitcnt vmcnt(4)
Lw219:
    buffer_load_dwordx4 v[236:239], v4, s[8:11], s43 offen offset:2176 nt
    s_waitcnt vmcnt(6)
    v_mfma_f32_16x16x32_bf16 v[24:27], v[212:215], v[84:87], v[24:27]
    s_cbranch_vccnz Lw220
    s_waitcnt vmcnt(4)
Lw220:
    s_add_u32 s43, s42, 888832
    s_and_b32 s43, s43, 0xfffff
    buffer_load_dwordx4 v[240:243], v4, s[8:11], s43 offen offset:0 nt
    s_waitcnt lgkmcnt(0)
    v_readfirstlane_b32 s67, v61
    s_cmp_lg_u32 s67, 0
    s_cselect_b64 vcc, -1, 0
    s_waitcnt vmcnt(6)
    v_mfma_f32_16x16x32_bf16 v[24:27], v[216:219], v[88:91], v[24:27]
    s_cbranch_vccnz Lw221
    s_waitcnt vmcnt(4)
Lw221:
    buffer_load_dwordx4 v[244:247], v4, s[8:11], s43 offen offset:128 nt
    s_waitcnt vmcnt(6)
    v_mfma_f32_16x16x32_bf16 v[24:27], v[220:223], v[92:95], v[24:27]
    v_cndmask_b32 v56, v23, v20, s[64:65]
    v_cndmask_b32 v57, v21, v22, s[64:65]
    s_nop 1
    v_add_f32_dpp v56, v57, v56 quad_perm:[1,0,3,2] row_mask:0xf bank_mask:0xf
    v_cvt_pk_bf16_f32 v56, v56, v56
    v_and_b32 v56, 0xffff0000, v56
    v_mul_f32 v56, 0x3db504f3, v56
    v_cvt_pk_bf16_f32 v44, v56, v56
    v_and_b32 v44, 0xffff0000, v44
    s_cbranch_vccnz Lw222
    s_waitcnt vmcnt(4)
Lw222:
    buffer_load_dwordx4 v[248:251], v4, s[8:11], s43 offen offset:2048 nt
    v_mov_b32 v59, 54
    ds_write_b32 v60, v59 offset:22528
    s_waitcnt vmcnt(6)
    v_mfma_f32_16x16x32_bf16 v[24:27], v[224:227], v[96:99], v[24:27]
    s_cbranch_vccnz Lw223
    s_waitcnt vmcnt(4)
Lw223:
    buffer_load_dwordx4 v[252:255], v4, s[8:11], s43 offen offset:2176 nt
    s_waitcnt vmcnt(6)
    v_mfma_f32_16x16x32_bf16 v[24:27], v[228:231], v[100:103], v[24:27]
    s_cbranch_vccnz Lw224
    s_waitcnt vmcnt(4)
Lw224:
    s_add_u32 s43, s42, 917504
    s_and_b32 s43, s43, 0xfffff
    buffer_load_dwordx4 v[128:131], v4, s[8:11], s43 offen offset:0 nt
    ds_read_b32 v61, v62 offset:22544
    s_waitcnt vmcnt(6)
    v_mfma_f32_16x16x32_bf16 v[24:27], v[232:235], v[104:107], v[24:27]
    s_cbranch_vccnz Lw225
    s_waitcnt vmcnt(4)
Lw225:
    buffer_load_dwordx4 v[132:135], v4, s[8:11], s43 offen offset:128 nt
    s_waitcnt vmcnt(6)
    v_mfma_f32_16x16x32_bf16 v[24:27], v[236:239], v[108:111], v[24:27]
    s_cbranch_vccnz Lw226
    s_waitcnt vmcnt(4)
Lw226:
    buffer_load_dwordx4 v[136:139], v4, s[8:11], s43 offen offset:2048 nt
    v_mov_b32 v59, 55
    ds_write_b32 v60, v59 offset:22528
    s_waitcnt vmcnt(6)
    v_mfma_f32_16x16x32_bf16 v[24:27], v[240:243], v[112:115], v[24:27]
    s_cbranch_vccnz Lw227
    s_waitcnt vmcnt(4)
Lw227:
    buffer_load_dwordx4 v[140:143], v4, s[8:11], s43 offen offset:2176 nt
    s_waitcnt vmcnt(6)
    v_mfma_f32_16x16x32_bf16 v[24:27], v[244:247], v[116:119], v[24:27]
    s_cbranch_vccnz Lw228
    s_waitcnt vmcnt(4)
Lw228:
    s_add_u32 s43, s42, 921600
    s_and_b32 s43, s43, 0xfffff
    buffer_load_dwordx4 v[144:147], v4, s[8:11], s43 offen offset:0 nt
    s_waitcnt lgkmcnt(0)
    v_readfirstlane_b32 s67, v61
    s_cmp_lg_u32 s67, 0
    s_cselect_b64 vcc, -1, 0
    s_waitcnt vmcnt(6)
    v_mfma_f32_16x16x32_bf16 v[24:27], v[248:251], v[120:123], v[24:27]
    s_cbranch_vccnz Lw229
    s_waitcnt vmcnt(4)
Lw229:
    buffer_load_dwordx4 v[148:151], v4, s[8:11], s43 offen offset:128 nt
    s_waitcnt vmcnt(6)
    v_mfma_f32_16x16x32_bf16 v[24:27], v[252:255], v[124:127], v[24:27]
    s_cbranch_vccnz Lw230
    s_waitcnt vmcnt(4)
Lw230:
    buffer_load_dwordx4 v[152:155], v4, s[8:11], s43 offen offset:2048 nt
    v_mov_b32 v59, 56
    ds_write_b32 v60, v59 offset:22528
    s_waitcnt vmcnt(6)
    v_mfma_f32_16x16x32_bf16 v[20:23], v[128:131], v[64:67], 0
    s_cbranch_vccnz Lw231
    s_waitcnt vmcnt(4)
Lw231:
    buffer_load_dwordx4 v[156:159], v4, s[8:11], s43 offen offset:2176 nt
    s_waitcnt vmcnt(6)
    v_mfma_f32_16x16x32_bf16 v[20:23], v[132:135], v[68:71], v[20:23]
    s_cbranch_vccnz Lw232
    s_waitcnt vmcnt(4)
Lw232:
    s_add_u32 s43, s42, 950272
    s_and_b32 s43, s43, 0xfffff
    buffer_load_dwordx4 v[160:163], v4, s[8:11], s43 offen offset:0 nt
    ds_read_b32 v61, v62 offset:22544
    s_waitcnt vmcnt(6)
    v_mfma_f32_16x16x32_bf16 v[20:23], v[136:139], v[72:75], v[20:23]
    s_cbranch_vccnz Lw233
    s_waitcnt vmcnt(4)
Lw233:
    buffer_load_dwordx4 v[164:167], v4, s[8:11], s43 offen offset:128 nt
    s_waitcnt vmcnt(6)
    v_mfma_f32_16x16x32_bf16 v[20:23], v[140:143], v[76:79], v[20:23]
    s_cbranch_vccnz Lw234
    s_waitcnt vmcnt(4)
Lw234:
    buffer_load_dwordx4 v[168:171], v4, s[8:11], s43 offen offset:2048 nt
    v_mov_b32 v59, 57
    ds_write_b32 v60, v59 offset:22528
    s_waitcnt vmcnt(6)
    v_mfma_f32_16x16x32_bf16 v[20:23], v[144:147], v[80:83], v[20:23]
    s_cbranch_vccnz Lw235
    s_waitcnt vmcnt(4)
Lw235:
    buffer_load_dwordx4 v[172:175], v4, s[8:11], s43 offen offset:2176 nt
    s_waitcnt vmcnt(6)
    v_mfma_f32_16x16x32_bf16 v[20:23], v[148:151], v[84:87], v[20:23]
    s_cbranch_vccnz Lw236
    s_waitcnt vmcnt(4)
Lw236:
    s_add_u32 s43, s42, 954368
    s_and_b32 s43, s43, 0xfffff
    buffer_load_dwordx4 v[176:179], v4, s[8:11], s43 offen offset:0 nt
    s_waitcnt lgkmcnt(0)
    v_readfirstlane_b32 s67, v61
    s_cmp_lg_u32 s67, 0
    s_cselect_b64 vcc, -1, 0
    s_waitcnt vmcnt(6)
    v_mfma_f32_16x16x32_bf16 v[20:23], v[152:155], v[88:91], v[20:23]
    s_cbranch_vccnz Lw237
    s_waitcnt vmcnt(4)
Lw237:
    buffer_load_dwordx4 v[180:183], v4, s[8:11], s43 offen offset:128 nt
    s_waitcnt vmcnt(6)
    v_mfma_f32_16x16x32_bf16 v[20:23], v[156:159], v[92:95], v[20:23]
    v_cndmask_b32 v56, v27, v24, s[64:65]
    v_cndmask_b32 v57, v25, v26, s[64:65]
    s_nop 1
    v_add_f32_dpp v56, v57, v56 quad_perm:[1,0,3,2] row_mask:0xf bank_mask:0xf
    v_cvt_pk_bf16_f32 v56, v56, v56
    v_and_b32 v56, 0xffff0000, v56
    v_mul_f32 v56, 0x3db504f3, v56
    v_cvt_pk_bf16_f32 v45, v56, v56
    v_and_b32 v45, 0xffff0000, v45
    s_cbranch_vccnz Lw238
    s_waitcnt vmcnt(4)
Lw238:
    buffer_load_dwordx4 v[184:187], v4, s[8:11], s43 offen offset:2048 nt
    v_mov_b32 v59, 58
    ds_write_b32 v60, v59 offset:22528
    s_waitcnt vmcnt(6)
    v_mfma_f32_16x16x32_bf16 v[20:23], v[160:163], v[96:99], v[20:23]
    s_cbranch_vccnz Lw239
    s_waitcnt vmcnt(4)
Lw239:
    buffer_load_dwordx4 v[188:191], v4, s[8:11], s43 offen offset:2176 nt
    s_waitcnt vmcnt(6)
    v_mfma_f32_16x16x32_bf16 v[20:23], v[164:167], v[100:103], v[20:23]
    s_cbranch_vccnz Lw240
    s_waitcnt vmcnt(4)
Lw240:
    s_add_u32 s43, s42, 983040
    s_and_b32 s43, s43, 0xfffff
    buffer_load_dwordx4 v[192:195], v4, s[8:11], s43 offen offset:0 nt
    ds_read_b32 v61, v62 offset:22544
    s_waitcnt vmcnt(6)
    v_mfma_f32_16x16x32_bf16 v[20:23], v[168:171], v[104:107], v[20:23]
    s_cbranch_vccnz Lw241
    s_waitcnt vmcnt(4)
Lw241:
    buffer_load_dwordx4 v[196:199], v4, s[8:11], s43 offen offset:128 nt
    s_waitcnt vmcnt(6)
    v_mfma_f32_16x16x32_bf16 v[20:23], v[172:175], v[108:111], v[20:23]
    s_cbranch_vccnz Lw242
    s_waitcnt vmcnt(4)
Lw242:
    buffer_load_dwordx4 v[200:203], v4, s[8:11], s43 offen offset:2048 nt
    v_mov_b32 v59, 59
    ds_write_b32 v60, v59 offset:22528
    s_waitcnt vmcnt(6)
    v_mfma_f32_16x16x32_bf16 v[20:23], v[176:179], v[112:115], v[20:23]
    s_cbranch_vccnz Lw243
    s_waitcnt vmcnt(4)
Lw243:
    buffer_load_dwordx4 v[204:207], v4, s[8:11], s43 offen offset:2176 nt
    s_waitcnt vmcnt(6)
    v_mfma_f32_16x16x32_bf16 v[20:23], v[180:183], v[116:119], v[20:23]
    s_cbranch_vccnz Lw244
    s_waitcnt vmcnt(4)
Lw244:
    s_add_u32 s43, s42, 987136
    s_and_b32 s43, s43, 0xfffff
    buffer_load_dwordx4 v[208:211], v4, s[8:11], s43 offen offset:0 nt
    s_waitcnt lgkmcnt(0)
    v_readfirstlane_b32 s67, v61
    s_cmp_lg_u32 s67, 0
    s_cselect_b64 vcc, -1, 0
    s_waitcnt vmcnt(6)
    v_mfma_f32_16x16x32_bf16 v[20:23], v[184:187], v[120:123], v[20:23]
    s_cbranch_vccnz Lw245
    s_waitcnt vmcnt(4)
Lw245:
    buffer_load_dwordx4 v[212:215], v4, s[8:11], s43 offen offset:128 nt
    s_waitcnt vmcnt(6)
    v_mfma_f32_16x16x32_bf16 v[20:23], v[188:191], v[124:127], v[20:23]
    s_cbranch_vccnz Lw246
    s_waitcnt vmcnt(4)
Lw246:
    buffer_load_dwordx4 v[216:219], v4, s[8:11], s43 offen offset:2048 nt
    v_mov_b32 v59, 60
    ds_write_b32 v60, v59 offset:22528
    s_waitcnt vmcnt(6)
    v_mfma_f32_16x16x32_bf16 v[24:27], v[192:195], v[64:67], 0
    s_cbranch_vccnz Lw247
    s_waitcnt vmcnt(4)
Lw247:
    buffer_load_dwordx4 v[220:223], v4, s[8:11], s43 offen offset:2176 nt
    s_waitcnt vmcnt(6)
    v_mfma_f32_16x16x32_bf16 v[24:27], v[196:199], v[68:71], v[24:27]
    s_cbranch_vccnz Lw248
    s_waitcnt vmcnt(4)
Lw248:
    s_add_u32 s43, s42, 1015808
    s_and_b32 s43, s43, 0xfffff
    buffer_load_dwordx4 v[224:227], v4, s[8:11], s43 offen offset:0 nt
    ds_read_b32 v61, v62 offset:22544
    s_waitcnt vmcnt(6)
    v_mfma_f32_16x16x32_bf16 v[24:27], v[200:203], v[72:75], v[24:27]
    s_cbranch_vccnz Lw249
    s_waitcnt vmcnt(4)
Lw249:
    buffer_load_dwordx4 v[228:231], v4, s[8:11], s43 offen offset:128 nt
    s_waitcnt vmcnt(6)
    v_mfma_f32_16x16x32_bf16 v[24:27], v[204:207], v[76:79], v[24:27]
    s_cbranch_vccnz Lw250
    s_waitcnt vmcnt(4)
Lw250:
    buffer_load_dwordx4 v[232:235], v4, s[8:11], s43 offen offset:2048 nt
    v_mov_b32 v59, 61
    ds_write_b32 v60, v59 offset:22528
    s_waitcnt vmcnt(6)
    v_mfma_f32_16x16x32_bf16 v[24:27], v[208:211], v[80:83], v[24:27]
    s_cbranch_vccnz Lw251
    s_waitcnt vmcnt(4)
Lw251:
    buffer_load_dwordx4 v[236:239], v4, s[8:11], s43 offen offset:2176 nt
    s_waitcnt vmcnt(6)
    v_mfma_f32_16x16x32_bf16 v[24:27], v[212:215], v[84:87], v[24:27]
    s_cbranch_vccnz Lw252
    s_waitcnt vmcnt(4)
Lw252:
    s_add_u32 s43, s42, 1019904
    s_and_b32 s43, s43, 0xfffff
    buffer_load_dwordx4 v[240:243], v4, s[8:11], s43 offen offset:0 nt
    s_waitcnt lgkmcnt(0)
    v_readfirstlane_b32 s67, v61
    s_cmp_lg_u32 s67, 0
    s_cselect_b64 vcc, -1, 0
    s_waitcnt vmcnt(6)
    v_mfma_f32_16x16x32_bf16 v[24:27], v[216:219], v[88:91], v[24:27]
    s_cbranch_vccnz Lw253
    s_waitcnt vmcnt(4)
Lw253:
    buffer_load_dwordx4 v[244:247], v4, s[8:11], s43 offen offset:128 nt
    s_waitcnt vmcnt(6)
    v_mfma_f32_16x16x32_bf16 v[24:27], v[220:223], v[92:95], v[24:27]
    v_cndmask_b32 v56, v23, v20, s[64:65]
    v_cndmask_b32 v57, v21, v22, s[64:65]
    s_nop 1
    v_add_f32_dpp v56, v57, v56 quad_perm:[1,0,3,2] row_mask:0xf bank_mask:0xf
    v_cvt_pk_bf16_f32 v56, v56, v56
    v_and_b32 v56, 0xffff0000, v56
    v_mul_f32 v56, 0x3db504f3, v56
    v_cvt_pk_bf16_f32 v46, v56, v56
    v_and_b32 v46, 0xffff0000, v46
    s_cbranch_vccnz Lw254
    s_waitcnt vmcnt(4)
Lw254:
    buffer_load_dwordx4 v[248:251], v4, s[8:11], s43 offen offset:2048 nt
    v_mov_b32 v59, 62
    ds_write_b32 v60, v59 offset:22528
    s_waitcnt vmcnt(6)
    v_mfma_f32_16x16x32_bf16 v[24:27], v[224:227], v[96:99], v[24:27]
    s_cbranch_vccnz Lw255
    s_waitcnt vmcnt(4)
Lw255:
    buffer_load_dwordx4 v[252:255], v4, s[8:11], s43 offen offset:2176 nt
    s_waitcnt vmcnt(6)
    v_mfma_f32_16x16x32_bf16 v[24:27], v[228:231], v[100:103], v[24:27]
    s_cbranch_vccnz Lw256
    s_waitcnt vmcnt(4)
Lw256:
    s_add_u32 s43, s42, 0
    s_and_b32 s43, s43, 0xfffff
    buffer_load_dwordx4 v[128:131], v5, s[12:15], s43 offen offset:0 nt
    ds_read_b32 v61, v62 offset:22544
    s_waitcnt vmcnt(6)
    v_mfma_f32_16x16x32_bf16 v[24:27], v[232:235], v[104:107], v[24:27]
    s_cbranch_vccnz Lw257
    s_waitcnt vmcnt(4)
Lw257:
    buffer_load_dwordx4 v[132:135], v5, s[12:15], s43 offen offset:1024 nt
    s_waitcnt vmcnt(6)
    v_mfma_f32_16x16x32_bf16 v[24:27], v[236:239], v[108:111], v[24:27]
    s_cbranch_vccnz Lw258
    s_waitcnt vmcnt(4)
Lw258:
    buffer_load_dwordx4 v[136:139], v5, s[12:15], s43 offen offset:2048 nt
    v_mov_b32 v59, 63
    ds_write_b32 v60, v59 offset:22528
    s_waitcnt vmcnt(6)
    v_mfma_f32_16x16x32_bf16 v[24:27], v[240:243], v[112:115], v[24:27]
    s_cbranch_vccnz Lw259
    s_waitcnt vmcnt(4)
Lw259:
    buffer_load_dwordx4 v[140:143], v5, s[12:15], s43 offen offset:3072 nt
    s_waitcnt vmcnt(6)
    v_mfma_f32_16x16x32_bf16 v[24:27], v[244:247], v[116:119], v[24:27]
    s_cbranch_vccnz Lw260
    s_waitcnt vmcnt(4)
Lw260:
    s_add_u32 s43, s42, 4096
    s_and_b32 s43, s43, 0xfffff
    buffer_load_dwordx4 v[144:147], v5, s[12:15], s43 offen offset:0 nt
    s_waitcnt lgkmcnt(0)
    v_readfirstlane_b32 s67, v61
    s_cmp_lg_u32 s67, 0
    s_cselect_b64 vcc, -1, 0
    s_waitcnt vmcnt(6)
    v_mfma_f32_16x16x32_bf16 v[24:27], v[248:251], v[120:123], v[24:27]
    s_cbranch_vccnz Lw261
    s_waitcnt vmcnt(4)
Lw261:
    buffer_load_dwordx4 v[148:151], v5, s[12:15], s43 offen offset:1024 nt
    s_waitcnt vmcnt(6)
    v_mfma_f32_16x16x32_bf16 v[24:27], v[252:255], v[124:127], v[24:27]
    s_nop 7
    v_cndmask_b32 v56, v27, v24, s[64:65]
    v_cndmask_b32 v57, v25, v26, s[64:65]
    s_nop 1
    v_add_f32_dpp v56, v57, v56 quad_perm:[1,0,3,2] row_mask:0xf bank_mask:0xf
    v_cvt_pk_bf16_f32 v56, v56, v56
    v_and_b32 v56, 0xffff0000, v56
    v_mul_f32 v56, 0x3db504f3, v56
    v_cvt_pk_bf16_f32 v47, v56, v56
    v_and_b32 v47, 0xffff0000, v47
    v_max3_f32 v48, v32, v33, v34
    v_max3_f32 v48, v48, v35, v36
    v_max3_f32 v48, v48, v37, v38
    v_max3_f32 v48, v48, v39, v40
    v_max3_f32 v48, v48, v41, v42
    v_max3_f32 v48, v48, v43, v44
    v_max3_f32 v48, v48, v45, v46
    v_max_f32 v48, v48, v47
    s_cbranch_vccnz Lw262
    s_waitcnt vmcnt(4)
Lw262:
    buffer_load_dwordx4 v[152:155], v5, s[12:15], s43 offen offset:2048 nt
    s_nop 1
    v_max_f32_dpp v48, v48, v48 row_ror:8 row_mask:0xf bank_mask:0xf
    s_nop 1
    v_max_f32_dpp v48, v48, v48 row_ror:4 row_mask:0xf bank_mask:0xf
    s_nop 1
    v_max_f32_dpp v48, v48, v48 row_ror:2 row_mask:0xf bank_mask:0xf
    s_nop 1
    v_max_f32_dpp v48, v48, v48 row_ror:1 row_mask:0xf bank_mask:0xf
    v_mov_b32 v50, v48
    s_nop 1
    v_permlane16_swap_b32 v48, v50
    s_nop 0
    v_max_f32 v48, v48, v50
    v_mov_b32 v50, v48
    s_nop 1
    v_permlane32_swap_b32 v48, v50
    s_nop 0
    v_max_f32 v48, v48, v50
    s_cbranch_vccnz Lw263
    s_waitcnt vmcnt(4)
Lw263:
    s_waitcnt vmcnt(6)
    buffer_load_dwordx4 v[156:159], v5, s[12:15], s43 offen offset:3072 nt
    v_mov_b32 v49, 0
    v_sub_f32 v58, v32, v48
    v_mul_f32 v58, 0x3fb8aa3b, v58
    v_exp_f32 v58, v58
    s_nop 0
    v_add_f32 v49, v49, v58
    v_cvt_pk_bf16_f32 v32, v58, v58
    s_nop 1
    v_and_b32_dpp v12, v32, v8 row_newbcast:0 row_mask:0xf bank_mask:0xf
    v_and_b32_dpp v13, v32, v9 row_newbcast:0 row_mask:0xf bank_mask:0xf
    v_and_b32_dpp v14, v32, v10 row_newbcast:0 row_mask:0xf bank_mask:0xf
    v_and_b32_dpp v15, v32, v11 row_newbcast:0 row_mask:0xf bank_mask:0xf
    s_cbranch_vccnz Lw264
    s_waitcnt vmcnt(4)
Lw264:
    s_waitcnt vmcnt(6)
    s_add_u32 s43, s42, 32768
    s_and_b32 s43, s43, 0xfffff
    buffer_load_dwordx4 v[160:163], v5, s[12:15], s43 offen offset:0 nt
    v_mov_b32 v59, 64
    ds_write_b32 v60, v59 offset:22528
    v_and_b32_dpp v16, v32, v8 row_newbcast:1 row_mask:0xf bank_mask:0xf
    v_and_b32_dpp v17, v32, v9 row_newbcast:1 row_mask:0xf bank_mask:0xf
    v_and_b32_dpp v18, v32, v10 row_newbcast:1 row_mask:0xf bank_mask:0xf
    v_and_b32_dpp v19, v32, v11 row_newbcast:1 row_mask:0xf bank_mask:0xf
    v_mfma_f32_16x16x32_bf16 v[28:31], v[12:15], v[128:131], 0
    v_and_b32_dpp v12, v32, v8 row_newbcast:2 row_mask:0xf bank_mask:0xf
    v_and_b32_dpp v13, v32, v9 row_newbcast:2 row_mask:0xf bank_mask:0xf
    v_and_b32_dpp v14, v32, v10 row_newbcast:2 row_mask:0xf bank_mask:0xf
    v_and_b32_dpp v15, v32, v11 row_newbcast:2 row_mask:0xf bank_mask:0xf
    v_mfma_f32_16x16x32_bf16 v[28:31], v[16:19], v[132:135], v[28:31]
    s_cbranch_vccnz Lw265
    s_waitcnt vmcnt(4)
Lw265:
    s_waitcnt vmcnt(6)
    buffer_load_dwordx4 v[164:167], v5, s[12:15], s43 offen offset:1024 nt
    ds_read_b32 v61, v62 offset:22544
    v_and_b32_dpp v16, v32, v8 row_newbcast:3 row_mask:0xf bank_mask:0xf
    v_and_b32_dpp v17, v32, v9 row_newbcast:3 row_mask:0xf bank_mask:0xf
    v_and_b32_dpp v18, v32, v10 row_newbcast:3 row_mask:0xf bank_mask:0xf
    v_and_b32_dpp v19, v32, v11 row_newbcast:3 row_mask:0xf bank_mask:0xf
    v_mfma_f32_16x16x32_bf16 v[28:31], v[12:15], v[136:139], v[28:31]
    s_cbranch_vccnz Lw266
    s_waitcnt vmcnt(4)
Lw266:
    s_waitcnt vmcnt(6)
    buffer_load_dwordx4 v[168:171], v5, s[12:15], s43 offen offset:2048 nt
    v_and_b32_dpp v12, v32, v8 row_newbcast:4 row_mask:0xf bank_mask:0xf
    v_and_b32_dpp v13, v32, v9 row_newbcast:4 row_mask:0xf bank_mask:0xf
    v_and_b32_dpp v14, v32, v10 row_newbcast:4 row_mask:0xf bank_mask:0xf
    v_and_b32_dpp v15, v32, v11 row_newbcast:4 row_mask:0xf bank_mask:0xf
    v_mfma_f32_16x16x32_bf16 v[28:31], v[16:19], v[140:143], v[28:31]
    s_cbranch_vccnz Lw267
    s_waitcnt vmcnt(4)
Lw267:
    s_waitcnt vmcnt(6)
    buffer_load_dwordx4 v[172:175], v5, s[12:15], s43 offen offset:3072 nt
    v_mov_b32 v59, 65
    ds_write_b32 v60, v59 offset:22528
    v_and_b32_dpp v16, v32, v8 row_newbcast:5 row_mask:0xf bank_mask:0xf
    v_and_b32_dpp v17, v32, v9 row_newbcast:5 row_mask:0xf bank_mask:0xf
    v_and_b32_dpp v18, v32, v10 row_newbcast:5 row_mask:0xf bank_mask:0xf
    v_and_b32_dpp v19, v32, v11 row_newbcast:5 row_mask:0xf bank_mask:0xf
    v_mfma_f32_16x16x32_bf16 v[28:31], v[12:15], v[144:147], v[28:31]
    v_sub_f32 v58, v33, v48
    v_mul_f32 v58, 0x3fb8aa3b, v58
    v_exp_f32 v58, v58
    s_nop 0
    v_add_f32 v49, v49, v58
    v_cvt_pk_bf16_f32 v33, v58, v58
    s_cbranch_vccnz Lw268
    s_waitcnt vmcnt(4)
Lw268:
    s_waitcnt vmcnt(6)
    s_add_u32 s43, s42, 36864
    s_and_b32 s43, s43, 0xfffff
    buffer_load_dwordx4 v[176:179], v5, s[12:15], s43 offen offset:0 nt
    v_and_b32_dpp v12, v32, v8 row_newbcast:6 row_mask:0xf bank_mask:0xf
    v_and_b32_dpp v13, v32, v9 row_newbcast:6 row_mask:0xf bank_mask:0xf
    v_and_b32_dpp v14, v32, v10 row_newbcast:6 row_mask:0xf bank_mask:0xf
    v_and_b32_dpp v15, v32, v11 row_newbcast:6 row_mask:0xf bank_mask:0xf
    v_mfma_f32_16x16x32_bf16 v[28:31], v[16:19], v[148:151], v[28:31]
    s_cbranch_vccnz Lw269
    s_waitcnt vmcnt(4)
Lw269:
    s_waitcnt vmcnt(6)
    buffer_load_dwordx4 v[180:183], v5, s[12:15], s43 offen offset:1024 nt
    s_waitcnt lgkmcnt(0)
    v_readfirstlane_b32 s67, v61
    s_cmp_lg_u32 s67, 0
    s_cselect_b64 vcc, -1, 0
    v_and_b32_dpp v16, v32, v8 row_newbcast:7 row_mask:0xf bank_mask:0xf
    v_and_b32_dpp v17, v32, v9 row_newbcast:7 row_mask:0xf bank_mask:0xf
    v_and_b32_dpp v18, v32, v10 row_newbcast:7 row_mask:0xf bank_mask:0xf
    v_and_b32_dpp v19, v32, v11 row_newbcast:7 row_mask:0xf bank_mask:0xf
    v_mfma_f32_16x16x32_bf16 v[28:31], v[12:15], v[152:155], v[28:31]
    s_cbranch_vccnz Lw270
    s_waitcnt vmcnt(4)
Lw270:
    s_waitcnt vmcnt(6)
    buffer_load_dwordx4 v[184:187], v5, s[12:15], s43 offen offset:2048 nt
    v_and_b32_dpp v12, v32, v8 row_newbcast:8 row_mask:0xf bank_mask:0xf
    v_and_b32_dpp v13, v32, v9 row_newbcast:8 row_mask:0xf bank_mask:0xf
    v_and_b32_dpp v14, v32, v10 row_newbcast:8 row_mask:0xf bank_mask:0xf
    v_and_b32_dpp v15, v32, v11 row_newbcast:8 row_mask:0xf bank_mask:0xf
    v_mfma_f32_16x16x32_bf16 v[28:31], v[16:19], v[156:159], v[28:31]
    s_cbranch_vccnz Lw271
    s_waitcnt vmcnt(4)
Lw271:
    s_waitcnt vmcnt(6)
    buffer_load_dwordx4 v[188:191], v5, s[12:15], s43 offen offset:3072 nt
    v_mov_b32 v59, 66
    ds_write_b32 v60, v59 offset:22528
    v_and_b32_dpp v16, v32, v8 row_newbcast:9 row_mask:0xf bank_mask:0xf
    v_and_b32_dpp v17, v32, v9 row_newbcast:9 row_mask:0xf bank_mask:0xf
    v_and_b32_dpp v18, v32, v10 row_newbcast:9 row_mask:0xf bank_mask:0xf
    v_and_b32_dpp v19, v32, v11 row_newbcast:9 row_mask:0xf bank_mask:0xf
    v_mfma_f32_16x16x32_bf16 v[28:31], v[12:15], v[160:163], v[28:31]
    s_cbranch_vccnz Lw272
    s_waitcnt vmcnt(4)
Lw272:
    s_waitcnt vmcnt(6)
    s_add_u32 s43, s42, 65536
    s_and_b32 s43, s43, 0xfffff
    buffer_load_dwordx4 v[192:195], v5, s[12:15], s43 offen offset:0 nt
    v_and_b32_dpp v12, v32, v8 row_newbcast:10 row_mask:0xf bank_mask:0xf
    v_and_b32_dpp v13, v32, v9 row_newbcast:10 row_mask:0xf bank_mask:0xf
    v_and_b32_dpp v14, v32, v10 row_newbcast:10 row_mask:0xf bank_mask:0xf
    v_and_b32_dpp v15, v32, v11 row_newbcast:10 row_mask:0xf bank_mask:0xf
    v_mfma_f32_16x16x32_bf16 v[28:31], v[16:19], v[164:167], v[28:31]
    s_cbranch_vccnz Lw273
    s_waitcnt vmcnt(4)
Lw273:
    s_waitcnt vmcnt(6)
    buffer_load_dwordx4 v[196:199], v5, s[12:15], s43 offen offset:1024 nt
    ds_read_b32 v61, v62 offset:22544
    v_and_b32_dpp v16, v32, v8 row_newbcast:11 row_mask:0xf bank_mask:0xf
    v_and_b32_dpp v17, v32, v9 row_newbcast:11 row_mask:0xf bank_mask:0xf
    v_and_b32_dpp v18, v32, v10 row_newbcast:11 row_mask:0xf bank_mask:0xf
    v_and_b32_dpp v19, v32, v11 row_newbcast:11 row_mask:0xf bank_mask:0xf
    v_mfma_f32_16x16x32_bf16 v[28:31], v[12:15], v[168:171], v[28:31]
    s_cbranch_vccnz Lw274
    s_waitcnt vmcnt(4)
Lw274:
    s_waitcnt vmcnt(6)
    buffer_load_dwordx4 v[200:203], v5, s[12:15], s43 offen offset:2048 nt
    v_and_b32_dpp v12, v32, v8 row_newbcast:12 row_mask:0xf bank_mask:0xf
    v_and_b32_dpp v13, v32, v9 row_newbcast:12 row_mask:0xf bank_mask:0xf
    v_and_b32_dpp v14, v32, v10 row_newbcast:12 row_mask:0xf bank_mask:0xf
    v_and_b32_dpp v15, v32, v11 row_newbcast:12 row_mask:0xf bank_mask:0xf
    v_mfma_f32_16x16x32_bf16 v[28:31], v[16:19], v[172:175], v[28:31]
    s_cbranch_vccnz Lw275
    s_waitcnt vmcnt(4)
Lw275:
    s_waitcnt vmcnt(6)
    buffer_load_dwordx4 v[204:207], v5, s[12:15], s43 offen offset:3072 nt
    v_mov_b32 v59, 67
    ds_write_b32 v60, v59 offset:22528
    v_and_b32_dpp v16, v32, v8 row_newbcast:13 row_mask:0xf bank_mask:0xf
    v_and_b32_dpp v17, v32, v9 row_newbcast:13 row_mask:0xf bank_mask:0xf
    v_and_b32_dpp v18, v32, v10 row_newbcast:13 row_mask:0xf bank_mask:0xf
    v_and_b32_dpp v19, v32, v11 row_newbcast:13 row_mask:0xf bank_mask:0xf
    v_mfma_f32_16x16x32_bf16 v[28:31], v[12:15], v[176:179], v[28:31]
    s_cbranch_vccnz Lw276
    s_waitcnt vmcnt(4)
Lw276:
    s_waitcnt vmcnt(6)
    s_add_u32 s43, s42, 69632
    s_and_b32 s43, s43, 0xfffff
    buffer_load_dwordx4 v[208:211], v5, s[12:15], s43 offen offset:0 nt
    v_and_b32_dpp v12, v32, v8 row_newbcast:14 row_mask:0xf bank_mask:0xf
    v_and_b32_dpp v13, v32, v9 row_newbcast:14 row_mask:0xf bank_mask:0xf
    v_and_b32_dpp v14, v32, v10 row_newbcast:14 row_mask:0xf bank_mask:0xf
    v_and_b32_dpp v15, v32, v11 row_newbcast:14 row_mask:0xf bank_mask:0xf
    v_mfma_f32_16x16x32_bf16 v[28:31], v[16:19], v[180:183], v[28:31]
    s_cbranch_vccnz Lw277
    s_waitcnt vmcnt(4)
Lw277:
    s_waitcnt vmcnt(6)
    buffer_load_dwordx4 v[212:215], v5, s[12:15], s43 offen offset:1024 nt
    s_waitcnt lgkmcnt(0)
    v_readfirstlane_b32 s67, v61
    s_cmp_lg_u32 s67, 0
    s_cselect_b64 vcc, -1, 0
    v_and_b32_dpp v16, v32, v8 row_newbcast:15 row_mask:0xf bank_mask:0xf
    v_and_b32_dpp v17, v32, v9 row_newbcast:15 row_mask:0xf bank_mask:0xf
    v_and_b32_dpp v18, v32, v10 row_newbcast:15 row_mask:0xf bank_mask:0xf
    v_and_b32_dpp v19, v32, v11 row_newbcast:15 row_mask:0xf bank_mask:0xf
    v_mfma_f32_16x16x32_bf16 v[28:31], v[12:15], v[184:187], v[28:31]
    s_cbranch_vccnz Lw278
    s_waitcnt vmcnt(4)
Lw278:
    s_waitcnt vmcnt(6)
    buffer_load_dwordx4 v[216:219], v5, s[12:15], s43 offen offset:2048 nt
    v_and_b32_dpp v12, v33, v8 row_newbcast:0 row_mask:0xf bank_mask:0xf
    v_and_b32_dpp v13, v33, v9 row_newbcast:0 row_mask:0xf bank_mask:0xf
    v_and_b32_dpp v14, v33, v10 row_newbcast:0 row_mask:0xf bank_mask:0xf
    v_and_b32_dpp v15, v33, v11 row_newbcast:0 row_mask:0xf bank_mask:0xf
    v_mfma_f32_16x16x32_bf16 v[28:31], v[16:19], v[188:191], v[28:31]
    s_cbranch_vccnz Lw279
    s_waitcnt vmcnt(4)
Lw279:
    s_waitcnt vmcnt(6)
    buffer_load_dwordx4 v[220:223], v5, s[12:15], s43 offen offset:3072 nt
    v_mov_b32 v59, 68
    ds_write_b32 v60, v59 offset:22528
    v_and_b32_dpp v16, v33, v8 row_newbcast:1 row_mask:0xf bank_mask:0xf
    v_and_b32_dpp v17, v33, v9 row_newbcast:1 row_mask:0xf bank_mask:0xf
    v_and_b32_dpp v18, v33, v10 row_newbcast:1 row_mask:0xf bank_mask:0xf
    v_and_b32_dpp v19, v33, v11 row_newbcast:1 row_mask:0xf bank_mask:0xf
    v_mfma_f32_16x16x32_bf16 v[28:31], v[12:15], v[192:195], v[28:31]
    s_cbranch_vccnz Lw280
    s_waitcnt vmcnt(4)
Lw280:
    s_waitcnt vmcnt(6)
    s_add_u32 s43, s42, 98304
    s_and_b32 s43, s43, 0xfffff
    buffer_load_dwordx4 v[224:227], v5, s[12:15], s43 offen offset:0 nt
    v_and_b32_dpp v12, v33, v8 row_newbcast:2 row_mask:0xf bank_mask:0xf
    v_and_b32_dpp v13, v33, v9 row_newbcast:2 row_mask:0xf bank_mask:0xf
    v_and_b32_dpp v14, v33, v10 row_newbcast:2 row_mask:0xf bank_mask:0xf
    v_and_b32_dpp v15, v33, v11 row_newbcast:2 row_mask:0xf bank_mask:0xf
    v_mfma_f32_16x16x32_bf16 v[28:31], v[16:19], v[196:199], v[28:31]
    s_cbranch_vccnz Lw281
    s_waitcnt vmcnt(4)
Lw281:
    s_waitcnt vmcnt(6)
    buffer_load_dwordx4 v[228:231], v5, s[12:15], s43 offen offset:1024 nt
    ds_read_b32 v61, v62 offset:22544
    v_and_b32_dpp v16, v33, v8 row_newbcast:3 row_mask:0xf bank_mask:0xf
    v_and_b32_dpp v17, v33, v9 row_newbcast:3 row_mask:0xf bank_mask:0xf
    v_and_b32_dpp v18, v33, v10 row_newbcast:3 row_mask:0xf bank_mask:0xf
    v_and_b32_dpp v19, v33, v11 row_newbcast:3 row_mask:0xf bank_mask:0xf
    v_mfma_f32_16x16x32_bf16 v[28:31], v[12:15], v[200:203], v[28:31]
    s_cbranch_vccnz Lw282
    s_waitcnt vmcnt(4)
Lw282:
    s_waitcnt vmcnt(6)
    buffer_load_dwordx4 v[232:235], v5, s[12:15], s43 offen offset:2048 nt
    v_and_b32_dpp v12, v33, v8 row_newbcast:4 row_mask:0xf bank_mask:0xf
    v_and_b32_dpp v13, v33, v9 row_newbcast:4 row_mask:0xf bank_mask:0xf
    v_and_b32_dpp v14, v33, v10 row_newbcast:4 row_mask:0xf bank_mask:0xf
    v_and_b32_dpp v15, v33, v11 row_newbcast:4 row_mask:0xf bank_mask:0xf
    v_mfma_f32_16x16x32_bf16 v[28:31], v[16:19], v[204:207], v[28:31]
    s_cbranch_vccnz Lw283
    s_waitcnt vmcnt(4)
Lw283:
    s_waitcnt vmcnt(6)
    buffer_load_dwordx4 v[236:239], v5, s[12:15], s43 offen offset:3072 nt
    v_mov_b32 v59, 69
    ds_write_b32 v60, v59 offset:22528
    v_and_b32_dpp v16, v33, v8 row_newbcast:5 row_mask:0xf bank_mask:0xf
    v_and_b32_dpp v17, v33, v9 row_newbcast:5 row_mask:0xf bank_mask:0xf
    v_and_b32_dpp v18, v33, v10 row_newbcast:5 row_mask:0xf bank_mask:0xf
    v_and_b32_dpp v19, v33, v11 row_newbcast:5 row_mask:0xf bank_mask:0xf
    v_mfma_f32_16x16x32_bf16 v[28:31], v[12:15], v[208:211], v[28:31]
    v_sub_f32 v58, v34, v48
    v_mul_f32 v58, 0x3fb8aa3b, v58
    v_exp_f32 v58, v58
    s_nop 0
    v_add_f32 v49, v49, v58
    v_cvt_pk_bf16_f32 v34, v58, v58
    s_cbranch_vccnz Lw284
    s_waitcnt vmcnt(4)
Lw284:
    s_waitcnt vmcnt(6)
    s_add_u32 s43, s42, 102400
    s_and_b32 s43, s43, 0xfffff
    buffer_load_dwordx4 v[240:243], v5, s[12:15], s43 offen offset:0 nt
    v_and_b32_dpp v12, v33, v8 row_newbcast:6 row_mask:0xf bank_mask:0xf
    v_and_b32_dpp v13, v33, v9 row_newbcast:6 row_mask:0xf bank_mask:0xf
    v_and_b32_dpp v14, v33, v10 row_newbcast:6 row_mask:0xf bank_mask:0xf
    v_and_b32_dpp v15, v33, v11 row_newbcast:6 row_mask:0xf bank_mask:0xf
    v_mfma_f32_16x16x32_bf16 v[28:31], v[16:19], v[212:215], v[28:31]
    s_cbranch_vccnz Lw285
    s_waitcnt vmcnt(4)
Lw285:
    s_waitcnt vmcnt(6)
    buffer_load_dwordx4 v[244:247], v5, s[12:15], s43 offen offset:1024 nt
    s_waitcnt lgkmcnt(0)
    v_readfirstlane_b32 s67, v61
    s_cmp_lg_u32 s67, 0
    s_cselect_b64 vcc, -1, 0
    v_and_b32_dpp v16, v33, v8 row_newbcast:7 row_mask:0xf bank_mask:0xf
    v_and_b32_dpp v17, v33, v9 row_newbcast:7 row_mask:0xf bank_mask:0xf
    v_and_b32_dpp v18, v33, v10 row_newbcast:7 row_mask:0xf bank_mask:0xf
    v_and_b32_dpp v19, v33, v11 row_newbcast:7 row_mask:0xf bank_mask:0xf
    v_mfma_f32_16x16x32_bf16 v[28:31], v[12:15], v[216:219], v[28:31]
    s_cbranch_vccnz Lw286
    s_waitcnt vmcnt(4)
Lw286:
    s_waitcnt vmcnt(6)
    buffer_load_dwordx4 v[248:251], v5, s[12:15], s43 offen offset:2048 nt
    v_and_b32_dpp v12, v33, v8 row_newbcast:8 row_mask:0xf bank_mask:0xf
    v_and_b32_dpp v13, v33, v9 row_newbcast:8 row_mask:0xf bank_mask:0xf
    v_and_b32_dpp v14, v33, v10 row_newbcast:8 row_mask:0xf bank_mask:0xf
    v_and_b32_dpp v15, v33, v11 row_newbcast:8 row_mask:0xf bank_mask:0xf
    v_mfma_f32_16x16x32_bf16 v[28:31], v[16:19], v[220:223], v[28:31]
    s_cbranch_vccnz Lw287
    s_waitcnt vmcnt(4)
Lw287:
    s_waitcnt vmcnt(6)
    buffer_load_dwordx4 v[252:255], v5, s[12:15], s43 offen offset:3072 nt
    v_mov_b32 v59, 70
    ds_write_b32 v60, v59 offset:22528
    v_and_b32_dpp v16, v33, v8 row_newbcast:9 row_mask:0xf bank_mask:0xf
    v_and_b32_dpp v17, v33, v9 row_newbcast:9 row_mask:0xf bank_mask:0xf
    v_and_b32_dpp v18, v33, v10 row_newbcast:9 row_mask:0xf bank_mask:0xf
    v_and_b32_dpp v19, v33, v11 row_newbcast:9 row_mask:0xf bank_mask:0xf
    v_mfma_f32_16x16x32_bf16 v[28:31], v[12:15], v[224:227], v[28:31]
    s_cbranch_vccnz Lw288
    s_waitcnt vmcnt(4)
Lw288:
    s_waitcnt vmcnt(6)
    s_add_u32 s43, s42, 131072
    s_and_b32 s43, s43, 0xfffff
    buffer_load_dwordx4 v[128:131], v5, s[12:15], s43 offen offset:0 nt
    v_and_b32_dpp v12, v33, v8 row_newbcast:10 row_mask:0xf bank_mask:0xf
    v_and_b32_dpp v13, v33, v9 row_newbcast:10 row_mask:0xf bank_mask:0xf
    v_and_b32_dpp v14, v33, v10 row_newbcast:10 row_mask:0xf bank_mask:0xf
    v_and_b32_dpp v15, v33, v11 row_newbcast:10 row_mask:0xf bank_mask:0xf
    v_mfma_f32_16x16x32_bf16 v[28:31], v[16:19], v[228:231], v[28:31]
    s_cbranch_vccnz Lw289
    s_waitcnt vmcnt(4)
Lw289:
    s_waitcnt vmcnt(6)
    buffer_load_dwordx4 v[132:135], v5, s[12:15], s43 offen offset:1024 nt
    ds_read_b32 v61, v62 offset:22544
    v_and_b32_dpp v16, v33, v8 row_newbcast:11 row_mask:0xf bank_mask:0xf
    v_and_b32_dpp v17, v33, v9 row_newbcast:11 row_mask:0xf bank_mask:0xf
    v_and_b32_dpp v18, v33, v10 row_newbcast:11 row_mask:0xf bank_mask:0xf
    v_and_b32_dpp v19, v33, v11 row_newbcast:11 row_mask:0xf bank_mask:0xf
    v_mfma_f32_16x16x32_bf16 v[28:31], v[12:15], v[232:235], v[28:31]
    s_cbranch_vccnz Lw290
    s_waitcnt vmcnt(4)
Lw290:
    s_waitcnt vmcnt(6)
    buffer_load_dwordx4 v[136:139], v5, s[12:15], s43 offen offset:2048 nt
    v_and_b32_dpp v12, v33, v8 row_newbcast:12 row_mask:0xf bank_mask:0xf
    v_and_b32_dpp v13, v33, v9 row_newbcast:12 row_mask:0xf bank_mask:0xf
    v_and_b32_dpp v14, v33, v10 row_newbcast:12 row_mask:0xf bank_mask:0xf
    v_and_b32_dpp v15, v33, v11 row_newbcast:12 row_mask:0xf bank_mask:0xf
    v_mfma_f32_16x16x32_bf16 v[28:31], v[16:19], v[236:239], v[28:31]
    s_cbranch_vccnz Lw291
    s_waitcnt vmcnt(4)
Lw291:
    s_waitcnt vmcnt(6)
    buffer_load_dwordx4 v[140:143], v5, s[12:15], s43 offen offset:3072 nt
    v_mov_b32 v59, 71
    ds_write_b32 v60, v59 offset:22528
    v_and_b32_dpp v16, v33, v8 row_newbcast:13 row_mask:0xf bank_mask:0xf
    v_and_b32_dpp v17, v33, v9 row_newbcast:13 row_mask:0xf bank_mask:0xf
    v_and_b32_dpp v18, v33, v10 row_newbcast:13 row_mask:0xf bank_mask:0xf
    v_and_b32_dpp v19, v33, v11 row_newbcast:13 row_mask:0xf bank_mask:0xf
    v_mfma_f32_16x16x32_bf16 v[28:31], v[12:15], v[240:243], v[28:31]
    s_cbranch_vccnz Lw292
    s_waitcnt vmcnt(4)
Lw292:
    s_waitcnt vmcnt(6)
    s_add_u32 s43, s42, 135168
    s_and_b32 s43, s43, 0xfffff
    buffer_load_dwordx4 v[144:147], v5, s[12:15], s43 offen offset:0 nt
    v_and_b32_dpp v12, v33, v8 row_newbcast:14 row_mask:0xf bank_mask:0xf
    v_and_b32_dpp v13, v33, v9 row_newbcast:14 row_mask:0xf bank_mask:0xf
    v_and_b32_dpp v14, v33, v10 row_newbcast:14 row_mask:0xf bank_mask:0xf
    v_and_b32_dpp v15, v33, v11 row_newbcast:14 row_mask:0xf bank_mask:0xf
    v_mfma_f32_16x16x32_bf16 v[28:31], v[16:19], v[244:247], v[28:31]
    s_cbranch_vccnz Lw293
    s_waitcnt vmcnt(4)
Lw293:
    s_waitcnt vmcnt(6)
    buffer_load_dwordx4 v[148:151], v5, s[12:15], s43 offen offset:1024 nt
    s_waitcnt lgkmcnt(0)
    v_readfirstlane_b32 s67, v61
    s_cmp_lg_u32 s67, 0
    s_cselect_b64 vcc, -1, 0
    v_and_b32_dpp v16, v33, v8 row_newbcast:15 row_mask:0xf bank_mask:0xf
    v_and_b32_dpp v17, v33, v9 row_newbcast:15 row_mask:0xf bank_mask:0xf
    v_and_b32_dpp v18, v33, v10 row_newbcast:15 row_mask:0xf bank_mask:0xf
    v_and_b32_dpp v19, v33, v11 row_newbcast:15 row_mask:0xf bank_mask:0xf
    v_mfma_f32_16x16x32_bf16 v[28:31], v[12:15], v[248:251], v[28:31]
    s_cbranch_vccnz Lw294
    s_waitcnt vmcnt(4)
Lw294:
    s_waitcnt vmcnt(6)
    buffer_load_dwordx4 v[152:155], v5, s[12:15], s43 offen offset:2048 nt
    v_and_b32_dpp v12, v34, v8 row_newbcast:0 row_mask:0xf bank_mask:0xf
    v_and_b32_dpp v13, v34, v9 row_newbcast:0 row_mask:0xf bank_mask:0xf
    v_and_b32_dpp v14, v34, v10 row_newbcast:0 row_mask:0xf bank_mask:0xf
    v_and_b32_dpp v15, v34, v11 row_newbcast:0 row_mask:0xf bank_mask:0xf
    v_mfma_f32_16x16x32_bf16 v[28:31], v[16:19], v[252:255], v[28:31]
    s_cbranch_vccnz Lw295
    s_waitcnt vmcnt(4)
Lw295:
    s_waitcnt vmcnt(6)
    buffer_load_dwordx4 v[156:159], v5, s[12:15], s43 offen offset:3072 nt
    v_mov_b32 v59, 72
    ds_write_b32 v60, v59 offset:22528
    v_and_b32_dpp v16, v34, v8 row_newbcast:1 row_mask:0xf bank_mask:0xf
    v_and_b32_dpp v17, v34, v9 row_newbcast:1 row_mask:0xf bank_mask:0xf
    v_and_b32_dpp v18, v34, v10 row_newbcast:1 row_mask:0xf bank_mask:0xf
    v_and_b32_dpp v19, v34, v11 row_newbcast:1 row_mask:0xf bank_mask:0xf
    v_mfma_f32_16x16x32_bf16 v[28:31], v[12:15], v[128:131], v[28:31]
    s_cbranch_vccnz Lw296
    s_waitcnt vmcnt(4)
Lw296:
    s_waitcnt vmcnt(6)
    s_add_u32 s43, s42, 163840
    s_and_b32 s43, s43, 0xfffff
    buffer_load_dwordx4 v[160:163], v5, s[12:15], s43 offen offset:0 nt
    v_and_b32_dpp v12, v34, v8 row_newbcast:2 row_mask:0xf bank_mask:0xf
    v_and_b32_dpp v13, v34, v9 row_newbcast:2 row_mask:0xf bank_mask:0xf
    v_and_b32_dpp v14, v34, v10 row_newbcast:2 row_mask:0xf bank_mask:0xf
    v_and_b32_dpp v15, v34, v11 row_newbcast:2 row_mask:0xf bank_mask:0xf
    v_mfma_f32_16x16x32_bf16 v[28:31], v[16:19], v[132:135], v[28:31]
    s_cbranch_vccnz Lw297
    s_waitcnt vmcnt(4)
Lw297:
    s_waitcnt vmcnt(6)
    buffer_load_dwordx4 v[164:167], v5, s[12:15], s43 offen offset:1024 nt
    ds_read_b32 v61, v62 offset:22544
    v_and_b32_dpp v16, v34, v8 row_newbcast:3 row_mask:0xf bank_mask:0xf
    v_and_b32_dpp v17, v34, v9 row_newbcast:3 row_mask:0xf bank_mask:0xf
    v_and_b32_dpp v18, v34, v10 row_newbcast:3 row_mask:0xf bank_mask:0xf
    v_and_b32_dpp v19, v34, v11 row_newbcast:3 row_mask:0xf bank_mask:0xf
    v_mfma_f32_16x16x32_bf16 v[28:31], v[12:15], v[136:139], v[28:31]
    s_cbranch_vccnz Lw298
    s_waitcnt vmcnt(4)
Lw298:
    s_waitcnt vmcnt(6)
    buffer_load_dwordx4 v[168:171], v5, s[12:15], s43 offen offset:2048 nt
    v_and_b32_dpp v12, v34, v8 row_newbcast:4 row_mask:0xf bank_mask:0xf
    v_and_b32_dpp v13, v34, v9 row_newbcast:4 row_mask:0xf bank_mask:0xf
    v_and_b32_dpp v14, v34, v10 row_newbcast:4 row_mask:0xf bank_mask:0xf
    v_and_b32_dpp v15, v34, v11 row_newbcast:4 row_mask:0xf bank_mask:0xf
    v_mfma_f32_16x16x32_bf16 v[28:31], v[16:19], v[140:143], v[28:31]
    s_cbranch_vccnz Lw299
    s_waitcnt vmcnt(4)
Lw299:
    s_waitcnt vmcnt(6)
    buffer_load_dwordx4 v[172:175], v5, s[12:15], s43 offen offset:3072 nt
    v_mov_b32 v59, 73
    ds_write_b32 v60, v59 offset:22528
    v_and_b32_dpp v16, v34, v8 row_newbcast:5 row_mask:0xf bank_mask:0xf
    v_and_b32_dpp v17, v34, v9 row_newbcast:5 row_mask:0xf bank_mask:0xf
    v_and_b32_dpp v18, v34, v10 row_newbcast:5 row_mask:0xf bank_mask:0xf
    v_and_b32_dpp v19, v34, v11 row_newbcast:5 row_mask:0xf bank_mask:0xf
    v_mfma_f32_16x16x32_bf16 v[28:31], v[12:15], v[144:147], v[28:31]
    v_sub_f32 v58, v35, v48
    v_mul_f32 v58, 0x3fb8aa3b, v58
    v_exp_f32 v58, v58
    s_nop 0
    v_add_f32 v49, v49, v58
    v_cvt_pk_bf16_f32 v35, v58, v58
    s_cbranch_vccnz Lw300
    s_waitcnt vmcnt(4)
Lw300:
    s_waitcnt vmcnt(6)
    s_add_u32 s43, s42, 167936
    s_and_b32 s43, s43, 0xfffff
    buffer_load_dwordx4 v[176:179], v5, s[12:15], s43 offen offset:0 nt
    v_and_b32_dpp v12, v34, v8 row_newbcast:6 row_mask:0xf bank_mask:0xf
    v_and_b32_dpp v13, v34, v9 row_newbcast:6 row_mask:0xf bank_mask:0xf
    v_and_b32_dpp v14, v34, v10 row_newbcast:6 row_mask:0xf bank_mask:0xf
    v_and_b32_dpp v15, v34, v11 row_newbcast:6 row_mask:0xf bank_mask:0xf
    v_mfma_f32_16x16x32_bf16 v[28:31], v[16:19], v[148:151], v[28:31]
    s_cbranch_vccnz Lw301
    s_waitcnt vmcnt(4)
Lw301:
    s_waitcnt vmcnt(6)
    buffer_load_dwordx4 v[180:183], v5, s[12:15], s43 offen offset:1024 nt
    s_waitcnt lgkmcnt(0)
    v_readfirstlane_b32 s67, v61
    s_cmp_lg_u32 s67, 0
    s_cselect_b64 vcc, -1, 0
    v_and_b32_dpp v16, v34, v8 row_newbcast:7 row_mask:0xf bank_mask:0xf
    v_and_b32_dpp v17, v34, v9 row_newbcast:7 row_mask:0xf bank_mask:0xf
    v_and_b32_dpp v18, v34, v10 row_newbcast:7 row_mask:0xf bank_mask:0xf
    v_and_b32_dpp v19, v34, v11 row_newbcast:7 row_mask:0xf bank_mask:0xf
    v_mfma_f32_16x16x32_bf16 v[28:31], v[12:15], v[152:155], v[28:31]
    s_cbranch_vccnz Lw302
    s_waitcnt vmcnt(4)
Lw302:
    s_waitcnt vmcnt(6)
    buffer_load_dwordx4 v[184:187], v5, s[12:15], s43 offen offset:2048 nt
    v_and_b32_dpp v12, v34, v8 row_newbcast:8 row_mask:0xf bank_mask:0xf
    v_and_b32_dpp v13, v34, v9 row_newbcast:8 row_mask:0xf bank_mask:0xf
    v_and_b32_dpp v14, v34, v10 row_newbcast:8 row_mask:0xf bank_mask:0xf
    v_and_b32_dpp v15, v34, v11 row_newbcast:8 row_mask:0xf bank_mask:0xf
    v_mfma_f32_16x16x32_bf16 v[28:31], v[16:19], v[156:159], v[28:31]
    s_cbranch_vccnz Lw303
    s_waitcnt vmcnt(4)
Lw303:
    s_waitcnt vmcnt(6)
    buffer_load_dwordx4 v[188:191], v5, s[12:15], s43 offen offset:3072 nt
    v_mov_b32 v59, 74
    ds_write_b32 v60, v59 offset:22528
    v_and_b32_dpp v16, v34, v8 row_newbcast:9 row_mask:0xf bank_mask:0xf
    v_and_b32_dpp v17, v34, v9 row_newbcast:9 row_mask:0xf bank_mask:0xf
    v_and_b32_dpp v18, v34, v10 row_newbcast:9 row_mask:0xf bank_mask:0xf
    v_and_b32_dpp v19, v34, v11 row_newbcast:9 row_mask:0xf bank_mask:0xf
    v_mfma_f32_16x16x32_bf16 v[28:31], v[12:15], v[160:163], v[28:31]
    s_cbranch_vccnz Lw304
    s_waitcnt vmcnt(4)
Lw304:
    s_waitcnt vmcnt(6)
    s_add_u32 s43, s42, 196608
    s_and_b32 s43, s43, 0xfffff
    buffer_load_dwordx4 v[192:195], v5, s[12:15], s43 offen offset:0 nt
    v_and_b32_dpp v12, v34, v8 row_newbcast:10 row_mask:0xf bank_mask:0xf
    v_and_b32_dpp v13, v34, v9 row_newbcast:10 row_mask:0xf bank_mask:0xf
    v_and_b32_dpp v14, v34, v10 row_newbcast:10 row_mask:0xf bank_mask:0xf
    v_and_b32_dpp v15, v34, v11 row_newbcast:10 row_mask:0xf bank_mask:0xf
    v_mfma_f32_16x16x32_bf16 v[28:31], v[16:19], v[164:167], v[28:31]
    s_cbranch_vccnz Lw305
    s_waitcnt vmcnt(4)
Lw305:
    s_waitcnt vmcnt(6)
    buffer_load_dwordx4 v[196:199], v5, s[12:15], s43 offen offset:1024 nt
    ds_read_b32 v61, v62 offset:22544
    v_and_b32_dpp v16, v34, v8 row_newbcast:11 row_mask:0xf bank_mask:0xf
    v_and_b32_dpp v17, v34, v9 row_newbcast:11 row_mask:0xf bank_mask:0xf
    v_and_b32_dpp v18, v34, v10 row_newbcast:11 row_mask:0xf bank_mask:0xf
    v_and_b32_dpp v19, v34, v11 row_newbcast:11 row_mask:0xf bank_mask:0xf
    v_mfma_f32_16x16x32_bf16 v[28:31], v[12:15], v[168:171], v[28:31]
    s_cbranch_vccnz Lw306
    s_waitcnt vmcnt(4)
Lw306:
    s_waitcnt vmcnt(6)
    buffer_load_dwordx4 v[200:203], v5, s[12:15], s43 offen offset:2048 nt
    v_and_b32_dpp v12, v34, v8 row_newbcast:12 row_mask:0xf bank_mask:0xf
    v_and_b32_dpp v13, v34, v9 row_newbcast:12 row_mask:0xf bank_mask:0xf
    v_and_b32_dpp v14, v34, v10 row_newbcast:12 row_mask:0xf bank_mask:0xf
    v_and_b32_dpp v15, v34, v11 row_newbcast:12 row_mask:0xf bank_mask:0xf
    v_mfma_f32_16x16x32_bf16 v[28:31], v[16:19], v[172:175], v[28:31]
    s_cbranch_vccnz Lw307
    s_waitcnt vmcnt(4)
Lw307:
    s_waitcnt vmcnt(6)
    buffer_load_dwordx4 v[204:207], v5, s[12:15], s43 offen offset:3072 nt
    v_mov_b32 v59, 75
    ds_write_b32 v60, v59 offset:22528
    v_and_b32_dpp v16, v34, v8 row_newbcast:13 row_mask:0xf bank_mask:0xf
    v_and_b32_dpp v17, v34, v9 row_newbcast:13 row_mask:0xf bank_mask:0xf
    v_and_b32_dpp v18, v34, v10 row_newbcast:13 row_mask:0xf bank_mask:0xf
    v_and_b32_dpp v19, v34, v11 row_newbcast:13 row_mask:0xf bank_mask:0xf
    v_mfma_f32_16x16x32_bf16 v[28:31], v[12:15], v[176:179], v[28:31]
    s_cbranch_vccnz Lw308
    s_waitcnt vmcnt(4)
Lw308:
    s_waitcnt vmcnt(6)
    s_add_u32 s43, s42, 200704
    s_and_b32 s43, s43, 0xfffff
    buffer_load_dwordx4 v[208:211], v5, s[12:15], s43 offen offset:0 nt
    v_and_b32_dpp v12, v34, v8 row_newbcast:14 row_mask:0xf bank_mask:0xf
    v_and_b32_dpp v13, v34, v9 row_newbcast:14 row_mask:0xf bank_mask:0xf
    v_and_b32_dpp v14, v34, v10 row_newbcast:14 row_mask:0xf bank_mask:0xf
    v_and_b32_dpp v15, v34, v11 row_newbcast:14 row_mask:0xf bank_mask:0xf
    v_mfma_f32_16x16x32_bf16 v[28:31], v[16:19], v[180:183], v[28:31]
    s_cbranch_vccnz Lw309
    s_waitcnt vmcnt(4)
Lw309:
    s_waitcnt vmcnt(6)
    buffer_load_dwordx4 v[212:215], v5, s[12:15], s43 offen offset:1024 nt
    s_waitcnt lgkmcnt(0)
    v_readfirstlane_b32 s67, v61
    s_cmp_lg_u32 s67, 0
    s_cselect_b64 vcc, -1, 0
    v_and_b32_dpp v16, v34, v8 row_newbcast:15 row_mask:0xf bank_mask:0xf
    v_and_b32_dpp v17, v34, v9 row_newbcast:15 row_mask:0xf bank_mask:0xf
    v_and_b32_dpp v18, v34, v10 row_newbcast:15 row_mask:0xf bank_mask:0xf
    v_and_b32_dpp v19, v34, v11 row_newbcast:15 row_mask:0xf bank_mask:0xf
    v_mfma_f32_16x16x32_bf16 v[28:31], v[12:15], v[184:187], v[28:31]
    s_cbranch_vccnz Lw310
    s_waitcnt vmcnt(4)
Lw310:
    s_waitcnt vmcnt(6)
    buffer_load_dwordx4 v[216:219], v5, s[12:15], s43 offen offset:2048 nt
    v_and_b32_dpp v12, v35, v8 row_newbcast:0 row_mask:0xf bank_mask:0xf
    v_and_b32_dpp v13, v35, v9 row_newbcast:0 row_mask:0xf bank_mask:0xf
    v_and_b32_dpp v14, v35, v10 row_newbcast:0 row_mask:0xf bank_mask:0xf
    v_and_b32_dpp v15, v35, v11 row_newbcast:0 row_mask:0xf bank_mask:0xf
    v_mfma_f32_16x16x32_bf16 v[28:31], v[16:19], v[188:191], v[28:31]
    s_cbranch_vccnz Lw311
    s_waitcnt vmcnt(4)
Lw311:
    s_waitcnt vmcnt(6)
    buffer_load_dwordx4 v[220:223], v5, s[12:15], s43 offen offset:3072 nt
    v_mov_b32 v59, 76
    ds_write_b32 v60, v59 offset:22528
    v_and_b32_dpp v16, v35, v8 row_newbcast:1 row_mask:0xf bank_mask:0xf
    v_and_b32_dpp v17, v35, v9 row_newbcast:1 row_mask:0xf bank_mask:0xf
    v_and_b32_dpp v18, v35, v10 row_newbcast:1 row_mask:0xf bank_mask:0xf
    v_and_b32_dpp v19, v35, v11 row_newbcast:1 row_mask:0xf bank_mask:0xf
    v_mfma_f32_16x16x32_bf16 v[28:31], v[12:15], v[192:195], v[28:31]
    s_cbranch_vccnz Lw312
    s_waitcnt vmcnt(4)
Lw312:
    s_waitcnt vmcnt(6)
    s_add_u32 s43, s42, 229376
    s_and_b32 s43, s43, 0xfffff
    buffer_load_dwordx4 v[224:227], v5, s[12:15], s43 offen offset:0 nt
    v_and_b32_dpp v12, v35, v8 row_newbcast:2 row_mask:0xf bank_mask:0xf
    v_and_b32_dpp v13, v35, v9 row_newbcast:2 row_mask:0xf bank_mask:0xf
    v_and_b32_dpp v14, v35, v10 row_newbcast:2 row_mask:0xf bank_mask:0xf
    v_and_b32_dpp v15, v35, v11 row_newbcast:2 row_mask:0xf bank_mask:0xf
    v_mfma_f32_16x16x32_bf16 v[28:31], v[16:19], v[196:199], v[28:31]
    s_cbranch_vccnz Lw313
    s_waitcnt vmcnt(4)
Lw313:
    s_waitcnt vmcnt(6)
    buffer_load_dwordx4 v[228:231], v5, s[12:15], s43 offen offset:1024 nt
    ds_read_b32 v61, v62 offset:22544
    v_and_b32_dpp v16, v35, v8 row_newbcast:3 row_mask:0xf bank_mask:0xf
    v_and_b32_dpp v17, v35, v9 row_newbcast:3 row_mask:0xf bank_mask:0xf
    v_and_b32_dpp v18, v35, v10 row_newbcast:3 row_mask:0xf bank_mask:0xf
    v_and_b32_dpp v19, v35, v11 row_newbcast:3 row_mask:0xf bank_mask:0xf
    v_mfma_f32_16x16x32_bf16 v[28:31], v[12:15], v[200:203], v[28:31]
    s_cbranch_vccnz Lw314
    s_waitcnt vmcnt(4)
Lw314:
    s_waitcnt vmcnt(6)
    buffer_load_dwordx4 v[232:235], v5, s[12:15], s43 offen offset:2048 nt
    v_and_b32_dpp v12, v35, v8 row_newbcast:4 row_mask:0xf bank_mask:0xf
    v_and_b32_dpp v13, v35, v9 row_newbcast:4 row_mask:0xf bank_mask:0xf
    v_and_b32_dpp v14, v35, v10 row_newbcast:4 row_mask:0xf bank_mask:0xf
    v_and_b32_dpp v15, v35, v11 row_newbcast:4 row_mask:0xf bank_mask:0xf
    v_mfma_f32_16x16x32_bf16 v[28:31], v[16:19], v[204:207], v[28:31]
    s_cbranch_vccnz Lw315
    s_waitcnt vmcnt(4)
Lw315:
    s_waitcnt vmcnt(6)
    buffer_load_dwordx4 v[236:239], v5, s[12:15], s43 offen offset:3072 nt
    v_mov_b32 v59, 77
    ds_write_b32 v60, v59 offset:22528
    v_and_b32_dpp v16, v35, v8 row_newbcast:5 row_mask:0xf bank_mask:0xf
    v_and_b32_dpp v17, v35, v9 row_newbcast:5 row_mask:0xf bank_mask:0xf
    v_and_b32_dpp v18, v35, v10 row_newbcast:5 row_mask:0xf bank_mask:0xf
    v_and_b32_dpp v19, v35, v11 row_newbcast:5 row_mask:0xf bank_mask:0xf
    v_mfma_f32_16x16x32_bf16 v[28:31], v[12:15], v[208:211], v[28:31]
    v_sub_f32 v58, v36, v48
    v_mul_f32 v58, 0x3fb8aa3b, v58
    v_exp_f32 v58, v58
    s_nop 0
    v_add_f32 v49, v49, v58
    v_cvt_pk_bf16_f32 v36, v58, v58
    s_cbranch_vccnz Lw316
    s_waitcnt vmcnt(4)
Lw316:
    s_waitcnt vmcnt(6)
    s_add_u32 s43, s42, 233472
    s_and_b32 s43, s43, 0xfffff
    buffer_load_dwordx4 v[240:243], v5, s[12:15], s43 offen offset:0 nt
    v_and_b32_dpp v12, v35, v8 row_newbcast:6 row_mask:0xf bank_mask:0xf
    v_and_b32_dpp v13, v35, v9 row_newbcast:6 row_mask:0xf bank_mask:0xf
    v_and_b32_dpp v14, v35, v10 row_newbcast:6 row_mask:0xf bank_mask:0xf
    v_and_b32_dpp v15, v35, v11 row_newbcast:6 row_mask:0xf bank_mask:0xf
    v_mfma_f32_16x16x32_bf16 v[28:31], v[16:19], v[212:215], v[28:31]
    s_cbranch_vccnz Lw317
    s_waitcnt vmcnt(4)
Lw317:
    s_waitcnt vmcnt(6)
    buffer_load_dwordx4 v[244:247], v5, s[12:15], s43 offen offset:1024 nt
    s_waitcnt lgkmcnt(0)
    v_readfirstlane_b32 s67, v61
    s_cmp_lg_u32 s67, 0
    s_cselect_b64 vcc, -1, 0
    v_and_b32_dpp v16, v35, v8 row_newbcast:7 row_mask:0xf bank_mask:0xf
    v_and_b32_dpp v17, v35, v9 row_newbcast:7 row_mask:0xf bank_mask:0xf
    v_and_b32_dpp v18, v35, v10 row_newbcast:7 row_mask:0xf bank_mask:0xf
    v_and_b32_dpp v19, v35, v11 row_newbcast:7 row_mask:0xf bank_mask:0xf
    v_mfma_f32_16x16x32_bf16 v[28:31], v[12:15], v[216:219], v[28:31]
    s_cbranch_vccnz Lw318
    s_waitcnt vmcnt(4)
Lw318:
    s_waitcnt vmcnt(6)
    buffer_load_dwordx4 v[248:251], v5, s[12:15], s43 offen offset:2048 nt
    v_and_b32_dpp v12, v35, v8 row_newbcast:8 row_mask:0xf bank_mask:0xf
    v_and_b32_dpp v13, v35, v9 row_newbcast:8 row_mask:0xf bank_mask:0xf
    v_and_b32_dpp v14, v35, v10 row_newbcast:8 row_mask:0xf bank_mask:0xf
    v_and_b32_dpp v15, v35, v11 row_newbcast:8 row_mask:0xf bank_mask:0xf
    v_mfma_f32_16x16x32_bf16 v[28:31], v[16:19], v[220:223], v[28:31]
    s_cbranch_vccnz Lw319
    s_waitcnt vmcnt(4)
Lw319:
    s_waitcnt vmcnt(6)
    buffer_load_dwordx4 v[252:255], v5, s[12:15], s43 offen offset:3072 nt
    v_mov_b32 v59, 78
    ds_write_b32 v60, v59 offset:22528
    v_and_b32_dpp v16, v35, v8 row_newbcast:9 row_mask:0xf bank_mask:0xf
    v_and_b32_dpp v17, v35, v9 row_newbcast:9 row_mask:0xf bank_mask:0xf
    v_and_b32_dpp v18, v35, v10 row_newbcast:9 row_mask:0xf bank_mask:0xf
    v_and_b32_dpp v19, v35, v11 row_newbcast:9 row_mask:0xf bank_mask:0xf
    v_mfma_f32_16x16x32_bf16 v[28:31], v[12:15], v[224:227], v[28:31]
    s_cbranch_vccnz Lw320
    s_waitcnt vmcnt(4)
Lw320:
    s_waitcnt vmcnt(6)
    s_add_u32 s43, s42, 262144
    s_and_b32 s43, s43, 0xfffff
    buffer_load_dwordx4 v[128:131], v5, s[12:15], s43 offen offset:0 nt
    v_and_b32_dpp v12, v35, v8 row_newbcast:10 row_mask:0xf bank_mask:0xf
    v_and_b32_dpp v13, v35, v9 row_newbcast:10 row_mask:0xf bank_mask:0xf
    v_and_b32_dpp v14, v35, v10 row_newbcast:10 row_mask:0xf bank_mask:0xf
    v_and_b32_dpp v15, v35, v11 row_newbcast:10 row_mask:0xf bank_mask:0xf
    v_mfma_f32_16x16x32_bf16 v[28:31], v[16:19], v[228:231], v[28:31]
    s_cbranch_vccnz Lw321
    s_waitcnt vmcnt(4)
Lw321:
    s_waitcnt vmcnt(6)
    buffer_load_dwordx4 v[132:135], v5, s[12:15], s43 offen offset:1024 nt
    ds_read_b32 v61, v62 offset:22544
    v_and_b32_dpp v16, v35, v8 row_newbcast:11 row_mask:0xf bank_mask:0xf
    v_and_b32_dpp v17, v35, v9 row_newbcast:11 row_mask:0xf bank_mask:0xf
    v_and_b32_dpp v18, v35, v10 row_newbcast:11 row_mask:0xf bank_mask:0xf
    v_and_b32_dpp v19, v35, v11 row_newbcast:11 row_mask:0xf bank_mask:0xf
    v_mfma_f32_16x16x32_bf16 v[28:31], v[12:15], v[232:235], v[28:31]
    s_cbranch_vccnz Lw322
    s_waitcnt vmcnt(4)
Lw322:
    s_waitcnt vmcnt(6)
    buffer_load_dwordx4 v[136:139], v5, s[12:15], s43 offen offset:2048 nt
    v_and_b32_dpp v12, v35, v8 row_newbcast:12 row_mask:0xf bank_mask:0xf
    v_and_b32_dpp v13, v35, v9 row_newbcast:12 row_mask:0xf bank_mask:0xf
    v_and_b32_dpp v14, v35, v10 row_newbcast:12 row_mask:0xf bank_mask:0xf
    v_and_b32_dpp v15, v35, v11 row_newbcast:12 row_mask:0xf bank_mask:0xf
    v_mfma_f32_16x16x32_bf16 v[28:31], v[16:19], v[236:239], v[28:31]
    s_cbranch_vccnz Lw323
    s_waitcnt vmcnt(4)
Lw323:
    s_waitcnt vmcnt(6)
    buffer_load_dwordx4 v[140:143], v5, s[12:15], s43 offen offset:3072 nt
    v_mov_b32 v59, 79
    ds_write_b32 v60, v59 offset:22528
    v_and_b32_dpp v16, v35, v8 row_newbcast:13 row_mask:0xf bank_mask:0xf
    v_and_b32_dpp v17, v35, v9 row_newbcast:13 row_mask:0xf bank_mask:0xf
    v_and_b32_dpp v18, v35, v10 row_newbcast:13 row_mask:0xf bank_mask:0xf
    v_and_b32_dpp v19, v35, v11 row_newbcast:13 row_mask:0xf bank_mask:0xf
    v_mfma_f32_16x16x32_bf16 v[28:31], v[12:15], v[240:243], v[28:31]
    s_cbranch_vccnz Lw324
    s_waitcnt vmcnt(4)
Lw324:
    s_waitcnt vmcnt(6)
    s_add_u32 s43, s42, 266240
    s_and_b32 s43, s43, 0xfffff
    buffer_load_dwordx4 v[144:147], v5, s[12:15], s43 offen offset:0 nt
    v_and_b32_dpp v12, v35, v8 row_newbcast:14 row_mask:0xf bank_mask:0xf
    v_and_b32_dpp v13, v35, v9 row_newbcast:14 row_mask:0xf bank_mask:0xf
    v_and_b32_dpp v14, v35, v10 row_newbcast:14 row_mask:0xf bank_mask:0xf
    v_and_b32_dpp v15, v35, v11 row_newbcast:14 row_mask:0xf bank_mask:0xf
    v_mfma_f32_16x16x32_bf16 v[28:31], v[16:19], v[244:247], v[28:31]
    s_cbranch_vccnz Lw325
    s_waitcnt vmcnt(4)
Lw325:
    s_waitcnt vmcnt(6)
    buffer_load_dwordx4 v[148:151], v5, s[12:15], s43 offen offset:1024 nt
    s_waitcnt lgkmcnt(0)
    v_readfirstlane_b32 s67, v61
    s_cmp_lg_u32 s67, 0
    s_cselect_b64 vcc, -1, 0
    v_and_b32_dpp v16, v35, v8 row_newbcast:15 row_mask:0xf bank_mask:0xf
    v_and_b32_dpp v17, v35, v9 row_newbcast:15 row_mask:0xf bank_mask:0xf
    v_and_b32_dpp v18, v35, v10 row_newbcast:15 row_mask:0xf bank_mask:0xf
    v_and_b32_dpp v19, v35, v11 row_newbcast:15 row_mask:0xf bank_mask:0xf
    v_mfma_f32_16x16x32_bf16 v[28:31], v[12:15], v[248:251], v[28:31]
    s_cbranch_vccnz Lw326
    s_waitcnt vmcnt(4)
Lw326:
    s_waitcnt vmcnt(6)
    buffer_load_dwordx4 v[152:155], v5, s[12:15], s43 offen offset:2048 nt
    v_and_b32_dpp v12, v36, v8 row_newbcast:0 row_mask:0xf bank_mask:0xf
    v_and_b32_dpp v13, v36, v9 row_newbcast:0 row_mask:0xf bank_mask:0xf
    v_and_b32_dpp v14, v36, v10 row_newbcast:0 row_mask:0xf bank_mask:0xf
    v_and_b32_dpp v15, v36, v11 row_newbcast:0 row_mask:0xf bank_mask:0xf
    v_mfma_f32_16x16x32_bf16 v[28:31], v[16:19], v[252:255], v[28:31]
    s_cbranch_vccnz Lw327
    s_waitcnt vmcnt(4)
Lw327:
    s_waitcnt vmcnt(6)
    buffer_load_dwordx4 v[156:159], v5, s[12:15], s43 offen offset:3072 nt
    v_mov_b32 v59, 80
    ds_write_b32 v60, v59 offset:22528
    v_and_b32_dpp v16, v36, v8 row_newbcast:1 row_mask:0xf bank_mask:0xf
    v_and_b32_dpp v17, v36, v9 row_newbcast:1 row_mask:0xf bank_mask:0xf
    v_and_b32_dpp v18, v36, v10 row_newbcast:1 row_mask:0xf bank_mask:0xf
    v_and_b32_dpp v19, v36, v11 row_newbcast:1 row_mask:0xf bank_mask:0xf
    v_mfma_f32_16x16x32_bf16 v[28:31], v[12:15], v[128:131], v[28:31]
    s_cbranch_vccnz Lw328
    s_waitcnt vmcnt(4)
Lw328:
    s_waitcnt vmcnt(6)
    s_add_u32 s43, s42, 294912
    s_and_b32 s43, s43, 0xfffff
    buffer_load_dwordx4 v[160:163], v5, s[12:15], s43 offen offset:0 nt
    v_and_b32_dpp v12, v36, v8 row_newbcast:2 row_mask:0xf bank_mask:0xf
    v_and_b32_dpp v13, v36, v9 row_newbcast:2 row_mask:0xf bank_mask:0xf
    v_and_b32_dpp v14, v36, v10 row_newbcast:2 row_mask:0xf bank_mask:0xf
    v_and_b32_dpp v15, v36, v11 row_newbcast:2 row_mask:0xf bank_mask:0xf
    v_mfma_f32_16x16x32_bf16 v[28:31], v[16:19], v[132:135], v[28:31]
    s_cbranch_vccnz Lw329
    s_waitcnt vmcnt(4)
Lw329:
    s_waitcnt vmcnt(6)
    buffer_load_dwordx4 v[164:167], v5, s[12:15], s43 offen offset:1024 nt
    ds_read_b32 v61, v62 offset:22544
    v_and_b32_dpp v16, v36, v8 row_newbcast:3 row_mask:0xf bank_mask:0xf
    v_and_b32_dpp v17, v36, v9 row_newbcast:3 row_mask:0xf bank_mask:0xf
    v_and_b32_dpp v18, v36, v10 row_newbcast:3 row_mask:0xf bank_mask:0xf
    v_and_b32_dpp v19, v36, v11 row_newbcast:3 row_mask:0xf bank_mask:0xf
    v_mfma_f32_16x16x32_bf16 v[28:31], v[12:15], v[136:139], v[28:31]
    s_cbranch_vccnz Lw330
    s_waitcnt vmcnt(4)
Lw330:
    s_waitcnt vmcnt(6)
    buffer_load_dwordx4 v[168:171], v5, s[12:15], s43 offen offset:2048 nt
    v_and_b32_dpp v12, v36, v8 row_newbcast:4 row_mask:0xf bank_mask:0xf
    v_and_b32_dpp v13, v36, v9 row_newbcast:4 row_mask:0xf bank_mask:0xf
    v_and_b32_dpp v14, v36, v10 row_newbcast:4 row_mask:0xf bank_mask:0xf
    v_and_b32_dpp v15, v36, v11 row_newbcast:4 row_mask:0xf bank_mask:0xf
    v_mfma_f32_16x16x32_bf16 v[28:31], v[16:19], v[140:143], v[28:31]
    s_cbranch_vccnz Lw331
    s_waitcnt vmcnt(4)
Lw331:
    s_waitcnt vmcnt(6)
    buffer_load_dwordx4 v[172:175], v5, s[12:15], s43 offen offset:3072 nt
    v_mov_b32 v59, 81
    ds_write_b32 v60, v59 offset:22528
    v_and_b32_dpp v16, v36, v8 row_newbcast:5 row_mask:0xf bank_mask:0xf
    v_and_b32_dpp v17, v36, v9 row_newbcast:5 row_mask:0xf bank_mask:0xf
    v_and_b32_dpp v18, v36, v10 row_newbcast:5 row_mask:0xf bank_mask:0xf
    v_and_b32_dpp v19, v36, v11 row_newbcast:5 row_mask:0xf bank_mask:0xf
    v_mfma_f32_16x16x32_bf16 v[28:31], v[12:15], v[144:147], v[28:31]
    v_sub_f32 v58, v37, v48
    v_mul_f32 v58, 0x3fb8aa3b, v58
    v_exp_f32 v58, v58
    s_nop 0
    v_add_f32 v49, v49, v58
    v_cvt_pk_bf16_f32 v37, v58, v58
    s_cbranch_vccnz Lw332
    s_waitcnt vmcnt(4)
Lw332:
    s_waitcnt vmcnt(6)
    s_add_u32 s43, s42, 299008
    s_and_b32 s43, s43, 0xfffff
    buffer_load_dwordx4 v[176:179], v5, s[12:15], s43 offen offset:0 nt
    v_and_b32_dpp v12, v36, v8 row_newbcast:6 row_mask:0xf bank_mask:0xf
    v_and_b32_dpp v13, v36, v9 row_newbcast:6 row_mask:0xf bank_mask:0xf
    v_and_b32_dpp v14, v36, v10 row_newbcast:6 row_mask:0xf bank_mask:0xf
    v_and_b32_dpp v15, v36, v11 row_newbcast:6 row_mask:0xf bank_mask:0xf
    v_mfma_f32_16x16x32_bf16 v[28:31], v[16:19], v[148:151], v[28:31]
    s_cbranch_vccnz Lw333
    s_waitcnt vmcnt(4)
Lw333:
    s_waitcnt vmcnt(6)
    buffer_load_dwordx4 v[180:183], v5, s[12:15], s43 offen offset:1024 nt
    s_waitcnt lgkmcnt(0)
    v_readfirstlane_b32 s67, v61
    s_cmp_lg_u32 s67, 0
    s_cselect_b64 vcc, -1, 0
    v_and_b32_dpp v16, v36, v8 row_newbcast:7 row_mask:0xf bank_mask:0xf
    v_and_b32_dpp v17, v36, v9 row_newbcast:7 row_mask:0xf bank_mask:0xf
    v_and_b32_dpp v18, v36, v10 row_newbcast:7 row_mask:0xf bank_mask:0xf
    v_and_b32_dpp v19, v36, v11 row_newbcast:7 row_mask:0xf bank_mask:0xf
    v_mfma_f32_16x16x32_bf16 v[28:31], v[12:15], v[152:155], v[28:31]
    s_cbranch_vccnz Lw334
    s_waitcnt vmcnt(4)
Lw334:
    s_waitcnt vmcnt(6)
    buffer_load_dwordx4 v[184:187], v5, s[12:15], s43 offen offset:2048 nt
    v_and_b32_dpp v12, v36, v8 row_newbcast:8 row_mask:0xf bank_mask:0xf
    v_and_b32_dpp v13, v36, v9 row_newbcast:8 row_mask:0xf bank_mask:0xf
    v_and_b32_dpp v14, v36, v10 row_newbcast:8 row_mask:0xf bank_mask:0xf
    v_and_b32_dpp v15, v36, v11 row_newbcast:8 row_mask:0xf bank_mask:0xf
    v_mfma_f32_16x16x32_bf16 v[28:31], v[16:19], v[156:159], v[28:31]
    s_cbranch_vccnz Lw335
    s_waitcnt vmcnt(4)
Lw335:
    s_waitcnt vmcnt(6)
    buffer_load_dwordx4 v[188:191], v5, s[12:15], s43 offen offset:3072 nt
    v_mov_b32 v59, 82
    ds_write_b32 v60, v59 offset:22528
    v_and_b32_dpp v16, v36, v8 row_newbcast:9 row_mask:0xf bank_mask:0xf
    v_and_b32_dpp v17, v36, v9 row_newbcast:9 row_mask:0xf bank_mask:0xf
    v_and_b32_dpp v18, v36, v10 row_newbcast:9 row_mask:0xf bank_mask:0xf
    v_and_b32_dpp v19, v36, v11 row_newbcast:9 row_mask:0xf bank_mask:0xf
    v_mfma_f32_16x16x32_bf16 v[28:31], v[12:15], v[160:163], v[28:31]
    s_cbranch_vccnz Lw336
    s_waitcnt vmcnt(4)
Lw336:
    s_waitcnt vmcnt(6)
    s_add_u32 s43, s42, 327680
    s_and_b32 s43, s43, 0xfffff
    buffer_load_dwordx4 v[192:195], v5, s[12:15], s43 offen offset:0 nt
    v_and_b32_dpp v12, v36, v8 row_newbcast:10 row_mask:0xf bank_mask:0xf
    v_and_b32_dpp v13, v36, v9 row_newbcast:10 row_mask:0xf bank_mask:0xf
    v_and_b32_dpp v14, v36, v10 row_newbcast:10 row_mask:0xf bank_mask:0xf
    v_and_b32_dpp v15, v36, v11 row_newbcast:10 row_mask:0xf bank_mask:0xf
    v_mfma_f32_16x16x32_bf16 v[28:31], v[16:19], v[164:167], v[28:31]
    s_cbranch_vccnz Lw337
    s_waitcnt vmcnt(4)
Lw337:
    s_waitcnt vmcnt(6)
    buffer_load_dwordx4 v[196:199], v5, s[12:15], s43 offen offset:1024 nt
    ds_read_b32 v61, v62 offset:22544
    v_and_b32_dpp v16, v36, v8 row_newbcast:11 row_mask:0xf bank_mask:0xf
    v_and_b32_dpp v17, v36, v9 row_newbcast:11 row_mask:0xf bank_mask:0xf
    v_and_b32_dpp v18, v36, v10 row_newbcast:11 row_mask:0xf bank_mask:0xf
    v_and_b32_dpp v19, v36, v11 row_newbcast:11 row_mask:0xf bank_mask:0xf
    v_mfma_f32_16x16x32_bf16 v[28:31], v[12:15], v[168:171], v[28:31]
    s_cbranch_vccnz Lw338
    s_waitcnt vmcnt(4)
Lw338:
    s_waitcnt vmcnt(6)
    buffer_load_dwordx4 v[200:203], v5, s[12:15], s43 offen offset:2048 nt
    v_and_b32_dpp v12, v36, v8 row_newbcast:12 row_mask:0xf bank_mask:0xf
    v_and_b32_dpp v13, v36, v9 row_newbcast:12 row_mask:0xf bank_mask:0xf
    v_and_b32_dpp v14, v36, v10 row_newbcast:12 row_mask:0xf bank_mask:0xf
    v_and_b32_dpp v15, v36, v11 row_newbcast:12 row_mask:0xf bank_mask:0xf
    v_mfma_f32_16x16x32_bf16 v[28:31], v[16:19], v[172:175], v[28:31]
    s_cbranch_vccnz Lw339
    s_waitcnt vmcnt(4)
Lw339:
    s_waitcnt vmcnt(6)
    buffer_load_dwordx4 v[204:207], v5, s[12:15], s43 offen offset:3072 nt
    v_mov_b32 v59, 83
    ds_write_b32 v60, v59 offset:22528
    v_and_b32_dpp v16, v36, v8 row_newbcast:13 row_mask:0xf bank_mask:0xf
    v_and_b32_dpp v17, v36, v9 row_newbcast:13 row_mask:0xf bank_mask:0xf
    v_and_b32_dpp v18, v36, v10 row_newbcast:13 row_mask:0xf bank_mask:0xf
    v_and_b32_dpp v19, v36, v11 row_newbcast:13 row_mask:0xf bank_mask:0xf
    v_mfma_f32_16x16x32_bf16 v[28:31], v[12:15], v[176:179], v[28:31]
    s_cbranch_vccnz Lw340
    s_waitcnt vmcnt(4)
Lw340:
    s_waitcnt vmcnt(6)
    s_add_u32 s43, s42, 331776
    s_and_b32 s43, s43, 0xfffff
    buffer_load_dwordx4 v[208:211], v5, s[12:15], s43 offen offset:0 nt
    v_and_b32_dpp v12, v36, v8 row_newbcast:14 row_mask:0xf bank_mask:0xf
    v_and_b32_dpp v13, v36, v9 row_newbcast:14 row_mask:0xf bank_mask:0xf
    v_and_b32_dpp v14, v36, v10 row_newbcast:14 row_mask:0xf bank_mask:0xf
    v_and_b32_dpp v15, v36, v11 row_newbcast:14 row_mask:0xf bank_mask:0xf
    v_mfma_f32_16x16x32_bf16 v[28:31], v[16:19], v[180:183], v[28:31]
    s_cbranch_vccnz Lw341
    s_waitcnt vmcnt(4)
Lw341:
    s_waitcnt vmcnt(6)
    buffer_load_dwordx4 v[212:215], v5, s[12:15], s43 offen offset:1024 nt
    s_waitcnt lgkmcnt(0)
    v_readfirstlane_b32 s67, v61
    s_cmp_lg_u32 s67, 0
    s_cselect_b64 vcc, -1, 0
    v_and_b32_dpp v16, v36, v8 row_newbcast:15 row_mask:0xf bank_mask:0xf
    v_and_b32_dpp v17, v36, v9 row_newbcast:15 row_mask:0xf bank_mask:0xf
    v_and_b32_dpp v18, v36, v10 row_newbcast:15 row_mask:0xf bank_mask:0xf
    v_and_b32_dpp v19, v36, v11 row_newbcast:15 row_mask:0xf bank_mask:0xf
    v_mfma_f32_16x16x32_bf16 v[28:31], v[12:15], v[184:187], v[28:31]
    s_cbranch_vccnz Lw342
    s_waitcnt vmcnt(4)
Lw342:
    s_waitcnt vmcnt(6)
    buffer_load_dwordx4 v[216:219], v5, s[12:15], s43 offen offset:2048 nt
    v_and_b32_dpp v12, v37, v8 row_newbcast:0 row_mask:0xf bank_mask:0xf
    v_and_b32_dpp v13, v37, v9 row_newbcast:0 row_mask:0xf bank_mask:0xf
    v_and_b32_dpp v14, v37, v10 row_newbcast:0 row_mask:0xf bank_mask:0xf
    v_and_b32_dpp v15, v37, v11 row_newbcast:0 row_mask:0xf bank_mask:0xf
    v_mfma_f32_16x16x32_bf16 v[28:31], v[16:19], v[188:191], v[28:31]
    s_cbranch_vccnz Lw343
    s_waitcnt vmcnt(4)
Lw343:
    s_waitcnt vmcnt(6)
    buffer_load_dwordx4 v[220:223], v5, s[12:15], s43 offen offset:3072 nt
    v_mov_b32 v59, 84
    ds_write_b32 v60, v59 offset:22528
    v_and_b32_dpp v16, v37, v8 row_newbcast:1 row_mask:0xf bank_mask:0xf
    v_and_b32_dpp v17, v37, v9 row_newbcast:1 row_mask:0xf bank_mask:0xf
    v_and_b32_dpp v18, v37, v10 row_newbcast:1 row_mask:0xf bank_mask:0xf
    v_and_b32_dpp v19, v37, v11 row_newbcast:1 row_mask:0xf bank_mask:0xf
    v_mfma_f32_16x16x32_bf16 v[28:31], v[12:15], v[192:195], v[28:31]
    s_cbranch_vccnz Lw344
    s_waitcnt vmcnt(4)
Lw344:
    s_waitcnt vmcnt(6)
    s_add_u32 s43, s42, 360448
    s_and_b32 s43, s43, 0xfffff
    buffer_load_dwordx4 v[224:227], v5, s[12:15], s43 offen offset:0 nt
    v_and_b32_dpp v12, v37, v8 row_newbcast:2 row_mask:0xf bank_mask:0xf
    v_and_b32_dpp v13, v37, v9 row_newbcast:2 row_mask:0xf bank_mask:0xf
    v_and_b32_dpp v14, v37, v10 row_newbcast:2 row_mask:0xf bank_mask:0xf
    v_and_b32_dpp v15, v37, v11 row_newbcast:2 row_mask:0xf bank_mask:0xf
    v_mfma_f32_16x16x32_bf16 v[28:31], v[16:19], v[196:199], v[28:31]
    s_cbranch_vccnz Lw345
    s_waitcnt vmcnt(4)
Lw345:
    s_waitcnt vmcnt(6)
    buffer_load_dwordx4 v[228:231], v5, s[12:15], s43 offen offset:1024 nt
    ds_read_b32 v61, v62 offset:22544
    v_and_b32_dpp v16, v37, v8 row_newbcast:3 row_mask:0xf bank_mask:0xf
    v_and_b32_dpp v17, v37, v9 row_newbcast:3 row_mask:0xf bank_mask:0xf
    v_and_b32_dpp v18, v37, v10 row_newbcast:3 row_mask:0xf bank_mask:0xf
    v_and_b32_dpp v19, v37, v11 row_newbcast:3 row_mask:0xf bank_mask:0xf
    v_mfma_f32_16x16x32_bf16 v[28:31], v[12:15], v[200:203], v[28:31]
    s_cbranch_vccnz Lw346
    s_waitcnt vmcnt(4)
Lw346:
    s_waitcnt vmcnt(6)
    buffer_load_dwordx4 v[232:235], v5, s[12:15], s43 offen offset:2048 nt
    v_and_b32_dpp v12, v37, v8 row_newbcast:4 row_mask:0xf bank_mask:0xf
    v_and_b32_dpp v13, v37, v9 row_newbcast:4 row_mask:0xf bank_mask:0xf
    v_and_b32_dpp v14, v37, v10 row_newbcast:4 row_mask:0xf bank_mask:0xf
    v_and_b32_dpp v15, v37, v11 row_newbcast:4 row_mask:0xf bank_mask:0xf
    v_mfma_f32_16x16x32_bf16 v[28:31], v[16:19], v[204:207], v[28:31]
    s_cbranch_vccnz Lw347
    s_waitcnt vmcnt(4)
Lw347:
    s_waitcnt vmcnt(6)
    buffer_load_dwordx4 v[236:239], v5, s[12:15], s43 offen offset:3072 nt
    v_mov_b32 v59, 85
    ds_write_b32 v60, v59 offset:22528
    v_and_b32_dpp v16, v37, v8 row_newbcast:5 row_mask:0xf bank_mask:0xf
    v_and_b32_dpp v17, v37, v9 row_newbcast:5 row_mask:0xf bank_mask:0xf
    v_and_b32_dpp v18, v37, v10 row_newbcast:5 row_mask:0xf bank_mask:0xf
    v_and_b32_dpp v19, v37, v11 row_newbcast:5 row_mask:0xf bank_mask:0xf
    v_mfma_f32_16x16x32_bf16 v[28:31], v[12:15], v[208:211], v[28:31]
    v_sub_f32 v58, v38, v48
    v_mul_f32 v58, 0x3fb8aa3b, v58
    v_exp_f32 v58, v58
    s_nop 0
    v_add_f32 v49, v49, v58
    v_cvt_pk_bf16_f32 v38, v58, v58
    s_cbranch_vccnz Lw348
    s_waitcnt vmcnt(4)
Lw348:
    s_waitcnt vmcnt(6)
    s_add_u32 s43, s42, 364544
    s_and_b32 s43, s43, 0xfffff
    buffer_load_dwordx4 v[240:243], v5, s[12:15], s43 offen offset:0 nt
    v_and_b32_dpp v12, v37, v8 row_newbcast:6 row_mask:0xf bank_mask:0xf
    v_and_b32_dpp v13, v37, v9 row_newbcast:6 row_mask:0xf bank_mask:0xf
    v_and_b32_dpp v14, v37, v10 row_newbcast:6 row_mask:0xf bank_mask:0xf
    v_and_b32_dpp v15, v37, v11 row_newbcast:6 row_mask:0xf bank_mask:0xf
    v_mfma_f32_16x16x32_bf16 v[28:31], v[16:19], v[212:215], v[28:31]
    s_cbranch_vccnz Lw349
    s_waitcnt vmcnt(4)
Lw349:
    s_waitcnt vmcnt(6)
    buffer_load_dwordx4 v[244:247], v5, s[12:15], s43 offen offset:1024 nt
    s_waitcnt lgkmcnt(0)
    v_readfirstlane_b32 s67, v61
    s_cmp_lg_u32 s67, 0
    s_cselect_b64 vcc, -1, 0
    v_and_b32_dpp v16, v37, v8 row_newbcast:7 row_mask:0xf bank_mask:0xf
    v_and_b32_dpp v17, v37, v9 row_newbcast:7 row_mask:0xf bank_mask:0xf
    v_and_b32_dpp v18, v37, v10 row_newbcast:7 row_mask:0xf bank_mask:0xf
    v_and_b32_dpp v19, v37, v11 row_newbcast:7 row_mask:0xf bank_mask:0xf
    v_mfma_f32_16x16x32_bf16 v[28:31], v[12:15], v[216:219], v[28:31]
    s_cbranch_vccnz Lw350
    s_waitcnt vmcnt(4)
Lw350:
    s_waitcnt vmcnt(6)
    buffer_load_dwordx4 v[248:251], v5, s[12:15], s43 offen offset:2048 nt
    v_and_b32_dpp v12, v37, v8 row_newbcast:8 row_mask:0xf bank_mask:0xf
    v_and_b32_dpp v13, v37, v9 row_newbcast:8 row_mask:0xf bank_mask:0xf
    v_and_b32_dpp v14, v37, v10 row_newbcast:8 row_mask:0xf bank_mask:0xf
    v_and_b32_dpp v15, v37, v11 row_newbcast:8 row_mask:0xf bank_mask:0xf
    v_mfma_f32_16x16x32_bf16 v[28:31], v[16:19], v[220:223], v[28:31]
    s_cbranch_vccnz Lw351
    s_waitcnt vmcnt(4)
Lw351:
    s_waitcnt vmcnt(6)
    buffer_load_dwordx4 v[252:255], v5, s[12:15], s43 offen offset:3072 nt
    v_mov_b32 v59, 86
    ds_write_b32 v60, v59 offset:22528
    v_and_b32_dpp v16, v37, v8 row_newbcast:9 row_mask:0xf bank_mask:0xf
    v_and_b32_dpp v17, v37, v9 row_newbcast:9 row_mask:0xf bank_mask:0xf
    v_and_b32_dpp v18, v37, v10 row_newbcast:9 row_mask:0xf bank_mask:0xf
    v_and_b32_dpp v19, v37, v11 row_newbcast:9 row_mask:0xf bank_mask:0xf
    v_mfma_f32_16x16x32_bf16 v[28:31], v[12:15], v[224:227], v[28:31]
    s_cbranch_vccnz Lw352
    s_waitcnt vmcnt(4)
Lw352:
    s_waitcnt vmcnt(6)
    s_add_u32 s43, s42, 393216
    s_and_b32 s43, s43, 0xfffff
    buffer_load_dwordx4 v[128:131], v5, s[12:15], s43 offen offset:0 nt
    v_and_b32_dpp v12, v37, v8 row_newbcast:10 row_mask:0xf bank_mask:0xf
    v_and_b32_dpp v13, v37, v9 row_newbcast:10 row_mask:0xf bank_mask:0xf
    v_and_b32_dpp v14, v37, v10 row_newbcast:10 row_mask:0xf bank_mask:0xf
    v_and_b32_dpp v15, v37, v11 row_newbcast:10 row_mask:0xf bank_mask:0xf
    v_mfma_f32_16x16x32_bf16 v[28:31], v[16:19], v[228:231], v[28:31]
    s_cbranch_vccnz Lw353
    s_waitcnt vmcnt(4)
Lw353:
    s_waitcnt vmcnt(6)
    buffer_load_dwordx4 v[132:135], v5, s[12:15], s43 offen offset:1024 nt
    ds_read_b32 v61, v62 offset:22544
    v_and_b32_dpp v16, v37, v8 row_newbcast:11 row_mask:0xf bank_mask:0xf
    v_and_b32_dpp v17, v37, v9 row_newbcast:11 row_mask:0xf bank_mask:0xf
    v_and_b32_dpp v18, v37, v10 row_newbcast:11 row_mask:0xf bank_mask:0xf
    v_and_b32_dpp v19, v37, v11 row_newbcast:11 row_mask:0xf bank_mask:0xf
    v_mfma_f32_16x16x32_bf16 v[28:31], v[12:15], v[232:235], v[28:31]
    s_cbranch_vccnz Lw354
    s_waitcnt vmcnt(4)
Lw354:
    s_waitcnt vmcnt(6)
    buffer_load_dwordx4 v[136:139], v5, s[12:15], s43 offen offset:2048 nt
    v_and_b32_dpp v12, v37, v8 row_newbcast:12 row_mask:0xf bank_mask:0xf
    v_and_b32_dpp v13, v37, v9 row_newbcast:12 row_mask:0xf bank_mask:0xf
    v_and_b32_dpp v14, v37, v10 row_newbcast:12 row_mask:0xf bank_mask:0xf
    v_and_b32_dpp v15, v37, v11 row_newbcast:12 row_mask:0xf bank_mask:0xf
    v_mfma_f32_16x16x32_bf16 v[28:31], v[16:19], v[236:239], v[28:31]
    s_cbranch_vccnz Lw355
    s_waitcnt vmcnt(4)
Lw355:
    s_waitcnt vmcnt(6)
    buffer_load_dwordx4 v[140:143], v5, s[12:15], s43 offen offset:3072 nt
    v_mov_b32 v59, 87
    ds_write_b32 v60, v59 offset:22528
    v_and_b32_dpp v16, v37, v8 row_newbcast:13 row_mask:0xf bank_mask:0xf
    v_and_b32_dpp v17, v37, v9 row_newbcast:13 row_mask:0xf bank_mask:0xf
    v_and_b32_dpp v18, v37, v10 row_newbcast:13 row_mask:0xf bank_mask:0xf
    v_and_b32_dpp v19, v37, v11 row_newbcast:13 row_mask:0xf bank_mask:0xf
    v_mfma_f32_16x16x32_bf16 v[28:31], v[12:15], v[240:243], v[28:31]
    s_cbranch_vccnz Lw356
    s_waitcnt vmcnt(4)
Lw356:
    s_waitcnt vmcnt(6)
    s_add_u32 s43, s42, 397312
    s_and_b32 s43, s43, 0xfffff
    buffer_load_dwordx4 v[144:147], v5, s[12:15], s43 offen offset:0 nt
    v_and_b32_dpp v12, v37, v8 row_newbcast:14 row_mask:0xf bank_mask:0xf
    v_and_b32_dpp v13, v37, v9 row_newbcast:14 row_mask:0xf bank_mask:0xf
    v_and_b32_dpp v14, v37, v10 row_newbcast:14 row_mask:0xf bank_mask:0xf
    v_and_b32_dpp v15, v37, v11 row_newbcast:14 row_mask:0xf bank_mask:0xf
    v_mfma_f32_16x16x32_bf16 v[28:31], v[16:19], v[244:247], v[28:31]
    s_cbranch_vccnz Lw357
    s_waitcnt vmcnt(4)
Lw357:
    s_waitcnt vmcnt(6)
    buffer_load_dwordx4 v[148:151], v5, s[12:15], s43 offen offset:1024 nt
    s_waitcnt lgkmcnt(0)
    v_readfirstlane_b32 s67, v61
    s_cmp_lg_u32 s67, 0
    s_cselect_b64 vcc, -1, 0
    v_and_b32_dpp v16, v37, v8 row_newbcast:15 row_mask:0xf bank_mask:0xf
    v_and_b32_dpp v17, v37, v9 row_newbcast:15 row_mask:0xf bank_mask:0xf
    v_and_b32_dpp v18, v37, v10 row_newbcast:15 row_mask:0xf bank_mask:0xf
    v_and_b32_dpp v19, v37, v11 row_newbcast:15 row_mask:0xf bank_mask:0xf
    v_mfma_f32_16x16x32_bf16 v[28:31], v[12:15], v[248:251], v[28:31]
    s_cbranch_vccnz Lw358
    s_waitcnt vmcnt(4)
Lw358:
    s_waitcnt vmcnt(6)
    buffer_load_dwordx4 v[152:155], v5, s[12:15], s43 offen offset:2048 nt
    v_and_b32_dpp v12, v38, v8 row_newbcast:0 row_mask:0xf bank_mask:0xf
    v_and_b32_dpp v13, v38, v9 row_newbcast:0 row_mask:0xf bank_mask:0xf
    v_and_b32_dpp v14, v38, v10 row_newbcast:0 row_mask:0xf bank_mask:0xf
    v_and_b32_dpp v15, v38, v11 row_newbcast:0 row_mask:0xf bank_mask:0xf
    v_mfma_f32_16x16x32_bf16 v[28:31], v[16:19], v[252:255], v[28:31]
    s_cbranch_vccnz Lw359
    s_waitcnt vmcnt(4)
Lw359:
    s_waitcnt vmcnt(6)
    buffer_load_dwordx4 v[156:159], v5, s[12:15], s43 offen offset:3072 nt
    v_mov_b32 v59, 88
    ds_write_b32 v60, v59 offset:22528
    v_and_b32_dpp v16, v38, v8 row_newbcast:1 row_mask:0xf bank_mask:0xf
    v_and_b32_dpp v17, v38, v9 row_newbcast:1 row_mask:0xf bank_mask:0xf
    v_and_b32_dpp v18, v38, v10 row_newbcast:1 row_mask:0xf bank_mask:0xf
    v_and_b32_dpp v19, v38, v11 row_newbcast:1 row_mask:0xf bank_mask:0xf
    v_mfma_f32_16x16x32_bf16 v[28:31], v[12:15], v[128:131], v[28:31]
    s_cbranch_vccnz Lw360
    s_waitcnt vmcnt(4)
Lw360:
    s_waitcnt vmcnt(6)
    s_add_u32 s43, s42, 425984
    s_and_b32 s43, s43, 0xfffff
    buffer_load_dwordx4 v[160:163], v5, s[12:15], s43 offen offset:0 nt
    v_and_b32_dpp v12, v38, v8 row_newbcast:2 row_mask:0xf bank_mask:0xf
    v_and_b32_dpp v13, v38, v9 row_newbcast:2 row_mask:0xf bank_mask:0xf
    v_and_b32_dpp v14, v38, v10 row_newbcast:2 row_mask:0xf bank_mask:0xf
    v_and_b32_dpp v15, v38, v11 row_newbcast:2 row_mask:0xf bank_mask:0xf
    v_mfma_f32_16x16x32_bf16 v[28:31], v[16:19], v[132:135], v[28:31]
    s_cbranch_vccnz Lw361
    s_waitcnt vmcnt(4)
Lw361:
    s_waitcnt vmcnt(6)
    buffer_load_dwordx4 v[164:167], v5, s[12:15], s43 offen offset:1024 nt
    ds_read_b32 v61, v62 offset:22544
    v_and_b32_dpp v16, v38, v8 row_newbcast:3 row_mask:0xf bank_mask:0xf
    v_and_b32_dpp v17, v38, v9 row_newbcast:3 row_mask:0xf bank_mask:0xf
    v_and_b32_dpp v18, v38, v10 row_newbcast:3 row_mask:0xf bank_mask:0xf
    v_and_b32_dpp v19, v38, v11 row_newbcast:3 row_mask:0xf bank_mask:0xf
    v_mfma_f32_16x16x32_bf16 v[28:31], v[12:15], v[136:139], v[28:31]
    s_cbranch_vccnz Lw362
    s_waitcnt vmcnt(4)
Lw362:
    s_waitcnt vmcnt(6)
    buffer_load_dwordx4 v[168:171], v5, s[12:15], s43 offen offset:2048 nt
    v_and_b32_dpp v12, v38, v8 row_newbcast:4 row_mask:0xf bank_mask:0xf
    v_and_b32_dpp v13, v38, v9 row_newbcast:4 row_mask:0xf bank_mask:0xf
    v_and_b32_dpp v14, v38, v10 row_newbcast:4 row_mask:0xf bank_mask:0xf
    v_and_b32_dpp v15, v38, v11 row_newbcast:4 row_mask:0xf bank_mask:0xf
    v_mfma_f32_16x16x32_bf16 v[28:31], v[16:19], v[140:143], v[28:31]
    s_cbranch_vccnz Lw363
    s_waitcnt vmcnt(4)
Lw363:
    s_waitcnt vmcnt(6)
    buffer_load_dwordx4 v[172:175], v5, s[12:15], s43 offen offset:3072 nt
    v_mov_b32 v59, 89
    ds_write_b32 v60, v59 offset:22528
    v_and_b32_dpp v16, v38, v8 row_newbcast:5 row_mask:0xf bank_mask:0xf
    v_and_b32_dpp v17, v38, v9 row_newbcast:5 row_mask:0xf bank_mask:0xf
    v_and_b32_dpp v18, v38, v10 row_newbcast:5 row_mask:0xf bank_mask:0xf
    v_and_b32_dpp v19, v38, v11 row_newbcast:5 row_mask:0xf bank_mask:0xf
    v_mfma_f32_16x16x32_bf16 v[28:31], v[12:15], v[144:147], v[28:31]
    v_sub_f32 v58, v39, v48
    v_mul_f32 v58, 0x3fb8aa3b, v58
    v_exp_f32 v58, v58
    s_nop 0
    v_add_f32 v49, v49, v58
    v_cvt_pk_bf16_f32 v39, v58, v58
    s_cbranch_vccnz Lw364
    s_waitcnt vmcnt(4)
Lw364:
    s_waitcnt vmcnt(6)
    s_add_u32 s43, s42, 430080
    s_and_b32 s43, s43, 0xfffff
    buffer_load_dwordx4 v[176:179], v5, s[12:15], s43 offen offset:0 nt
    v_and_b32_dpp v12, v38, v8 row_newbcast:6 row_mask:0xf bank_mask:0xf
    v_and_b32_dpp v13, v38, v9 row_newbcast:6 row_mask:0xf bank_mask:0xf
    v_and_b32_dpp v14, v38, v10 row_newbcast:6 row_mask:0xf bank_mask:0xf
    v_and_b32_dpp v15, v38, v11 row_newbcast:6 row_mask:0xf bank_mask:0xf
    v_mfma_f32_16x16x32_bf16 v[28:31], v[16:19], v[148:151], v[28:31]
    s_cbranch_vccnz Lw365
    s_waitcnt vmcnt(4)
Lw365:
    s_waitcnt vmcnt(6)
    buffer_load_dwordx4 v[180:183], v5, s[12:15], s43 offen offset:1024 nt
    s_waitcnt lgkmcnt(0)
    v_readfirstlane_b32 s67, v61
    s_cmp_lg_u32 s67, 0
    s_cselect_b64 vcc, -1, 0
    v_and_b32_dpp v16, v38, v8 row_newbcast:7 row_mask:0xf bank_mask:0xf
    v_and_b32_dpp v17, v38, v9 row_newbcast:7 row_mask:0xf bank_mask:0xf
    v_and_b32_dpp v18, v38, v10 row_newbcast:7 row_mask:0xf bank_mask:0xf
    v_and_b32_dpp v19, v38, v11 row_newbcast:7 row_mask:0xf bank_mask:0xf
    v_mfma_f32_16x16x32_bf16 v[28:31], v[12:15], v[152:155], v[28:31]
    s_cbranch_vccnz Lw366
    s_waitcnt vmcnt(4)
Lw366:
    s_waitcnt vmcnt(6)
    buffer_load_dwordx4 v[184:187], v5, s[12:15], s43 offen offset:2048 nt
    v_and_b32_dpp v12, v38, v8 row_newbcast:8 row_mask:0xf bank_mask:0xf
    v_and_b32_dpp v13, v38, v9 row_newbcast:8 row_mask:0xf bank_mask:0xf
    v_and_b32_dpp v14, v38, v10 row_newbcast:8 row_mask:0xf bank_mask:0xf
    v_and_b32_dpp v15, v38, v11 row_newbcast:8 row_mask:0xf bank_mask:0xf
    v_mfma_f32_16x16x32_bf16 v[28:31], v[16:19], v[156:159], v[28:31]
    s_cbranch_vccnz Lw367
    s_waitcnt vmcnt(4)
Lw367:
    s_waitcnt vmcnt(6)
    buffer_load_dwordx4 v[188:191], v5, s[12:15], s43 offen offset:3072 nt
    v_mov_b32 v59, 90
    ds_write_b32 v60, v59 offset:22528
    v_and_b32_dpp v16, v38, v8 row_newbcast:9 row_mask:0xf bank_mask:0xf
    v_and_b32_dpp v17, v38, v9 row_newbcast:9 row_mask:0xf bank_mask:0xf
    v_and_b32_dpp v18, v38, v10 row_newbcast:9 row_mask:0xf bank_mask:0xf
    v_and_b32_dpp v19, v38, v11 row_newbcast:9 row_mask:0xf bank_mask:0xf
    v_mfma_f32_16x16x32_bf16 v[28:31], v[12:15], v[160:163], v[28:31]
    s_cbranch_vccnz Lw368
    s_waitcnt vmcnt(4)
Lw368:
    s_waitcnt vmcnt(6)
    s_add_u32 s43, s42, 458752
    s_and_b32 s43, s43, 0xfffff
    buffer_load_dwordx4 v[192:195], v5, s[12:15], s43 offen offset:0 nt
    v_and_b32_dpp v12, v38, v8 row_newbcast:10 row_mask:0xf bank_mask:0xf
    v_and_b32_dpp v13, v38, v9 row_newbcast:10 row_mask:0xf bank_mask:0xf
    v_and_b32_dpp v14, v38, v10 row_newbcast:10 row_mask:0xf bank_mask:0xf
    v_and_b32_dpp v15, v38, v11 row_newbcast:10 row_mask:0xf bank_mask:0xf
    v_mfma_f32_16x16x32_bf16 v[28:31], v[16:19], v[164:167], v[28:31]
    s_cbranch_vccnz Lw369
    s_waitcnt vmcnt(4)
Lw369:
    s_waitcnt vmcnt(6)
    buffer_load_dwordx4 v[196:199], v5, s[12:15], s43 offen offset:1024 nt
    ds_read_b32 v61, v62 offset:22544
    v_and_b32_dpp v16, v38, v8 row_newbcast:11 row_mask:0xf bank_mask:0xf
    v_and_b32_dpp v17, v38, v9 row_newbcast:11 row_mask:0xf bank_mask:0xf
    v_and_b32_dpp v18, v38, v10 row_newbcast:11 row_mask:0xf bank_mask:0xf
    v_and_b32_dpp v19, v38, v11 row_newbcast:11 row_mask:0xf bank_mask:0xf
    v_mfma_f32_16x16x32_bf16 v[28:31], v[12:15], v[168:171], v[28:31]
    s_cbranch_vccnz Lw370
    s_waitcnt vmcnt(4)
Lw370:
    s_waitcnt vmcnt(6)
    buffer_load_dwordx4 v[200:203], v5, s[12:15], s43 offen offset:2048 nt
    v_and_b32_dpp v12, v38, v8 row_newbcast:12 row_mask:0xf bank_mask:0xf
    v_and_b32_dpp v13, v38, v9 row_newbcast:12 row_mask:0xf bank_mask:0xf
    v_and_b32_dpp v14, v38, v10 row_newbcast:12 row_mask:0xf bank_mask:0xf
    v_and_b32_dpp v15, v38, v11 row_newbcast:12 row_mask:0xf bank_mask:0xf
    v_mfma_f32_16x16x32_bf16 v[28:31], v[16:19], v[172:175], v[28:31]
    s_cbranch_vccnz Lw371
    s_waitcnt vmcnt(4)
Lw371:
    s_waitcnt vmcnt(6)
    buffer_load_dwordx4 v[204:207], v5, s[12:15], s43 offen offset:3072 nt
    v_mov_b32 v59, 91
    ds_write_b32 v60, v59 offset:22528
    v_and_b32_dpp v16, v38, v8 row_newbcast:13 row_mask:0xf bank_mask:0xf
    v_and_b32_dpp v17, v38, v9 row_newbcast:13 row_mask:0xf bank_mask:0xf
    v_and_b32_dpp v18, v38, v10 row_newbcast:13 row_mask:0xf bank_mask:0xf
    v_and_b32_dpp v19, v38, v11 row_newbcast:13 row_mask:0xf bank_mask:0xf
    v_mfma_f32_16x16x32_bf16 v[28:31], v[12:15], v[176:179], v[28:31]
    s_cbranch_vccnz Lw372
    s_waitcnt vmcnt(4)
Lw372:
    s_waitcnt vmcnt(6)
    s_add_u32 s43, s42, 462848
    s_and_b32 s43, s43, 0xfffff
    buffer_load_dwordx4 v[208:211], v5, s[12:15], s43 offen offset:0 nt
    v_and_b32_dpp v12, v38, v8 row_newbcast:14 row_mask:0xf bank_mask:0xf
    v_and_b32_dpp v13, v38, v9 row_newbcast:14 row_mask:0xf bank_mask:0xf
    v_and_b32_dpp v14, v38, v10 row_newbcast:14 row_mask:0xf bank_mask:0xf
    v_and_b32_dpp v15, v38, v11 row_newbcast:14 row_mask:0xf bank_mask:0xf
    v_mfma_f32_16x16x32_bf16 v[28:31], v[16:19], v[180:183], v[28:31]
    s_cbranch_vccnz Lw373
    s_waitcnt vmcnt(4)
Lw373:
    s_waitcnt vmcnt(6)
    buffer_load_dwordx4 v[212:215], v5, s[12:15], s43 offen offset:1024 nt
    s_waitcnt lgkmcnt(0)
    v_readfirstlane_b32 s67, v61
    s_cmp_lg_u32 s67, 0
    s_cselect_b64 vcc, -1, 0
    v_and_b32_dpp v16, v38, v8 row_newbcast:15 row_mask:0xf bank_mask:0xf
    v_and_b32_dpp v17, v38, v9 row_newbcast:15 row_mask:0xf bank_mask:0xf
    v_and_b32_dpp v18, v38, v10 row_newbcast:15 row_mask:0xf bank_mask:0xf
    v_and_b32_dpp v19, v38, v11 row_newbcast:15 row_mask:0xf bank_mask:0xf
    v_mfma_f32_16x16x32_bf16 v[28:31], v[12:15], v[184:187], v[28:31]
    s_cbranch_vccnz Lw374
    s_waitcnt vmcnt(4)
Lw374:
    s_waitcnt vmcnt(6)
    buffer_load_dwordx4 v[216:219], v5, s[12:15], s43 offen offset:2048 nt
    v_and_b32_dpp v12, v39, v8 row_newbcast:0 row_mask:0xf bank_mask:0xf
    v_and_b32_dpp v13, v39, v9 row_newbcast:0 row_mask:0xf bank_mask:0xf
    v_and_b32_dpp v14, v39, v10 row_newbcast:0 row_mask:0xf bank_mask:0xf
    v_and_b32_dpp v15, v39, v11 row_newbcast:0 row_mask:0xf bank_mask:0xf
    v_mfma_f32_16x16x32_bf16 v[28:31], v[16:19], v[188:191], v[28:31]
    s_cbranch_vccnz Lw375
    s_waitcnt vmcnt(4)
Lw375:
    s_waitcnt vmcnt(6)
    buffer_load_dwordx4 v[220:223], v5, s[12:15], s43 offen offset:3072 nt
    v_mov_b32 v59, 92
    ds_write_b32 v60, v59 offset:22528
    v_and_b32_dpp v16, v39, v8 row_newbcast:1 row_mask:0xf bank_mask:0xf
    v_and_b32_dpp v17, v39, v9 row_newbcast:1 row_mask:0xf bank_mask:0xf
    v_and_b32_dpp v18, v39, v10 row_newbcast:1 row_mask:0xf bank_mask:0xf
    v_and_b32_dpp v19, v39, v11 row_newbcast:1 row_mask:0xf bank_mask:0xf
    v_mfma_f32_16x16x32_bf16 v[28:31], v[12:15], v[192:195], v[28:31]
    s_cbranch_vccnz Lw376
    s_waitcnt vmcnt(4)
Lw376:
    s_waitcnt vmcnt(6)
    s_add_u32 s43, s42, 491520
    s_and_b32 s43, s43, 0xfffff
    buffer_load_dwordx4 v[224:227], v5, s[12:15], s43 offen offset:0 nt
    v_and_b32_dpp v12, v39, v8 row_newbcast:2 row_mask:0xf bank_mask:0xf
    v_and_b32_dpp v13, v39, v9 row_newbcast:2 row_mask:0xf bank_mask:0xf
    v_and_b32_dpp v14, v39, v10 row_newbcast:2 row_mask:0xf bank_mask:0xf
    v_and_b32_dpp v15, v39, v11 row_newbcast:2 row_mask:0xf bank_mask:0xf
    v_mfma_f32_16x16x32_bf16 v[28:31], v[16:19], v[196:199], v[28:31]
    s_cbranch_vccnz Lw377
    s_waitcnt vmcnt(4)
Lw377:
    s_waitcnt vmcnt(6)
    buffer_load_dwordx4 v[228:231], v5, s[12:15], s43 offen offset:1024 nt
    ds_read_b32 v61, v62 offset:22544
    v_and_b32_dpp v16, v39, v8 row_newbcast:3 row_mask:0xf bank_mask:0xf
    v_and_b32_dpp v17, v39, v9 row_newbcast:3 row_mask:0xf bank_mask:0xf
    v_and_b32_dpp v18, v39, v10 row_newbcast:3 row_mask:0xf bank_mask:0xf
    v_and_b32_dpp v19, v39, v11 row_newbcast:3 row_mask:0xf bank_mask:0xf
    v_mfma_f32_16x16x32_bf16 v[28:31], v[12:15], v[200:203], v[28:31]
    s_cbranch_vccnz Lw378
    s_waitcnt vmcnt(4)
Lw378:
    s_waitcnt vmcnt(6)
    buffer_load_dwordx4 v[232:235], v5, s[12:15], s43 offen offset:2048 nt
    v_and_b32_dpp v12, v39, v8 row_newbcast:4 row_mask:0xf bank_mask:0xf
    v_and_b32_dpp v13, v39, v9 row_newbcast:4 row_mask:0xf bank_mask:0xf
    v_and_b32_dpp v14, v39, v10 row_newbcast:4 row_mask:0xf bank_mask:0xf
    v_and_b32_dpp v15, v39, v11 row_newbcast:4 row_mask:0xf bank_mask:0xf
    v_mfma_f32_16x16x32_bf16 v[28:31], v[16:19], v[204:207], v[28:31]
    s_cbranch_vccnz Lw379
    s_waitcnt vmcnt(4)
Lw379:
    s_waitcnt vmcnt(6)
    buffer_load_dwordx4 v[236:239], v5, s[12:15], s43 offen offset:3072 nt
    v_mov_b32 v59, 93
    ds_write_b32 v60, v59 offset:22528
    v_and_b32_dpp v16, v39, v8 row_newbcast:5 row_mask:0xf bank_mask:0xf
    v_and_b32_dpp v17, v39, v9 row_newbcast:5 row_mask:0xf bank_mask:0xf
    v_and_b32_dpp v18, v39, v10 row_newbcast:5 row_mask:0xf bank_mask:0xf
    v_and_b32_dpp v19, v39, v11 row_newbcast:5 row_mask:0xf bank_mask:0xf
    v_mfma_f32_16x16x32_bf16 v[28:31], v[12:15], v[208:211], v[28:31]
    v_sub_f32 v58, v40, v48
    v_mul_f32 v58, 0x3fb8aa3b, v58
    v_exp_f32 v58, v58
    s_nop 0
    v_add_f32 v49, v49, v58
    v_cvt_pk_bf16_f32 v40, v58, v58
    s_cbranch_vccnz Lw380
    s_waitcnt vmcnt(4)
Lw380:
    s_waitcnt vmcnt(6)
    s_add_u32 s43, s42, 495616
    s_and_b32 s43, s43, 0xfffff
    buffer_load_dwordx4 v[240:243], v5, s[12:15], s43 offen offset:0 nt
    v_and_b32_dpp v12, v39, v8 row_newbcast:6 row_mask:0xf bank_mask:0xf
    v_and_b32_dpp v13, v39, v9 row_newbcast:6 row_mask:0xf bank_mask:0xf
    v_and_b32_dpp v14, v39, v10 row_newbcast:6 row_mask:0xf bank_mask:0xf
    v_and_b32_dpp v15, v39, v11 row_newbcast:6 row_mask:0xf bank_mask:0xf
    v_mfma_f32_16x16x32_bf16 v[28:31], v[16:19], v[212:215], v[28:31]
    s_cbranch_vccnz Lw381
    s_waitcnt vmcnt(4)
Lw381:
    s_waitcnt vmcnt(6)
    buffer_load_dwordx4 v[244:247], v5, s[12:15], s43 offen offset:1024 nt
    s_waitcnt lgkmcnt(0)
    v_readfirstlane_b32 s67, v61
    s_cmp_lg_u32 s67, 0
    s_cselect_b64 vcc, -1, 0
    v_and_b32_dpp v16, v39, v8 row_newbcast:7 row_mask:0xf bank_mask:0xf
    v_and_b32_dpp v17, v39, v9 row_newbcast:7 row_mask:0xf bank_mask:0xf
    v_and_b32_dpp v18, v39, v10 row_newbcast:7 row_mask:0xf bank_mask:0xf
    v_and_b32_dpp v19, v39, v11 row_newbcast:7 row_mask:0xf bank_mask:0xf
    v_mfma_f32_16x16x32_bf16 v[28:31], v[12:15], v[216:219], v[28:31]
    s_cbranch_vccnz Lw382
    s_waitcnt vmcnt(4)
Lw382:
    s_waitcnt vmcnt(6)
    buffer_load_dwordx4 v[248:251], v5, s[12:15], s43 offen offset:2048 nt
    v_and_b32_dpp v12, v39, v8 row_newbcast:8 row_mask:0xf bank_mask:0xf
    v_and_b32_dpp v13, v39, v9 row_newbcast:8 row_mask:0xf bank_mask:0xf
    v_and_b32_dpp v14, v39, v10 row_newbcast:8 row_mask:0xf bank_mask:0xf
    v_and_b32_dpp v15, v39, v11 row_newbcast:8 row_mask:0xf bank_mask:0xf
    v_mfma_f32_16x16x32_bf16 v[28:31], v[16:19], v[220:223], v[28:31]
    s_cbranch_vccnz Lw383
    s_waitcnt vmcnt(4)
Lw383:
    s_waitcnt vmcnt(6)
    buffer_load_dwordx4 v[252:255], v5, s[12:15], s43 offen offset:3072 nt
    v_mov_b32 v59, 94
    ds_write_b32 v60, v59 offset:22528
    v_and_b32_dpp v16, v39, v8 row_newbcast:9 row_mask:0xf bank_mask:0xf
    v_and_b32_dpp v17, v39, v9 row_newbcast:9 row_mask:0xf bank_mask:0xf
    v_and_b32_dpp v18, v39, v10 row_newbcast:9 row_mask:0xf bank_mask:0xf
    v_and_b32_dpp v19, v39, v11 row_newbcast:9 row_mask:0xf bank_mask:0xf
    v_mfma_f32_16x16x32_bf16 v[28:31], v[12:15], v[224:227], v[28:31]
    s_cbranch_vccnz Lw384
    s_waitcnt vmcnt(4)
Lw384:
    s_waitcnt vmcnt(6)
    s_add_u32 s43, s42, 524288
    s_and_b32 s43, s43, 0xfffff
    buffer_load_dwordx4 v[128:131], v5, s[12:15], s43 offen offset:0 nt
    v_and_b32_dpp v12, v39, v8 row_newbcast:10 row_mask:0xf bank_mask:0xf
    v_and_b32_dpp v13, v39, v9 row_newbcast:10 row_mask:0xf bank_mask:0xf
    v_and_b32_dpp v14, v39, v10 row_newbcast:10 row_mask:0xf bank_mask:0xf
    v_and_b32_dpp v15, v39, v11 row_newbcast:10 row_mask:0xf bank_mask:0xf
    v_mfma_f32_16x16x32_bf16 v[28:31], v[16:19], v[228:231], v[28:31]
    s_cbranch_vccnz Lw385
    s_waitcnt vmcnt(4)
Lw385:
    s_waitcnt vmcnt(6)
    buffer_load_dwordx4 v[132:135], v5, s[12:15], s43 offen offset:1024 nt
    ds_read_b32 v61, v62 offset:22544
    v_and_b32_dpp v16, v39, v8 row_newbcast:11 row_mask:0xf bank_mask:0xf
    v_and_b32_dpp v17, v39, v9 row_newbcast:11 row_mask:0xf bank_mask:0xf
    v_and_b32_dpp v18, v39, v10 row_newbcast:11 row_mask:0xf bank_mask:0xf
    v_and_b32_dpp v19, v39, v11 row_newbcast:11 row_mask:0xf bank_mask:0xf
    v_mfma_f32_16x16x32_bf16 v[28:31], v[12:15], v[232:235], v[28:31]
    s_cbranch_vccnz Lw386
    s_waitcnt vmcnt(4)
Lw386:
    s_waitcnt vmcnt(6)
    buffer_load_dwordx4 v[136:139], v5, s[12:15], s43 offen offset:2048 nt
    v_and_b32_dpp v12, v39, v8 row_newbcast:12 row_mask:0xf bank_mask:0xf
    v_and_b32_dpp v13, v39, v9 row_newbcast:12 row_mask:0xf bank_mask:0xf
    v_and_b32_dpp v14, v39, v10 row_newbcast:12 row_mask:0xf bank_mask:0xf
    v_and_b32_dpp v15, v39, v11 row_newbcast:12 row_mask:0xf bank_mask:0xf
    v_mfma_f32_16x16x32_bf16 v[28:31], v[16:19], v[236:239], v[28:31]
    s_cbranch_vccnz Lw387
    s_waitcnt vmcnt(4)
Lw387:
    s_waitcnt vmcnt(6)
    buffer_load_dwordx4 v[140:143], v5, s[12:15], s43 offen offset:3072 nt
    v_mov_b32 v59, 95
    ds_write_b32 v60, v59 offset:22528
    v_and_b32_dpp v16, v39, v8 row_newbcast:13 row_mask:0xf bank_mask:0xf
    v_and_b32_dpp v17, v39, v9 row_newbcast:13 row_mask:0xf bank_mask:0xf
    v_and_b32_dpp v18, v39, v10 row_newbcast:13 row_mask:0xf bank_mask:0xf
    v_and_b32_dpp v19, v39, v11 row_newbcast:13 row_mask:0xf bank_mask:0xf
    v_mfma_f32_16x16x32_bf16 v[28:31], v[12:15], v[240:243], v[28:31]
    s_cbranch_vccnz Lw388
    s_waitcnt vmcnt(4)
Lw388:
    s_waitcnt vmcnt(6)
    s_add_u32 s43, s42, 528384
    s_and_b32 s43, s43, 0xfffff
    buffer_load_dwordx4 v[144:147], v5, s[12:15], s43 offen offset:0 nt
    v_and_b32_dpp v12, v39, v8 row_newbcast:14 row_mask:0xf bank_mask:0xf
    v_and_b32_dpp v13, v39, v9 row_newbcast:14 row_mask:0xf bank_mask:0xf
    v_and_b32_dpp v14, v39, v10 row_newbcast:14 row_mask:0xf bank_mask:0xf
    v_and_b32_dpp v15, v39, v11 row_newbcast:14 row_mask:0xf bank_mask:0xf
    v_mfma_f32_16x16x32_bf16 v[28:31], v[16:19], v[244:247], v[28:31]
    s_cbranch_vccnz Lw389
    s_waitcnt vmcnt(4)
Lw389:
    s_waitcnt vmcnt(6)
    buffer_load_dwordx4 v[148:151], v5, s[12:15], s43 offen offset:1024 nt
    s_waitcnt lgkmcnt(0)
    v_readfirstlane_b32 s67, v61
    s_cmp_lg_u32 s67, 0
    s_cselect_b64 vcc, -1, 0
    v_and_b32_dpp v16, v39, v8 row_newbcast:15 row_mask:0xf bank_mask:0xf
    v_and_b32_dpp v17, v39, v9 row_newbcast:15 row_mask:0xf bank_mask:0xf
    v_and_b32_dpp v18, v39, v10 row_newbcast:15 row_mask:0xf bank_mask:0xf
    v_and_b32_dpp v19, v39, v11 row_newbcast:15 row_mask:0xf bank_mask:0xf
    v_mfma_f32_16x16x32_bf16 v[28:31], v[12:15], v[248:251], v[28:31]
    s_cbranch_vccnz Lw390
    s_waitcnt vmcnt(4)
Lw390:
    s_waitcnt vmcnt(6)
    buffer_load_dwordx4 v[152:155], v5, s[12:15], s43 offen offset:2048 nt
    v_and_b32_dpp v12, v40, v8 row_newbcast:0 row_mask:0xf bank_mask:0xf
    v_and_b32_dpp v13, v40, v9 row_newbcast:0 row_mask:0xf bank_mask:0xf
    v_and_b32_dpp v14, v40, v10 row_newbcast:0 row_mask:0xf bank_mask:0xf
    v_and_b32_dpp v15, v40, v11 row_newbcast:0 row_mask:0xf bank_mask:0xf
    v_mfma_f32_16x16x32_bf16 v[28:31], v[16:19], v[252:255], v[28:31]
    s_cbranch_vccnz Lw391
    s_waitcnt vmcnt(4)
Lw391:
    s_waitcnt vmcnt(6)
    buffer_load_dwordx4 v[156:159], v5, s[12:15], s43 offen offset:3072 nt
    v_mov_b32 v59, 96
    ds_write_b32 v60, v59 offset:22528
    v_and_b32_dpp v16, v40, v8 row_newbcast:1 row_mask:0xf bank_mask:0xf
    v_and_b32_dpp v17, v40, v9 row_newbcast:1 row_mask:0xf bank_mask:0xf
    v_and_b32_dpp v18, v40, v10 row_newbcast:1 row_mask:0xf bank_mask:0xf
    v_and_b32_dpp v19, v40, v11 row_newbcast:1 row_mask:0xf bank_mask:0xf
    v_mfma_f32_16x16x32_bf16 v[28:31], v[12:15], v[128:131], v[28:31]
    s_cbranch_vccnz Lw392
    s_waitcnt vmcnt(4)
Lw392:
    s_waitcnt vmcnt(6)
    s_add_u32 s43, s42, 557056
    s_and_b32 s43, s43, 0xfffff
    buffer_load_dwordx4 v[160:163], v5, s[12:15], s43 offen offset:0 nt
    v_and_b32_dpp v12, v40, v8 row_newbcast:2 row_mask:0xf bank_mask:0xf
    v_and_b32_dpp v13, v40, v9 row_newbcast:2 row_mask:0xf bank_mask:0xf
    v_and_b32_dpp v14, v40, v10 row_newbcast:2 row_mask:0xf bank_mask:0xf
    v_and_b32_dpp v15, v40, v11 row_newbcast:2 row_mask:0xf bank_mask:0xf
    v_mfma_f32_16x16x32_bf16 v[28:31], v[16:19], v[132:135], v[28:31]
    s_cbranch_vccnz Lw393
    s_waitcnt vmcnt(4)
Lw393:
    s_waitcnt vmcnt(6)
    buffer_load_dwordx4 v[164:167], v5, s[12:15], s43 offen offset:1024 nt
    ds_read_b32 v61, v62 offset:22544
    v_and_b32_dpp v16, v40, v8 row_newbcast:3 row_mask:0xf bank_mask:0xf
    v_and_b32_dpp v17, v40, v9 row_newbcast:3 row_mask:0xf bank_mask:0xf
    v_and_b32_dpp v18, v40, v10 row_newbcast:3 row_mask:0xf bank_mask:0xf
    v_and_b32_dpp v19, v40, v11 row_newbcast:3 row_mask:0xf bank_mask:0xf
    v_mfma_f32_16x16x32_bf16 v[28:31], v[12:15], v[136:139], v[28:31]
    s_cbranch_vccnz Lw394
    s_waitcnt vmcnt(4)
Lw394:
    s_waitcnt vmcnt(6)
    buffer_load_dwordx4 v[168:171], v5, s[12:15], s43 offen offset:2048 nt
    v_and_b32_dpp v12, v40, v8 row_newbcast:4 row_mask:0xf bank_mask:0xf
    v_and_b32_dpp v13, v40, v9 row_newbcast:4 row_mask:0xf bank_mask:0xf
    v_and_b32_dpp v14, v40, v10 row_newbcast:4 row_mask:0xf bank_mask:0xf
    v_and_b32_dpp v15, v40, v11 row_newbcast:4 row_mask:0xf bank_mask:0xf
    v_mfma_f32_16x16x32_bf16 v[28:31], v[16:19], v[140:143], v[28:31]
    s_cbranch_vccnz Lw395
    s_waitcnt vmcnt(4)
Lw395:
    s_waitcnt vmcnt(6)
    buffer_load_dwordx4 v[172:175], v5, s[12:15], s43 offen offset:3072 nt
    v_mov_b32 v59, 97
    ds_write_b32 v60, v59 offset:22528
    v_and_b32_dpp v16, v40, v8 row_newbcast:5 row_mask:0xf bank_mask:0xf
    v_and_b32_dpp v17, v40, v9 row_newbcast:5 row_mask:0xf bank_mask:0xf
    v_and_b32_dpp v18, v40, v10 row_newbcast:5 row_mask:0xf bank_mask:0xf
    v_and_b32_dpp v19, v40, v11 row_newbcast:5 row_mask:0xf bank_mask:0xf
    v_mfma_f32_16x16x32_bf16 v[28:31], v[12:15], v[144:147], v[28:31]
    v_sub_f32 v58, v41, v48
    v_mul_f32 v58, 0x3fb8aa3b, v58
    v_exp_f32 v58, v58
    s_nop 0
    v_add_f32 v49, v49, v58
    v_cvt_pk_bf16_f32 v41, v58, v58
    s_cbranch_vccnz Lw396
    s_waitcnt vmcnt(4)
Lw396:
    s_waitcnt vmcnt(6)
    s_add_u32 s43, s42, 561152
    s_and_b32 s43, s43, 0xfffff
    buffer_load_dwordx4 v[176:179], v5, s[12:15], s43 offen offset:0 nt
    v_and_b32_dpp v12, v40, v8 row_newbcast:6 row_mask:0xf bank_mask:0xf
    v_and_b32_dpp v13, v40, v9 row_newbcast:6 row_mask:0xf bank_mask:0xf
    v_and_b32_dpp v14, v40, v10 row_newbcast:6 row_mask:0xf bank_mask:0xf
    v_and_b32_dpp v15, v40, v11 row_newbcast:6 row_mask:0xf bank_mask:0xf
    v_mfma_f32_16x16x32_bf16 v[28:31], v[16:19], v[148:151], v[28:31]
    s_cbranch_vccnz Lw397
    s_waitcnt vmcnt(4)
Lw397:
    s_waitcnt vmcnt(6)
    buffer_load_dwordx4 v[180:183], v5, s[12:15], s43 offen offset:1024 nt
    s_waitcnt lgkmcnt(0)
    v_readfirstlane_b32 s67, v61
    s_getreg_b32 s73, hwreg(HW_REG_XCC_ID)
    s_andn2_b32 s73, 1, s73
    s_or_b32 s67, s67, s73
    s_cmp_lg_u32 s67, 0
    s_cselect_b64 vcc, -1, 0
    v_and_b32_dpp v16, v40, v8 row_newbcast:7 row_mask:0xf bank_mask:0xf
    v_and_b32_dpp v17, v40, v9 row_newbcast:7 row_mask:0xf bank_mask:0xf
    v_and_b32_dpp v18, v40, v10 row_newbcast:7 row_mask:0xf bank_mask:0xf
    v_and_b32_dpp v19, v40, v11 row_newbcast:7 row_mask:0xf bank_mask:0xf
    v_mfma_f32_16x16x32_bf16 v[28:31], v[12:15], v[152:155], v[28:31]
    s_cbranch_vccnz Lw398
    s_waitcnt vmcnt(4)
Lw398:
    s_waitcnt vmcnt(6)
    buffer_load_dwordx4 v[184:187], v5, s[12:15], s43 offen offset:2048 nt
    v_and_b32_dpp v12, v40, v8 row_newbcast:8 row_mask:0xf bank_mask:0xf
    v_and_b32_dpp v13, v40, v9 row_newbcast:8 row_mask:0xf bank_mask:0xf
    v_and_b32_dpp v14, v40, v10 row_newbcast:8 row_mask:0xf bank_mask:0xf
    v_and_b32_dpp v15, v40, v11 row_newbcast:8 row_mask:0xf bank_mask:0xf
    v_mfma_f32_16x16x32_bf16 v[28:31], v[16:19], v[156:159], v[28:31]
    s_cbranch_vccnz Lw399
    s_waitcnt vmcnt(4)
Lw399:
    s_waitcnt vmcnt(6)
    buffer_load_dwordx4 v[188:191], v5, s[12:15], s43 offen offset:3072 nt
    v_mov_b32 v59, 98
    ds_write_b32 v60, v59 offset:22528
    v_and_b32_dpp v16, v40, v8 row_newbcast:9 row_mask:0xf bank_mask:0xf
    v_and_b32_dpp v17, v40, v9 row_newbcast:9 row_mask:0xf bank_mask:0xf
    v_and_b32_dpp v18, v40, v10 row_newbcast:9 row_mask:0xf bank_mask:0xf
    v_and_b32_dpp v19, v40, v11 row_newbcast:9 row_mask:0xf bank_mask:0xf
    v_mfma_f32_16x16x32_bf16 v[28:31], v[12:15], v[160:163], v[28:31]
    s_cbranch_vccnz Lw400
    s_waitcnt vmcnt(4)
Lw400:
    s_waitcnt vmcnt(6)
    s_add_u32 s43, s42, 589824
    s_and_b32 s43, s43, 0xfffff
    buffer_load_dwordx4 v[192:195], v5, s[12:15], s43 offen offset:0 nt
    v_and_b32_dpp v12, v40, v8 row_newbcast:10 row_mask:0xf bank_mask:0xf
    v_and_b32_dpp v13, v40, v9 row_newbcast:10 row_mask:0xf bank_mask:0xf
    v_and_b32_dpp v14, v40, v10 row_newbcast:10 row_mask:0xf bank_mask:0xf
    v_and_b32_dpp v15, v40, v11 row_newbcast:10 row_mask:0xf bank_mask:0xf
    v_mfma_f32_16x16x32_bf16 v[28:31], v[16:19], v[164:167], v[28:31]
    s_cbranch_vccnz Lw401
    s_waitcnt vmcnt(4)
Lw401:
    s_waitcnt vmcnt(6)
    buffer_load_dwordx4 v[196:199], v5, s[12:15], s43 offen offset:1024 nt
    ds_read_b32 v61, v62 offset:22544
    v_and_b32_dpp v16, v40, v8 row_newbcast:11 row_mask:0xf bank_mask:0xf
    v_and_b32_dpp v17, v40, v9 row_newbcast:11 row_mask:0xf bank_mask:0xf
    v_and_b32_dpp v18, v40, v10 row_newbcast:11 row_mask:0xf bank_mask:0xf
    v_and_b32_dpp v19, v40, v11 row_newbcast:11 row_mask:0xf bank_mask:0xf
    v_mfma_f32_16x16x32_bf16 v[28:31], v[12:15], v[168:171], v[28:31]
    s_cbranch_vccnz Lw402
    s_waitcnt vmcnt(4)
Lw402:
    s_waitcnt vmcnt(6)
    buffer_load_dwordx4 v[200:203], v5, s[12:15], s43 offen offset:2048 nt
    v_and_b32_dpp v12, v40, v8 row_newbcast:12 row_mask:0xf bank_mask:0xf
    v_and_b32_dpp v13, v40, v9 row_newbcast:12 row_mask:0xf bank_mask:0xf
    v_and_b32_dpp v14, v40, v10 row_newbcast:12 row_mask:0xf bank_mask:0xf
    v_and_b32_dpp v15, v40, v11 row_newbcast:12 row_mask:0xf bank_mask:0xf
    v_mfma_f32_16x16x32_bf16 v[28:31], v[16:19], v[172:175], v[28:31]
    s_cbranch_vccnz Lw403
    s_waitcnt vmcnt(4)
Lw403:
    s_waitcnt vmcnt(6)
    buffer_load_dwordx4 v[204:207], v5, s[12:15], s43 offen offset:3072 nt
    v_mov_b32 v59, 99
    ds_write_b32 v60, v59 offset:22528
    v_and_b32_dpp v16, v40, v8 row_newbcast:13 row_mask:0xf bank_mask:0xf
    v_and_b32_dpp v17, v40, v9 row_newbcast:13 row_mask:0xf bank_mask:0xf
    v_and_b32_dpp v18, v40, v10 row_newbcast:13 row_mask:0xf bank_mask:0xf
    v_and_b32_dpp v19, v40, v11 row_newbcast:13 row_mask:0xf bank_mask:0xf
    v_mfma_f32_16x16x32_bf16 v[28:31], v[12:15], v[176:179], v[28:31]
    s_cbranch_vccnz Lw404
    s_waitcnt vmcnt(4)
Lw404:
    s_waitcnt vmcnt(6)
    s_add_u32 s43, s42, 593920
    s_and_b32 s43, s43, 0xfffff
    buffer_load_dwordx4 v[208:211], v5, s[12:15], s43 offen offset:0 nt
    v_and_b32_dpp v12, v40, v8 row_newbcast:14 row_mask:0xf bank_mask:0xf
    v_and_b32_dpp v13, v40, v9 row_newbcast:14 row_mask:0xf bank_mask:0xf
    v_and_b32_dpp v14, v40, v10 row_newbcast:14 row_mask:0xf bank_mask:0xf
    v_and_b32_dpp v15, v40, v11 row_newbcast:14 row_mask:0xf bank_mask:0xf
    v_mfma_f32_16x16x32_bf16 v[28:31], v[16:19], v[180:183], v[28:31]
    s_cbranch_vccnz Lw405
    s_waitcnt vmcnt(4)
Lw405:
    s_waitcnt vmcnt(6)
    buffer_load_dwordx4 v[212:215], v5, s[12:15], s43 offen offset:1024 nt
    s_waitcnt lgkmcnt(0)
    v_readfirstlane_b32 s67, v61
    s_getreg_b32 s73, hwreg(HW_REG_XCC_ID)
    s_andn2_b32 s73, 1, s73
    s_or_b32 s67, s67, s73
    s_cmp_lg_u32 s67, 0
    s_cselect_b64 vcc, -1, 0
    v_and_b32_dpp v16, v40, v8 row_newbcast:15 row_mask:0xf bank_mask:0xf
    v_and_b32_dpp v17, v40, v9 row_newbcast:15 row_mask:0xf bank_mask:0xf
    v_and_b32_dpp v18, v40, v10 row_newbcast:15 row_mask:0xf bank_mask:0xf
    v_and_b32_dpp v19, v40, v11 row_newbcast:15 row_mask:0xf bank_mask:0xf
    v_mfma_f32_16x16x32_bf16 v[28:31], v[12:15], v[184:187], v[28:31]
    s_cbranch_vccnz Lw406
    s_waitcnt vmcnt(4)
Lw406:
    s_waitcnt vmcnt(6)
    buffer_load_dwordx4 v[216:219], v5, s[12:15], s43 offen offset:2048 nt
    v_and_b32_dpp v12, v41, v8 row_newbcast:0 row_mask:0xf bank_mask:0xf
    v_and_b32_dpp v13, v41, v9 row_newbcast:0 row_mask:0xf bank_mask:0xf
    v_and_b32_dpp v14, v41, v10 row_newbcast:0 row_mask:0xf bank_mask:0xf
    v_and_b32_dpp v15, v41, v11 row_newbcast:0 row_mask:0xf bank_mask:0xf
    v_mfma_f32_16x16x32_bf16 v[28:31], v[16:19], v[188:191], v[28:31]
    s_cbranch_vccnz Lw407
    s_waitcnt vmcnt(4)
Lw407:
    s_waitcnt vmcnt(6)
    buffer_load_dwordx4 v[220:223], v5, s[12:15], s43 offen offset:3072 nt
    v_mov_b32 v59, 100
    ds_write_b32 v60, v59 offset:22528
    v_and_b32_dpp v16, v41, v8 row_newbcast:1 row_mask:0xf bank_mask:0xf
    v_and_b32_dpp v17, v41, v9 row_newbcast:1 row_mask:0xf bank_mask:0xf
    v_and_b32_dpp v18, v41, v10 row_newbcast:1 row_mask:0xf bank_mask:0xf
    v_and_b32_dpp v19, v41, v11 row_newbcast:1 row_mask:0xf bank_mask:0xf
    v_mfma_f32_16x16x32_bf16 v[28:31], v[12:15], v[192:195], v[28:31]
    s_cbranch_vccnz Lw408
    s_waitcnt vmcnt(4)
Lw408:
    s_waitcnt vmcnt(6)
    s_add_u32 s43, s42, 622592
    s_and_b32 s43, s43, 0xfffff
    buffer_load_dwordx4 v[224:227], v5, s[12:15], s43 offen offset:0 nt
    v_and_b32_dpp v12, v41, v8 row_newbcast:2 row_mask:0xf bank_mask:0xf
    v_and_b32_dpp v13, v41, v9 row_newbcast:2 row_mask:0xf bank_mask:0xf
    v_and_b32_dpp v14, v41, v10 row_newbcast:2 row_mask:0xf bank_mask:0xf
    v_and_b32_dpp v15, v41, v11 row_newbcast:2 row_mask:0xf bank_mask:0xf
    v_mfma_f32_16x16x32_bf16 v[28:31], v[16:19], v[196:199], v[28:31]
    s_cbranch_vccnz Lw409
    s_waitcnt vmcnt(4)
Lw409:
    s_waitcnt vmcnt(6)
    buffer_load_dwordx4 v[228:231], v5, s[12:15], s43 offen offset:1024 nt
    ds_read_b32 v61, v62 offset:22544
    v_and_b32_dpp v16, v41, v8 row_newbcast:3 row_mask:0xf bank_mask:0xf
    v_and_b32_dpp v17, v41, v9 row_newbcast:3 row_mask:0xf bank_mask:0xf
    v_and_b32_dpp v18, v41, v10 row_newbcast:3 row_mask:0xf bank_mask:0xf
    v_and_b32_dpp v19, v41, v11 row_newbcast:3 row_mask:0xf bank_mask:0xf
    v_mfma_f32_16x16x32_bf16 v[28:31], v[12:15], v[200:203], v[28:31]
    s_cbranch_vccnz Lw410
    s_waitcnt vmcnt(4)
Lw410:
    s_waitcnt vmcnt(6)
    buffer_load_dwordx4 v[232:235], v5, s[12:15], s43 offen offset:2048 nt
    v_and_b32_dpp v12, v41, v8 row_newbcast:4 row_mask:0xf bank_mask:0xf
    v_and_b32_dpp v13, v41, v9 row_newbcast:4 row_mask:0xf bank_mask:0xf
    v_and_b32_dpp v14, v41, v10 row_newbcast:4 row_mask:0xf bank_mask:0xf
    v_and_b32_dpp v15, v41, v11 row_newbcast:4 row_mask:0xf bank_mask:0xf
    v_mfma_f32_16x16x32_bf16 v[28:31], v[16:19], v[204:207], v[28:31]
    s_cbranch_vccnz Lw411
    s_waitcnt vmcnt(4)
Lw411:
    s_waitcnt vmcnt(6)
    buffer_load_dwordx4 v[236:239], v5, s[12:15], s43 offen offset:3072 nt
    v_mov_b32 v59, 101
    ds_write_b32 v60, v59 offset:22528
    v_and_b32_dpp v16, v41, v8 row_newbcast:5 row_mask:0xf bank_mask:0xf
    v_and_b32_dpp v17, v41, v9 row_newbcast:5 row_mask:0xf bank_mask:0xf
    v_and_b32_dpp v18, v41, v10 row_newbcast:5 row_mask:0xf bank_mask:0xf
    v_and_b32_dpp v19, v41, v11 row_newbcast:5 row_mask:0xf bank_mask:0xf
    v_mfma_f32_16x16x32_bf16 v[28:31], v[12:15], v[208:211], v[28:31]
    v_sub_f32 v58, v42, v48
    v_mul_f32 v58, 0x3fb8aa3b, v58
    v_exp_f32 v58, v58
    s_nop 0
    v_add_f32 v49, v49, v58
    v_cvt_pk_bf16_f32 v42, v58, v58
    s_cbranch_vccnz Lw412
    s_waitcnt vmcnt(4)
Lw412:
    s_waitcnt vmcnt(6)
    s_add_u32 s43, s42, 626688
    s_and_b32 s43, s43, 0xfffff
    buffer_load_dwordx4 v[240:243], v5, s[12:15], s43 offen offset:0 nt
    v_and_b32_dpp v12, v41, v8 row_newbcast:6 row_mask:0xf bank_mask:0xf
    v_and_b32_dpp v13, v41, v9 row_newbcast:6 row_mask:0xf bank_mask:0xf
    v_and_b32_dpp v14, v41, v10 row_newbcast:6 row_mask:0xf bank_mask:0xf
    v_and_b32_dpp v15, v41, v11 row_newbcast:6 row_mask:0xf bank_mask:0xf
    v_mfma_f32_16x16x32_bf16 v[28:31], v[16:19], v[212:215], v[28:31]
    s_cbranch_vccnz Lw413
    s_waitcnt vmcnt(4)
Lw413:
    s_waitcnt vmcnt(6)
    buffer_load_dwordx4 v[244:247], v5, s[12:15], s43 offen offset:1024 nt
    s_waitcnt lgkmcnt(0)
    v_readfirstlane_b32 s67, v61
    s_getreg_b32 s73, hwreg(HW_REG_XCC_ID)
    s_andn2_b32 s73, 1, s73
    s_or_b32 s67, s67, s73
    s_cmp_lg_u32 s67, 0
    s_cselect_b64 vcc, -1, 0
    v_and_b32_dpp v16, v41, v8 row_newbcast:7 row_mask:0xf bank_mask:0xf
    v_and_b32_dpp v17, v41, v9 row_newbcast:7 row_mask:0xf bank_mask:0xf
    v_and_b32_dpp v18, v41, v10 row_newbcast:7 row_mask:0xf bank_mask:0xf
    v_and_b32_dpp v19, v41, v11 row_newbcast:7 row_mask:0xf bank_mask:0xf
    v_mfma_f32_16x16x32_bf16 v[28:31], v[12:15], v[216:219], v[28:31]
    s_cbranch_vccnz Lw414
    s_waitcnt vmcnt(4)
Lw414:
    s_waitcnt vmcnt(6)
    buffer_load_dwordx4 v[248:251], v5, s[12:15], s43 offen offset:2048 nt
    v_and_b32_dpp v12, v41, v8 row_newbcast:8 row_mask:0xf bank_mask:0xf
    v_and_b32_dpp v13, v41, v9 row_newbcast:8 row_mask:0xf bank_mask:0xf
    v_and_b32_dpp v14, v41, v10 row_newbcast:8 row_mask:0xf bank_mask:0xf
    v_and_b32_dpp v15, v41, v11 row_newbcast:8 row_mask:0xf bank_mask:0xf
    v_mfma_f32_16x16x32_bf16 v[28:31], v[16:19], v[220:223], v[28:31]
    s_cbranch_vccnz Lw415
    s_waitcnt vmcnt(4)
Lw415:
    s_waitcnt vmcnt(6)
    buffer_load_dwordx4 v[252:255], v5, s[12:15], s43 offen offset:3072 nt
    v_mov_b32 v59, 102
    ds_write_b32 v60, v59 offset:22528
    v_and_b32_dpp v16, v41, v8 row_newbcast:9 row_mask:0xf bank_mask:0xf
    v_and_b32_dpp v17, v41, v9 row_newbcast:9 row_mask:0xf bank_mask:0xf
    v_and_b32_dpp v18, v41, v10 row_newbcast:9 row_mask:0xf bank_mask:0xf
    v_and_b32_dpp v19, v41, v11 row_newbcast:9 row_mask:0xf bank_mask:0xf
    v_mfma_f32_16x16x32_bf16 v[28:31], v[12:15], v[224:227], v[28:31]
    s_cbranch_vccnz Lw416
    s_waitcnt vmcnt(4)
Lw416:
    s_waitcnt vmcnt(6)
    s_add_u32 s43, s42, 655360
    s_and_b32 s43, s43, 0xfffff
    buffer_load_dwordx4 v[128:131], v5, s[12:15], s43 offen offset:0 nt
    v_and_b32_dpp v12, v41, v8 row_newbcast:10 row_mask:0xf bank_mask:0xf
    v_and_b32_dpp v13, v41, v9 row_newbcast:10 row_mask:0xf bank_mask:0xf
    v_and_b32_dpp v14, v41, v10 row_newbcast:10 row_mask:0xf bank_mask:0xf
    v_and_b32_dpp v15, v41, v11 row_newbcast:10 row_mask:0xf bank_mask:0xf
    v_mfma_f32_16x16x32_bf16 v[28:31], v[16:19], v[228:231], v[28:31]
    s_cbranch_vccnz Lw417
    s_waitcnt vmcnt(4)
Lw417:
    s_waitcnt vmcnt(6)
    buffer_load_dwordx4 v[132:135], v5, s[12:15], s43 offen offset:1024 nt
    ds_read_b32 v61, v62 offset:22544
    v_and_b32_dpp v16, v41, v8 row_newbcast:11 row_mask:0xf bank_mask:0xf
    v_and_b32_dpp v17, v41, v9 row_newbcast:11 row_mask:0xf bank_mask:0xf
    v_and_b32_dpp v18, v41, v10 row_newbcast:11 row_mask:0xf bank_mask:0xf
    v_and_b32_dpp v19, v41, v11 row_newbcast:11 row_mask:0xf bank_mask:0xf
    v_mfma_f32_16x16x32_bf16 v[28:31], v[12:15], v[232:235], v[28:31]
    s_cbranch_vccnz Lw418
    s_waitcnt vmcnt(4)
Lw418:
    s_waitcnt vmcnt(6)
    buffer_load_dwordx4 v[136:139], v5, s[12:15], s43 offen offset:2048 nt
    v_and_b32_dpp v12, v41, v8 row_newbcast:12 row_mask:0xf bank_mask:0xf
    v_and_b32_dpp v13, v41, v9 row_newbcast:12 row_mask:0xf bank_mask:0xf
    v_and_b32_dpp v14, v41, v10 row_newbcast:12 row_mask:0xf bank_mask:0xf
    v_and_b32_dpp v15, v41, v11 row_newbcast:12 row_mask:0xf bank_mask:0xf
    v_mfma_f32_16x16x32_bf16 v[28:31], v[16:19], v[236:239], v[28:31]
    s_cbranch_vccnz Lw419
    s_waitcnt vmcnt(4)
Lw419:
    s_waitcnt vmcnt(6)
    buffer_load_dwordx4 v[140:143], v5, s[12:15], s43 offen offset:3072 nt
    v_mov_b32 v59, 103
    ds_write_b32 v60, v59 offset:22528
    v_and_b32_dpp v16, v41, v8 row_newbcast:13 row_mask:0xf bank_mask:0xf
    v_and_b32_dpp v17, v41, v9 row_newbcast:13 row_mask:0xf bank_mask:0xf
    v_and_b32_dpp v18, v41, v10 row_newbcast:13 row_mask:0xf bank_mask:0xf
    v_and_b32_dpp v19, v41, v11 row_newbcast:13 row_mask:0xf bank_mask:0xf
    v_mfma_f32_16x16x32_bf16 v[28:31], v[12:15], v[240:243], v[28:31]
    s_cbranch_vccnz Lw420
    s_waitcnt vmcnt(4)
Lw420:
    s_waitcnt vmcnt(6)
    s_add_u32 s43, s42, 659456
    s_and_b32 s43, s43, 0xfffff
    buffer_load_dwordx4 v[144:147], v5, s[12:15], s43 offen offset:0 nt
    v_and_b32_dpp v12, v41, v8 row_newbcast:14 row_mask:0xf bank_mask:0xf
    v_and_b32_dpp v13, v41, v9 row_newbcast:14 row_mask:0xf bank_mask:0xf
    v_and_b32_dpp v14, v41, v10 row_newbcast:14 row_mask:0xf bank_mask:0xf
    v_and_b32_dpp v15, v41, v11 row_newbcast:14 row_mask:0xf bank_mask:0xf
    v_mfma_f32_16x16x32_bf16 v[28:31], v[16:19], v[244:247], v[28:31]
    s_cbranch_vccnz Lw421
    s_waitcnt vmcnt(4)
Lw421:
    s_waitcnt vmcnt(6)
    buffer_load_dwordx4 v[148:151], v5, s[12:15], s43 offen offset:1024 nt
    s_waitcnt lgkmcnt(0)
    v_readfirstlane_b32 s67, v61
    s_getreg_b32 s73, hwreg(HW_REG_XCC_ID)
    s_andn2_b32 s73, 1, s73
    s_or_b32 s67, s67, s73
    s_cmp_lg_u32 s67, 0
    s_cselect_b64 vcc, -1, 0
    v_and_b32_dpp v16, v41, v8 row_newbcast:15 row_mask:0xf bank_mask:0xf
    v_and_b32_dpp v17, v41, v9 row_newbcast:15 row_mask:0xf bank_mask:0xf
    v_and_b32_dpp v18, v41, v10 row_newbcast:15 row_mask:0xf bank_mask:0xf
    v_and_b32_dpp v19, v41, v11 row_newbcast:15 row_mask:0xf bank_mask:0xf
    v_mfma_f32_16x16x32_bf16 v[28:31], v[12:15], v[248:251], v[28:31]
    s_cbranch_vccnz Lw422
    s_waitcnt vmcnt(4)
Lw422:
    s_waitcnt vmcnt(6)
    buffer_load_dwordx4 v[152:155], v5, s[12:15], s43 offen offset:2048 nt
    v_and_b32_dpp v12, v42, v8 row_newbcast:0 row_mask:0xf bank_mask:0xf
    v_and_b32_dpp v13, v42, v9 row_newbcast:0 row_mask:0xf bank_mask:0xf
    v_and_b32_dpp v14, v42, v10 row_newbcast:0 row_mask:0xf bank_mask:0xf
    v_and_b32_dpp v15, v42, v11 row_newbcast:0 row_mask:0xf bank_mask:0xf
    v_mfma_f32_16x16x32_bf16 v[28:31], v[16:19], v[252:255], v[28:31]
    s_cbranch_vccnz Lw423
    s_waitcnt vmcnt(4)
Lw423:
    s_waitcnt vmcnt(6)
    buffer_load_dwordx4 v[156:159], v5, s[12:15], s43 offen offset:3072 nt
    v_mov_b32 v59, 104
    ds_write_b32 v60, v59 offset:22528
    v_and_b32_dpp v16, v42, v8 row_newbcast:1 row_mask:0xf bank_mask:0xf
    v_and_b32_dpp v17, v42, v9 row_newbcast:1 row_mask:0xf bank_mask:0xf
    v_and_b32_dpp v18, v42, v10 row_newbcast:1 row_mask:0xf bank_mask:0xf
    v_and_b32_dpp v19, v42, v11 row_newbcast:1 row_mask:0xf bank_mask:0xf
    v_mfma_f32_16x16x32_bf16 v[28:31], v[12:15], v[128:131], v[28:31]
    s_cbranch_vccnz Lw424
    s_waitcnt vmcnt(4)
Lw424:
    s_waitcnt vmcnt(6)
    s_add_u32 s43, s42, 688128
    s_and_b32 s43, s43, 0xfffff
    buffer_load_dwordx4 v[160:163], v5, s[12:15], s43 offen offset:0 nt
    v_and_b32_dpp v12, v42, v8 row_newbcast:2 row_mask:0xf bank_mask:0xf
    v_and_b32_dpp v13, v42, v9 row_newbcast:2 row_mask:0xf bank_mask:0xf
    v_and_b32_dpp v14, v42, v10 row_newbcast:2 row_mask:0xf bank_mask:0xf
    v_and_b32_dpp v15, v42, v11 row_newbcast:2 row_mask:0xf bank_mask:0xf
    v_mfma_f32_16x16x32_bf16 v[28:31], v[16:19], v[132:135], v[28:31]
    s_cbranch_vccnz Lw425
    s_waitcnt vmcnt(4)
Lw425:
    s_waitcnt vmcnt(6)
    buffer_load_dwordx4 v[164:167], v5, s[12:15], s43 offen offset:1024 nt
    ds_read_b32 v61, v62 offset:22544
    v_and_b32_dpp v16, v42, v8 row_newbcast:3 row_mask:0xf bank_mask:0xf
    v_and_b32_dpp v17, v42, v9 row_newbcast:3 row_mask:0xf bank_mask:0xf
    v_and_b32_dpp v18, v42, v10 row_newbcast:3 row_mask:0xf bank_mask:0xf
    v_and_b32_dpp v19, v42, v11 row_newbcast:3 row_mask:0xf bank_mask:0xf
    v_mfma_f32_16x16x32_bf16 v[28:31], v[12:15], v[136:139], v[28:31]
    s_cbranch_vccnz Lw426
    s_waitcnt vmcnt(4)
Lw426:
    s_waitcnt vmcnt(6)
    buffer_load_dwordx4 v[168:171], v5, s[12:15], s43 offen offset:2048 nt
    v_and_b32_dpp v12, v42, v8 row_newbcast:4 row_mask:0xf bank_mask:0xf
    v_and_b32_dpp v13, v42, v9 row_newbcast:4 row_mask:0xf bank_mask:0xf
    v_and_b32_dpp v14, v42, v10 row_newbcast:4 row_mask:0xf bank_mask:0xf
    v_and_b32_dpp v15, v42, v11 row_newbcast:4 row_mask:0xf bank_mask:0xf
    v_mfma_f32_16x16x32_bf16 v[28:31], v[16:19], v[140:143], v[28:31]
    s_cbranch_vccnz Lw427
    s_waitcnt vmcnt(4)
Lw427:
    s_waitcnt vmcnt(6)
    buffer_load_dwordx4 v[172:175], v5, s[12:15], s43 offen offset:3072 nt
    v_mov_b32 v59, 105
    ds_write_b32 v60, v59 offset:22528
    v_and_b32_dpp v16, v42, v8 row_newbcast:5 row_mask:0xf bank_mask:0xf
    v_and_b32_dpp v17, v42, v9 row_newbcast:5 row_mask:0xf bank_mask:0xf
    v_and_b32_dpp v18, v42, v10 row_newbcast:5 row_mask:0xf bank_mask:0xf
    v_and_b32_dpp v19, v42, v11 row_newbcast:5 row_mask:0xf bank_mask:0xf
    v_mfma_f32_16x16x32_bf16 v[28:31], v[12:15], v[144:147], v[28:31]
    v_sub_f32 v58, v43, v48
    v_mul_f32 v58, 0x3fb8aa3b, v58
    v_exp_f32 v58, v58
    s_nop 0
    v_add_f32 v49, v49, v58
    v_cvt_pk_bf16_f32 v43, v58, v58
    s_cbranch_vccnz Lw428
    s_waitcnt vmcnt(4)
Lw428:
    s_waitcnt vmcnt(6)
    s_add_u32 s43, s42, 692224
    s_and_b32 s43, s43, 0xfffff
    buffer_load_dwordx4 v[176:179], v5, s[12:15], s43 offen offset:0 nt
    v_and_b32_dpp v12, v42, v8 row_newbcast:6 row_mask:0xf bank_mask:0xf
    v_and_b32_dpp v13, v42, v9 row_newbcast:6 row_mask:0xf bank_mask:0xf
    v_and_b32_dpp v14, v42, v10 row_newbcast:6 row_mask:0xf bank_mask:0xf
    v_and_b32_dpp v15, v42, v11 row_newbcast:6 row_mask:0xf bank_mask:0xf
    v_mfma_f32_16x16x32_bf16 v[28:31], v[16:19], v[148:151], v[28:31]
    s_cbranch_vccnz Lw429
    s_waitcnt vmcnt(4)
Lw429:
    s_waitcnt vmcnt(6)
    buffer_load_dwordx4 v[180:183], v5, s[12:15], s43 offen offset:1024 nt
    s_waitcnt lgkmcnt(0)
    v_readfirstlane_b32 s67, v61
    s_cmp_lg_u32 s67, 0
    s_cselect_b64 vcc, -1, 0
    v_and_b32_dpp v16, v42, v8 row_newbcast:7 row_mask:0xf bank_mask:0xf
    v_and_b32_dpp v17, v42, v9 row_newbcast:7 row_mask:0xf bank_mask:0xf
    v_and_b32_dpp v18, v42, v10 row_newbcast:7 row_mask:0xf bank_mask:0xf
    v_and_b32_dpp v19, v42, v11 row_newbcast:7 row_mask:0xf bank_mask:0xf
    v_mfma_f32_16x16x32_bf16 v[28:31], v[12:15], v[152:155], v[28:31]
    s_cbranch_vccnz Lw430
    s_waitcnt vmcnt(4)
Lw430:
    s_waitcnt vmcnt(6)
    buffer_load_dwordx4 v[184:187], v5, s[12:15], s43 offen offset:2048 nt
    v_and_b32_dpp v12, v42, v8 row_newbcast:8 row_mask:0xf bank_mask:0xf
    v_and_b32_dpp v13, v42, v9 row_newbcast:8 row_mask:0xf bank_mask:0xf
    v_and_b32_dpp v14, v42, v10 row_newbcast:8 row_mask:0xf bank_mask:0xf
    v_and_b32_dpp v15, v42, v11 row_newbcast:8 row_mask:0xf bank_mask:0xf
    v_mfma_f32_16x16x32_bf16 v[28:31], v[16:19], v[156:159], v[28:31]
    s_cbranch_vccnz Lw431
    s_waitcnt vmcnt(4)
Lw431:
    s_waitcnt vmcnt(6)
    buffer_load_dwordx4 v[188:191], v5, s[12:15], s43 offen offset:3072 nt
    v_mov_b32 v59, 106
    ds_write_b32 v60, v59 offset:22528
    v_and_b32_dpp v16, v42, v8 row_newbcast:9 row_mask:0xf bank_mask:0xf
    v_and_b32_dpp v17, v42, v9 row_newbcast:9 row_mask:0xf bank_mask:0xf
    v_and_b32_dpp v18, v42, v10 row_newbcast:9 row_mask:0xf bank_mask:0xf
    v_and_b32_dpp v19, v42, v11 row_newbcast:9 row_mask:0xf bank_mask:0xf
    v_mfma_f32_16x16x32_bf16 v[28:31], v[12:15], v[160:163], v[28:31]
    s_cbranch_vccnz Lw432
    s_waitcnt vmcnt(4)
Lw432:
    s_waitcnt vmcnt(6)
    s_add_u32 s43, s42, 720896
    s_and_b32 s43, s43, 0xfffff
    buffer_load_dwordx4 v[192:195], v5, s[12:15], s43 offen offset:0 nt
    v_and_b32_dpp v12, v42, v8 row_newbcast:10 row_mask:0xf bank_mask:0xf
    v_and_b32_dpp v13, v42, v9 row_newbcast:10 row_mask:0xf bank_mask:0xf
    v_and_b32_dpp v14, v42, v10 row_newbcast:10 row_mask:0xf bank_mask:0xf
    v_and_b32_dpp v15, v42, v11 row_newbcast:10 row_mask:0xf bank_mask:0xf
    v_mfma_f32_16x16x32_bf16 v[28:31], v[16:19], v[164:167], v[28:31]
    s_cbranch_vccnz Lw433
    s_waitcnt vmcnt(4)
Lw433:
    s_waitcnt vmcnt(6)
    buffer_load_dwordx4 v[196:199], v5, s[12:15], s43 offen offset:1024 nt
    ds_read_b32 v61, v62 offset:22544
    v_and_b32_dpp v16, v42, v8 row_newbcast:11 row_mask:0xf bank_mask:0xf
    v_and_b32_dpp v17, v42, v9 row_newbcast:11 row_mask:0xf bank_mask:0xf
    v_and_b32_dpp v18, v42, v10 row_newbcast:11 row_mask:0xf bank_mask:0xf
    v_and_b32_dpp v19, v42, v11 row_newbcast:11 row_mask:0xf bank_mask:0xf
    v_mfma_f32_16x16x32_bf16 v[28:31], v[12:15], v[168:171], v[28:31]
    s_cbranch_vccnz Lw434
    s_waitcnt vmcnt(4)
Lw434:
    s_waitcnt vmcnt(6)
    buffer_load_dwordx4 v[200:203], v5, s[12:15], s43 offen offset:2048 nt
    v_and_b32_dpp v12, v42, v8 row_newbcast:12 row_mask:0xf bank_mask:0xf
    v_and_b32_dpp v13, v42, v9 row_newbcast:12 row_mask:0xf bank_mask:0xf
    v_and_b32_dpp v14, v42, v10 row_newbcast:12 row_mask:0xf bank_mask:0xf
    v_and_b32_dpp v15, v42, v11 row_newbcast:12 row_mask:0xf bank_mask:0xf
    v_mfma_f32_16x16x32_bf16 v[28:31], v[16:19], v[172:175], v[28:31]
    s_cbranch_vccnz Lw435
    s_waitcnt vmcnt(4)
Lw435:
    s_waitcnt vmcnt(6)
    buffer_load_dwordx4 v[204:207], v5, s[12:15], s43 offen offset:3072 nt
    v_mov_b32 v59, 107
    ds_write_b32 v60, v59 offset:22528
    v_and_b32_dpp v16, v42, v8 row_newbcast:13 row_mask:0xf bank_mask:0xf
    v_and_b32_dpp v17, v42, v9 row_newbcast:13 row_mask:0xf bank_mask:0xf
    v_and_b32_dpp v18, v42, v10 row_newbcast:13 row_mask:0xf bank_mask:0xf
    v_and_b32_dpp v19, v42, v11 row_newbcast:13 row_mask:0xf bank_mask:0xf
    v_mfma_f32_16x16x32_bf16 v[28:31], v[12:15], v[176:179], v[28:31]
    s_cbranch_vccnz Lw436
    s_waitcnt vmcnt(4)
Lw436:
    s_waitcnt vmcnt(6)
    s_add_u32 s43, s42, 724992
    s_and_b32 s43, s43, 0xfffff
    buffer_load_dwordx4 v[208:211], v5, s[12:15], s43 offen offset:0 nt
    v_and_b32_dpp v12, v42, v8 row_newbcast:14 row_mask:0xf bank_mask:0xf
    v_and_b32_dpp v13, v42, v9 row_newbcast:14 row_mask:0xf bank_mask:0xf
    v_and_b32_dpp v14, v42, v10 row_newbcast:14 row_mask:0xf bank_mask:0xf
    v_and_b32_dpp v15, v42, v11 row_newbcast:14 row_mask:0xf bank_mask:0xf
    v_mfma_f32_16x16x32_bf16 v[28:31], v[16:19], v[180:183], v[28:31]
    s_cbranch_vccnz Lw437
    s_waitcnt vmcnt(4)
Lw437:
    s_waitcnt vmcnt(6)
    buffer_load_dwordx4 v[212:215], v5, s[12:15], s43 offen offset:1024 nt
    s_waitcnt lgkmcnt(0)
    v_readfirstlane_b32 s67, v61
    s_cmp_lg_u32 s67, 0
    s_cselect_b64 vcc, -1, 0
    v_and_b32_dpp v16, v42, v8 row_newbcast:15 row_mask:0xf bank_mask:0xf
    v_and_b32_dpp v17, v42, v9 row_newbcast:15 row_mask:0xf bank_mask:0xf
    v_and_b32_dpp v18, v42, v10 row_newbcast:15 row_mask:0xf bank_mask:0xf
    v_and_b32_dpp v19, v42, v11 row_newbcast:15 row_mask:0xf bank_mask:0xf
    v_mfma_f32_16x16x32_bf16 v[28:31], v[12:15], v[184:187], v[28:31]
    s_cbranch_vccnz Lw438
    s_waitcnt vmcnt(4)
Lw438:
    s_waitcnt vmcnt(6)
    buffer_load_dwordx4 v[216:219], v5, s[12:15], s43 offen offset:2048 nt
    v_and_b32_dpp v12, v43, v8 row_newbcast:0 row_mask:0xf bank_mask:0xf
    v_and_b32_dpp v13, v43, v9 row_newbcast:0 row_mask:0xf bank_mask:0xf
    v_and_b32_dpp v14, v43, v10 row_newbcast:0 row_mask:0xf bank_mask:0xf
    v_and_b32_dpp v15, v43, v11 row_newbcast:0 row_mask:0xf bank_mask:0xf
    v_mfma_f32_16x16x32_bf16 v[28:31], v[16:19], v[188:191], v[28:31]
    s_cbranch_vccnz Lw439
    s_waitcnt vmcnt(4)
Lw439:
    s_waitcnt vmcnt(6)
    buffer_load_dwordx4 v[220:223], v5, s[12:15], s43 offen offset:3072 nt
    v_mov_b32 v59, 108
    ds_write_b32 v60, v59 offset:22528
    v_and_b32_dpp v16, v43, v8 row_newbcast:1 row_mask:0xf bank_mask:0xf
    v_and_b32_dpp v17, v43, v9 row_newbcast:1 row_mask:0xf bank_mask:0xf
    v_and_b32_dpp v18, v43, v10 row_newbcast:1 row_mask:0xf bank_mask:0xf
    v_and_b32_dpp v19, v43, v11 row_newbcast:1 row_mask:0xf bank_mask:0xf
    v_mfma_f32_16x16x32_bf16 v[28:31], v[12:15], v[192:195], v[28:31]
    s_cbranch_vccnz Lw440
    s_waitcnt vmcnt(4)
Lw440:
    s_waitcnt vmcnt(6)
    s_add_u32 s43, s42, 753664
    s_and_b32 s43, s43, 0xfffff
    buffer_load_dwordx4 v[224:227], v5, s[12:15], s43 offen offset:0 nt
    v_and_b32_dpp v12, v43, v8 row_newbcast:2 row_mask:0xf bank_mask:0xf
    v_and_b32_dpp v13, v43, v9 row_newbcast:2 row_mask:0xf bank_mask:0xf
    v_and_b32_dpp v14, v43, v10 row_newbcast:2 row_mask:0xf bank_mask:0xf
    v_and_b32_dpp v15, v43, v11 row_newbcast:2 row_mask:0xf bank_mask:0xf
    v_mfma_f32_16x16x32_bf16 v[28:31], v[16:19], v[196:199], v[28:31]
    s_cbranch_vccnz Lw441
    s_waitcnt vmcnt(4)
Lw441:
    s_waitcnt vmcnt(6)
    buffer_load_dwordx4 v[228:231], v5, s[12:15], s43 offen offset:1024 nt
    ds_read_b32 v61, v62 offset:22544
    v_and_b32_dpp v16, v43, v8 row_newbcast:3 row_mask:0xf bank_mask:0xf
    v_and_b32_dpp v17, v43, v9 row_newbcast:3 row_mask:0xf bank_mask:0xf
    v_and_b32_dpp v18, v43, v10 row_newbcast:3 row_mask:0xf bank_mask:0xf
    v_and_b32_dpp v19, v43, v11 row_newbcast:3 row_mask:0xf bank_mask:0xf
    v_mfma_f32_16x16x32_bf16 v[28:31], v[12:15], v[200:203], v[28:31]
    s_cbranch_vccnz Lw442
    s_waitcnt vmcnt(4)
Lw442:
    s_waitcnt vmcnt(6)
    buffer_load_dwordx4 v[232:235], v5, s[12:15], s43 offen offset:2048 nt
    v_and_b32_dpp v12, v43, v8 row_newbcast:4 row_mask:0xf bank_mask:0xf
    v_and_b32_dpp v13, v43, v9 row_newbcast:4 row_mask:0xf bank_mask:0xf
    v_and_b32_dpp v14, v43, v10 row_newbcast:4 row_mask:0xf bank_mask:0xf
    v_and_b32_dpp v15, v43, v11 row_newbcast:4 row_mask:0xf bank_mask:0xf
    v_mfma_f32_16x16x32_bf16 v[28:31], v[16:19], v[204:207], v[28:31]
    s_cbranch_vccnz Lw443
    s_waitcnt vmcnt(4)
Lw443:
    s_waitcnt vmcnt(6)
    buffer_load_dwordx4 v[236:239], v5, s[12:15], s43 offen offset:3072 nt
    v_mov_b32 v59, 109
    ds_write_b32 v60, v59 offset:22528
    v_and_b32_dpp v16, v43, v8 row_newbcast:5 row_mask:0xf bank_mask:0xf
    v_and_b32_dpp v17, v43, v9 row_newbcast:5 row_mask:0xf bank_mask:0xf
    v_and_b32_dpp v18, v43, v10 row_newbcast:5 row_mask:0xf bank_mask:0xf
    v_and_b32_dpp v19, v43, v11 row_newbcast:5 row_mask:0xf bank_mask:0xf
    v_mfma_f32_16x16x32_bf16 v[28:31], v[12:15], v[208:211], v[28:31]
    v_sub_f32 v58, v44, v48
    v_mul_f32 v58, 0x3fb8aa3b, v58
    v_exp_f32 v58, v58
    s_nop 0
    v_add_f32 v49, v49, v58
    v_cvt_pk_bf16_f32 v44, v58, v58
    s_cbranch_vccnz Lw444
    s_waitcnt vmcnt(4)
Lw444:
    s_waitcnt vmcnt(6)
    s_add_u32 s43, s42, 757760
    s_and_b32 s43, s43, 0xfffff
    buffer_load_dwordx4 v[240:243], v5, s[12:15], s43 offen offset:0 nt
    v_and_b32_dpp v12, v43, v8 row_newbcast:6 row_mask:0xf bank_mask:0xf
    v_and_b32_dpp v13, v43, v9 row_newbcast:6 row_mask:0xf bank_mask:0xf
    v_and_b32_dpp v14, v43, v10 row_newbcast:6 row_mask:0xf bank_mask:0xf
    v_and_b32_dpp v15, v43, v11 row_newbcast:6 row_mask:0xf bank_mask:0xf
    v_mfma_f32_16x16x32_bf16 v[28:31], v[16:19], v[212:215], v[28:31]
    s_cbranch_vccnz Lw445
    s_waitcnt vmcnt(4)
Lw445:
    s_waitcnt vmcnt(6)
    buffer_load_dwordx4 v[244:247], v5, s[12:15], s43 offen offset:1024 nt
    s_waitcnt lgkmcnt(0)
    v_readfirstlane_b32 s67, v61
    s_cmp_lg_u32 s67, 0
    s_cselect_b64 vcc, -1, 0
    v_and_b32_dpp v16, v43, v8 row_newbcast:7 row_mask:0xf bank_mask:0xf
    v_and_b32_dpp v17, v43, v9 row_newbcast:7 row_mask:0xf bank_mask:0xf
    v_and_b32_dpp v18, v43, v10 row_newbcast:7 row_mask:0xf bank_mask:0xf
    v_and_b32_dpp v19, v43, v11 row_newbcast:7 row_mask:0xf bank_mask:0xf
    v_mfma_f32_16x16x32_bf16 v[28:31], v[12:15], v[216:219], v[28:31]
    s_cbranch_vccnz Lw446
    s_waitcnt vmcnt(4)
Lw446:
    s_waitcnt vmcnt(6)
    buffer_load_dwordx4 v[248:251], v5, s[12:15], s43 offen offset:2048 nt
    v_and_b32_dpp v12, v43, v8 row_newbcast:8 row_mask:0xf bank_mask:0xf
    v_and_b32_dpp v13, v43, v9 row_newbcast:8 row_mask:0xf bank_mask:0xf
    v_and_b32_dpp v14, v43, v10 row_newbcast:8 row_mask:0xf bank_mask:0xf
    v_and_b32_dpp v15, v43, v11 row_newbcast:8 row_mask:0xf bank_mask:0xf
    v_mfma_f32_16x16x32_bf16 v[28:31], v[16:19], v[220:223], v[28:31]
    s_cbranch_vccnz Lw447
    s_waitcnt vmcnt(4)
Lw447:
    s_waitcnt vmcnt(6)
    buffer_load_dwordx4 v[252:255], v5, s[12:15], s43 offen offset:3072 nt
    v_mov_b32 v59, 110
    ds_write_b32 v60, v59 offset:22528
    v_and_b32_dpp v16, v43, v8 row_newbcast:9 row_mask:0xf bank_mask:0xf
    v_and_b32_dpp v17, v43, v9 row_newbcast:9 row_mask:0xf bank_mask:0xf
    v_and_b32_dpp v18, v43, v10 row_newbcast:9 row_mask:0xf bank_mask:0xf
    v_and_b32_dpp v19, v43, v11 row_newbcast:9 row_mask:0xf bank_mask:0xf
    v_mfma_f32_16x16x32_bf16 v[28:31], v[12:15], v[224:227], v[28:31]
    s_cbranch_vccnz Lw448
    s_waitcnt vmcnt(4)
Lw448:
    s_waitcnt vmcnt(6)
    s_add_u32 s43, s42, 786432
    s_and_b32 s43, s43, 0xfffff
    buffer_load_dwordx4 v[128:131], v5, s[12:15], s43 offen offset:0 nt
    v_and_b32_dpp v12, v43, v8 row_newbcast:10 row_mask:0xf bank_mask:0xf
    v_and_b32_dpp v13, v43, v9 row_newbcast:10 row_mask:0xf bank_mask:0xf
    v_and_b32_dpp v14, v43, v10 row_newbcast:10 row_mask:0xf bank_mask:0xf
    v_and_b32_dpp v15, v43, v11 row_newbcast:10 row_mask:0xf bank_mask:0xf
    v_mfma_f32_16x16x32_bf16 v[28:31], v[16:19], v[228:231], v[28:31]
    s_cbranch_vccnz Lw449
    s_waitcnt vmcnt(4)
Lw449:
    s_waitcnt vmcnt(6)
    buffer_load_dwordx4 v[132:135], v5, s[12:15], s43 offen offset:1024 nt
    ds_read_b32 v61, v62 offset:22544
    v_and_b32_dpp v16, v43, v8 row_newbcast:11 row_mask:0xf bank_mask:0xf
    v_and_b32_dpp v17, v43, v9 row_newbcast:11 row_mask:0xf bank_mask:0xf
    v_and_b32_dpp v18, v43, v10 row_newbcast:11 row_mask:0xf bank_mask:0xf
    v_and_b32_dpp v19, v43, v11 row_newbcast:11 row_mask:0xf bank_mask:0xf
    v_mfma_f32_16x16x32_bf16 v[28:31], v[12:15], v[232:235], v[28:31]
    s_cbranch_vccnz Lw450
    s_waitcnt vmcnt(4)
Lw450:
    s_waitcnt vmcnt(6)
    buffer_load_dwordx4 v[136:139], v5, s[12:15], s43 offen offset:2048 nt
    v_and_b32_dpp v12, v43, v8 row_newbcast:12 row_mask:0xf bank_mask:0xf
    v_and_b32_dpp v13, v43, v9 row_newbcast:12 row_mask:0xf bank_mask:0xf
    v_and_b32_dpp v14, v43, v10 row_newbcast:12 row_mask:0xf bank_mask:0xf
    v_and_b32_dpp v15, v43, v11 row_newbcast:12 row_mask:0xf bank_mask:0xf
    v_mfma_f32_16x16x32_bf16 v[28:31], v[16:19], v[236:239], v[28:31]
    s_cbranch_vccnz Lw451
    s_waitcnt vmcnt(4)
Lw451:
    s_waitcnt vmcnt(6)
    buffer_load_dwordx4 v[140:143], v5, s[12:15], s43 offen offset:3072 nt
    v_mov_b32 v59, 111
    ds_write_b32 v60, v59 offset:22528
    v_and_b32_dpp v16, v43, v8 row_newbcast:13 row_mask:0xf bank_mask:0xf
    v_and_b32_dpp v17, v43, v9 row_newbcast:13 row_mask:0xf bank_mask:0xf
    v_and_b32_dpp v18, v43, v10 row_newbcast:13 row_mask:0xf bank_mask:0xf
    v_and_b32_dpp v19, v43, v11 row_newbcast:13 row_mask:0xf bank_mask:0xf
    v_mfma_f32_16x16x32_bf16 v[28:31], v[12:15], v[240:243], v[28:31]
    s_cbranch_vccnz Lw452
    s_waitcnt vmcnt(4)
Lw452:
    s_waitcnt vmcnt(6)
    s_add_u32 s43, s42, 790528
    s_and_b32 s43, s43, 0xfffff
    buffer_load_dwordx4 v[144:147], v5, s[12:15], s43 offen offset:0 nt
    v_and_b32_dpp v12, v43, v8 row_newbcast:14 row_mask:0xf bank_mask:0xf
    v_and_b32_dpp v13, v43, v9 row_newbcast:14 row_mask:0xf bank_mask:0xf
    v_and_b32_dpp v14, v43, v10 row_newbcast:14 row_mask:0xf bank_mask:0xf
    v_and_b32_dpp v15, v43, v11 row_newbcast:14 row_mask:0xf bank_mask:0xf
    v_mfma_f32_16x16x32_bf16 v[28:31], v[16:19], v[244:247], v[28:31]
    s_cbranch_vccnz Lw453
    s_waitcnt vmcnt(4)
Lw453:
    s_waitcnt vmcnt(6)
    buffer_load_dwordx4 v[148:151], v5, s[12:15], s43 offen offset:1024 nt
    s_waitcnt lgkmcnt(0)
    v_readfirstlane_b32 s67, v61
    s_cmp_lg_u32 s67, 0
    s_cselect_b64 vcc, -1, 0
    v_and_b32_dpp v16, v43, v8 row_newbcast:15 row_mask:0xf bank_mask:0xf
    v_and_b32_dpp v17, v43, v9 row_newbcast:15 row_mask:0xf bank_mask:0xf
    v_and_b32_dpp v18, v43, v10 row_newbcast:15 row_mask:0xf bank_mask:0xf
    v_and_b32_dpp v19, v43, v11 row_newbcast:15 row_mask:0xf bank_mask:0xf
    v_mfma_f32_16x16x32_bf16 v[28:31], v[12:15], v[248:251], v[28:31]
    s_cbranch_vccnz Lw454
    s_waitcnt vmcnt(4)
Lw454:
    s_waitcnt vmcnt(6)
    buffer_load_dwordx4 v[152:155], v5, s[12:15], s43 offen offset:2048 nt
    v_and_b32_dpp v12, v44, v8 row_newbcast:0 row_mask:0xf bank_mask:0xf
    v_and_b32_dpp v13, v44, v9 row_newbcast:0 row_mask:0xf bank_mask:0xf
    v_and_b32_dpp v14, v44, v10 row_newbcast:0 row_mask:0xf bank_mask:0xf
    v_and_b32_dpp v15, v44, v11 row_newbcast:0 row_mask:0xf bank_mask:0xf
    v_mfma_f32_16x16x32_bf16 v[28:31], v[16:19], v[252:255], v[28:31]
    s_cbranch_vccnz Lw455
    s_waitcnt vmcnt(4)
Lw455:
    s_waitcnt vmcnt(6)
    buffer_load_dwordx4 v[156:159], v5, s[12:15], s43 offen offset:3072 nt
    v_mov_b32 v59, 112
    ds_write_b32 v60, v59 offset:22528
    v_and_b32_dpp v16, v44, v8 row_newbcast:1 row_mask:0xf bank_mask:0xf
    v_and_b32_dpp v17, v44, v9 row_newbcast:1 row_mask:0xf bank_mask:0xf
    v_and_b32_dpp v18, v44, v10 row_newbcast:1 row_mask:0xf bank_mask:0xf
    v_and_b32_dpp v19, v44, v11 row_newbcast:1 row_mask:0xf bank_mask:0xf
    v_mfma_f32_16x16x32_bf16 v[28:31], v[12:15], v[128:131], v[28:31]
    s_cbranch_vccnz Lw456
    s_waitcnt vmcnt(4)
Lw456:
    s_waitcnt vmcnt(6)
    s_add_u32 s43, s42, 819200
    s_and_b32 s43, s43, 0xfffff
    buffer_load_dwordx4 v[160:163], v5, s[12:15], s43 offen offset:0 nt
    v_and_b32_dpp v12, v44, v8 row_newbcast:2 row_mask:0xf bank_mask:0xf
    v_and_b32_dpp v13, v44, v9 row_newbcast:2 row_mask:0xf bank_mask:0xf
    v_and_b32_dpp v14, v44, v10 row_newbcast:2 row_mask:0xf bank_mask:0xf
    v_and_b32_dpp v15, v44, v11 row_newbcast:2 row_mask:0xf bank_mask:0xf
    v_mfma_f32_16x16x32_bf16 v[28:31], v[16:19], v[132:135], v[28:31]
    s_cbranch_vccnz Lw457
    s_waitcnt vmcnt(4)
Lw457:
    s_waitcnt vmcnt(6)
    buffer_load_dwordx4 v[164:167], v5, s[12:15], s43 offen offset:1024 nt
    ds_read_b32 v61, v62 offset:22544
    v_and_b32_dpp v16, v44, v8 row_newbcast:3 row_mask:0xf bank_mask:0xf
    v_and_b32_dpp v17, v44, v9 row_newbcast:3 row_mask:0xf bank_mask:0xf
    v_and_b32_dpp v18, v44, v10 row_newbcast:3 row_mask:0xf bank_mask:0xf
    v_and_b32_dpp v19, v44, v11 row_newbcast:3 row_mask:0xf bank_mask:0xf
    v_mfma_f32_16x16x32_bf16 v[28:31], v[12:15], v[136:139], v[28:31]
    s_cbranch_vccnz Lw458
    s_waitcnt vmcnt(4)
Lw458:
    s_waitcnt vmcnt(6)
    buffer_load_dwordx4 v[168:171], v5, s[12:15], s43 offen offset:2048 nt
    v_and_b32_dpp v12, v44, v8 row_newbcast:4 row_mask:0xf bank_mask:0xf
    v_and_b32_dpp v13, v44, v9 row_newbcast:4 row_mask:0xf bank_mask:0xf
    v_and_b32_dpp v14, v44, v10 row_newbcast:4 row_mask:0xf bank_mask:0xf
    v_and_b32_dpp v15, v44, v11 row_newbcast:4 row_mask:0xf bank_mask:0xf
    v_mfma_f32_16x16x32_bf16 v[28:31], v[16:19], v[140:143], v[28:31]
    s_cbranch_vccnz Lw459
    s_waitcnt vmcnt(4)
Lw459:
    s_waitcnt vmcnt(6)
    buffer_load_dwordx4 v[172:175], v5, s[12:15], s43 offen offset:3072 nt
    v_mov_b32 v59, 113
    ds_write_b32 v60, v59 offset:22528
    v_and_b32_dpp v16, v44, v8 row_newbcast:5 row_mask:0xf bank_mask:0xf
    v_and_b32_dpp v17, v44, v9 row_newbcast:5 row_mask:0xf bank_mask:0xf
    v_and_b32_dpp v18, v44, v10 row_newbcast:5 row_mask:0xf bank_mask:0xf
    v_and_b32_dpp v19, v44, v11 row_newbcast:5 row_mask:0xf bank_mask:0xf
    v_mfma_f32_16x16x32_bf16 v[28:31], v[12:15], v[144:147], v[28:31]
    v_sub_f32 v58, v45, v48
    v_mul_f32 v58, 0x3fb8aa3b, v58
    v_exp_f32 v58, v58
    s_nop 0
    v_add_f32 v49, v49, v58
    v_cvt_pk_bf16_f32 v45, v58, v58
    s_cbranch_vccnz Lw460
    s_waitcnt vmcnt(4)
Lw460:
    s_waitcnt vmcnt(6)
    s_add_u32 s43, s42, 823296
    s_and_b32 s43, s43, 0xfffff
    buffer_load_dwordx4 v[176:179], v5, s[12:15], s43 offen offset:0 nt
    v_and_b32_dpp v12, v44, v8 row_newbcast:6 row_mask:0xf bank_mask:0xf
    v_and_b32_dpp v13, v44, v9 row_newbcast:6 row_mask:0xf bank_mask:0xf
    v_and_b32_dpp v14, v44, v10 row_newbcast:6 row_mask:0xf bank_mask:0xf
    v_and_b32_dpp v15, v44, v11 row_newbcast:6 row_mask:0xf bank_mask:0xf
    v_mfma_f32_16x16x32_bf16 v[28:31], v[16:19], v[148:151], v[28:31]
    s_cbranch_vccnz Lw461
    s_waitcnt vmcnt(4)
Lw461:
    s_waitcnt vmcnt(6)
    buffer_load_dwordx4 v[180:183], v5, s[12:15], s43 offen offset:1024 nt
    s_waitcnt lgkmcnt(0)
    v_readfirstlane_b32 s67, v61
    s_cmp_lg_u32 s67, 0
    s_cselect_b64 vcc, -1, 0
    v_and_b32_dpp v16, v44, v8 row_newbcast:7 row_mask:0xf bank_mask:0xf
    v_and_b32_dpp v17, v44, v9 row_newbcast:7 row_mask:0xf bank_mask:0xf
    v_and_b32_dpp v18, v44, v10 row_newbcast:7 row_mask:0xf bank_mask:0xf
    v_and_b32_dpp v19, v44, v11 row_newbcast:7 row_mask:0xf bank_mask:0xf
    v_mfma_f32_16x16x32_bf16 v[28:31], v[12:15], v[152:155], v[28:31]
    s_cbranch_vccnz Lw462
    s_waitcnt vmcnt(4)
Lw462:
    s_waitcnt vmcnt(6)
    buffer_load_dwordx4 v[184:187], v5, s[12:15], s43 offen offset:2048 nt
    v_and_b32_dpp v12, v44, v8 row_newbcast:8 row_mask:0xf bank_mask:0xf
    v_and_b32_dpp v13, v44, v9 row_newbcast:8 row_mask:0xf bank_mask:0xf
    v_and_b32_dpp v14, v44, v10 row_newbcast:8 row_mask:0xf bank_mask:0xf
    v_and_b32_dpp v15, v44, v11 row_newbcast:8 row_mask:0xf bank_mask:0xf
    v_mfma_f32_16x16x32_bf16 v[28:31], v[16:19], v[156:159], v[28:31]
    s_cbranch_vccnz Lw463
    s_waitcnt vmcnt(4)
Lw463:
    s_waitcnt vmcnt(6)
    buffer_load_dwordx4 v[188:191], v5, s[12:15], s43 offen offset:3072 nt
    v_mov_b32 v59, 114
    ds_write_b32 v60, v59 offset:22528
    v_and_b32_dpp v16, v44, v8 row_newbcast:9 row_mask:0xf bank_mask:0xf
    v_and_b32_dpp v17, v44, v9 row_newbcast:9 row_mask:0xf bank_mask:0xf
    v_and_b32_dpp v18, v44, v10 row_newbcast:9 row_mask:0xf bank_mask:0xf
    v_and_b32_dpp v19, v44, v11 row_newbcast:9 row_mask:0xf bank_mask:0xf
    v_mfma_f32_16x16x32_bf16 v[28:31], v[12:15], v[160:163], v[28:31]
    s_cbranch_vccnz Lw464
    s_waitcnt vmcnt(4)
Lw464:
    s_waitcnt vmcnt(6)
    s_add_u32 s43, s42, 851968
    s_and_b32 s43, s43, 0xfffff
    buffer_load_dwordx4 v[192:195], v5, s[12:15], s43 offen offset:0 nt
    v_and_b32_dpp v12, v44, v8 row_newbcast:10 row_mask:0xf bank_mask:0xf
    v_and_b32_dpp v13, v44, v9 row_newbcast:10 row_mask:0xf bank_mask:0xf
    v_and_b32_dpp v14, v44, v10 row_newbcast:10 row_mask:0xf bank_mask:0xf
    v_and_b32_dpp v15, v44, v11 row_newbcast:10 row_mask:0xf bank_mask:0xf
    v_mfma_f32_16x16x32_bf16 v[28:31], v[16:19], v[164:167], v[28:31]
    s_cbranch_vccnz Lw465
    s_waitcnt vmcnt(4)
Lw465:
    s_waitcnt vmcnt(6)
    buffer_load_dwordx4 v[196:199], v5, s[12:15], s43 offen offset:1024 nt
    ds_read_b32 v61, v62 offset:22544
    v_and_b32_dpp v16, v44, v8 row_newbcast:11 row_mask:0xf bank_mask:0xf
    v_and_b32_dpp v17, v44, v9 row_newbcast:11 row_mask:0xf bank_mask:0xf
    v_and_b32_dpp v18, v44, v10 row_newbcast:11 row_mask:0xf bank_mask:0xf
    v_and_b32_dpp v19, v44, v11 row_newbcast:11 row_mask:0xf bank_mask:0xf
    v_mfma_f32_16x16x32_bf16 v[28:31], v[12:15], v[168:171], v[28:31]
    s_cbranch_vccnz Lw466
    s_waitcnt vmcnt(4)
Lw466:
    s_waitcnt vmcnt(6)
    buffer_load_dwordx4 v[200:203], v5, s[12:15], s43 offen offset:2048 nt
    v_and_b32_dpp v12, v44, v8 row_newbcast:12 row_mask:0xf bank_mask:0xf
    v_and_b32_dpp v13, v44, v9 row_newbcast:12 row_mask:0xf bank_mask:0xf
    v_and_b32_dpp v14, v44, v10 row_newbcast:12 row_mask:0xf bank_mask:0xf
    v_and_b32_dpp v15, v44, v11 row_newbcast:12 row_mask:0xf bank_mask:0xf
    v_mfma_f32_16x16x32_bf16 v[28:31], v[16:19], v[172:175], v[28:31]
    s_cbranch_vccnz Lw467
    s_waitcnt vmcnt(4)
Lw467:
    s_waitcnt vmcnt(6)
    buffer_load_dwordx4 v[204:207], v5, s[12:15], s43 offen offset:3072 nt
    v_mov_b32 v59, 115
    ds_write_b32 v60, v59 offset:22528
    v_and_b32_dpp v16, v44, v8 row_newbcast:13 row_mask:0xf bank_mask:0xf
    v_and_b32_dpp v17, v44, v9 row_newbcast:13 row_mask:0xf bank_mask:0xf
    v_and_b32_dpp v18, v44, v10 row_newbcast:13 row_mask:0xf bank_mask:0xf
    v_and_b32_dpp v19, v44, v11 row_newbcast:13 row_mask:0xf bank_mask:0xf
    v_mfma_f32_16x16x32_bf16 v[28:31], v[12:15], v[176:179], v[28:31]
    s_cbranch_vccnz Lw468
    s_waitcnt vmcnt(4)
Lw468:
    s_waitcnt vmcnt(6)
    s_add_u32 s43, s42, 856064
    s_and_b32 s43, s43, 0xfffff
    buffer_load_dwordx4 v[208:211], v5, s[12:15], s43 offen offset:0 nt
    v_and_b32_dpp v12, v44, v8 row_newbcast:14 row_mask:0xf bank_mask:0xf
    v_and_b32_dpp v13, v44, v9 row_newbcast:14 row_mask:0xf bank_mask:0xf
    v_and_b32_dpp v14, v44, v10 row_newbcast:14 row_mask:0xf bank_mask:0xf
    v_and_b32_dpp v15, v44, v11 row_newbcast:14 row_mask:0xf bank_mask:0xf
    v_mfma_f32_16x16x32_bf16 v[28:31], v[16:19], v[180:183], v[28:31]
    s_cbranch_vccnz Lw469
    s_waitcnt vmcnt(4)
Lw469:
    s_waitcnt vmcnt(6)
    buffer_load_dwordx4 v[212:215], v5, s[12:15], s43 offen offset:1024 nt
    s_waitcnt lgkmcnt(0)
    v_readfirstlane_b32 s67, v61
    s_cmp_lg_u32 s67, 0
    s_cselect_b64 vcc, -1, 0
    v_and_b32_dpp v16, v44, v8 row_newbcast:15 row_mask:0xf bank_mask:0xf
    v_and_b32_dpp v17, v44, v9 row_newbcast:15 row_mask:0xf bank_mask:0xf
    v_and_b32_dpp v18, v44, v10 row_newbcast:15 row_mask:0xf bank_mask:0xf
    v_and_b32_dpp v19, v44, v11 row_newbcast:15 row_mask:0xf bank_mask:0xf
    v_mfma_f32_16x16x32_bf16 v[28:31], v[12:15], v[184:187], v[28:31]
    s_cbranch_vccnz Lw470
    s_waitcnt vmcnt(4)
Lw470:
    s_waitcnt vmcnt(6)
    buffer_load_dwordx4 v[216:219], v5, s[12:15], s43 offen offset:2048 nt
    v_and_b32_dpp v12, v45, v8 row_newbcast:0 row_mask:0xf bank_mask:0xf
    v_and_b32_dpp v13, v45, v9 row_newbcast:0 row_mask:0xf bank_mask:0xf
    v_and_b32_dpp v14, v45, v10 row_newbcast:0 row_mask:0xf bank_mask:0xf
    v_and_b32_dpp v15, v45, v11 row_newbcast:0 row_mask:0xf bank_mask:0xf
    v_mfma_f32_16x16x32_bf16 v[28:31], v[16:19], v[188:191], v[28:31]
    s_cbranch_vccnz Lw471
    s_waitcnt vmcnt(4)
Lw471:
    s_waitcnt vmcnt(6)
    buffer_load_dwordx4 v[220:223], v5, s[12:15], s43 offen offset:3072 nt
    v_mov_b32 v59, 116
    ds_write_b32 v60, v59 offset:22528
    v_and_b32_dpp v16, v45, v8 row_newbcast:1 row_mask:0xf bank_mask:0xf
    v_and_b32_dpp v17, v45, v9 row_newbcast:1 row_mask:0xf bank_mask:0xf
    v_and_b32_dpp v18, v45, v10 row_newbcast:1 row_mask:0xf bank_mask:0xf
    v_and_b32_dpp v19, v45, v11 row_newbcast:1 row_mask:0xf bank_mask:0xf
    v_mfma_f32_16x16x32_bf16 v[28:31], v[12:15], v[192:195], v[28:31]
    s_cbranch_vccnz Lw472
    s_waitcnt vmcnt(4)
Lw472:
    s_waitcnt vmcnt(6)
    s_add_u32 s43, s42, 884736
    s_and_b32 s43, s43, 0xfffff
    buffer_load_dwordx4 v[224:227], v5, s[12:15], s43 offen offset:0 nt
    v_and_b32_dpp v12, v45, v8 row_newbcast:2 row_mask:0xf bank_mask:0xf
    v_and_b32_dpp v13, v45, v9 row_newbcast:2 row_mask:0xf bank_mask:0xf
    v_and_b32_dpp v14, v45, v10 row_newbcast:2 row_mask:0xf bank_mask:0xf
    v_and_b32_dpp v15, v45, v11 row_newbcast:2 row_mask:0xf bank_mask:0xf
    v_mfma_f32_16x16x32_bf16 v[28:31], v[16:19], v[196:199], v[28:31]
    s_cbranch_vccnz Lw473
    s_waitcnt vmcnt(4)
Lw473:
    s_waitcnt vmcnt(6)
    buffer_load_dwordx4 v[228:231], v5, s[12:15], s43 offen offset:1024 nt
    ds_read_b32 v61, v62 offset:22544
    v_and_b32_dpp v16, v45, v8 row_newbcast:3 row_mask:0xf bank_mask:0xf
    v_and_b32_dpp v17, v45, v9 row_newbcast:3 row_mask:0xf bank_mask:0xf
    v_and_b32_dpp v18, v45, v10 row_newbcast:3 row_mask:0xf bank_mask:0xf
    v_and_b32_dpp v19, v45, v11 row_newbcast:3 row_mask:0xf bank_mask:0xf
    v_mfma_f32_16x16x32_bf16 v[28:31], v[12:15], v[200:203], v[28:31]
    s_cbranch_vccnz Lw474
    s_waitcnt vmcnt(4)
Lw474:
    s_waitcnt vmcnt(6)
    buffer_load_dwordx4 v[232:235], v5, s[12:15], s43 offen offset:2048 nt
    v_and_b32_dpp v12, v45, v8 row_newbcast:4 row_mask:0xf bank_mask:0xf
    v_and_b32_dpp v13, v45, v9 row_newbcast:4 row_mask:0xf bank_mask:0xf
    v_and_b32_dpp v14, v45, v10 row_newbcast:4 row_mask:0xf bank_mask:0xf
    v_and_b32_dpp v15, v45, v11 row_newbcast:4 row_mask:0xf bank_mask:0xf
    v_mfma_f32_16x16x32_bf16 v[28:31], v[16:19], v[204:207], v[28:31]
    s_cbranch_vccnz Lw475
    s_waitcnt vmcnt(4)
Lw475:
    s_waitcnt vmcnt(6)
    buffer_load_dwordx4 v[236:239], v5, s[12:15], s43 offen offset:3072 nt
    v_mov_b32 v59, 117
    ds_write_b32 v60, v59 offset:22528
    v_and_b32_dpp v16, v45, v8 row_newbcast:5 row_mask:0xf bank_mask:0xf
    v_and_b32_dpp v17, v45, v9 row_newbcast:5 row_mask:0xf bank_mask:0xf
    v_and_b32_dpp v18, v45, v10 row_newbcast:5 row_mask:0xf bank_mask:0xf
    v_and_b32_dpp v19, v45, v11 row_newbcast:5 row_mask:0xf bank_mask:0xf
    v_mfma_f32_16x16x32_bf16 v[28:31], v[12:15], v[208:211], v[28:31]
    v_sub_f32 v58, v46, v48
    v_mul_f32 v58, 0x3fb8aa3b, v58
    v_exp_f32 v58, v58
    s_nop 0
    v_add_f32 v49, v49, v58
    v_cvt_pk_bf16_f32 v46, v58, v58
    s_cbranch_vccnz Lw476
    s_waitcnt vmcnt(4)
Lw476:
    s_waitcnt vmcnt(6)
    s_add_u32 s43, s42, 888832
    s_and_b32 s43, s43, 0xfffff
    buffer_load_dwordx4 v[240:243], v5, s[12:15], s43 offen offset:0 nt
    v_and_b32_dpp v12, v45, v8 row_newbcast:6 row_mask:0xf bank_mask:0xf
    v_and_b32_dpp v13, v45, v9 row_newbcast:6 row_mask:0xf bank_mask:0xf
    v_and_b32_dpp v14, v45, v10 row_newbcast:6 row_mask:0xf bank_mask:0xf
    v_and_b32_dpp v15, v45, v11 row_newbcast:6 row_mask:0xf bank_mask:0xf
    v_mfma_f32_16x16x32_bf16 v[28:31], v[16:19], v[212:215], v[28:31]
    s_cbranch_vccnz Lw477
    s_waitcnt vmcnt(4)
Lw477:
    s_waitcnt vmcnt(6)
    buffer_load_dwordx4 v[244:247], v5, s[12:15], s43 offen offset:1024 nt
    s_waitcnt lgkmcnt(0)
    v_readfirstlane_b32 s67, v61
    s_cmp_lg_u32 s67, 0
    s_cselect_b64 vcc, -1, 0
    v_and_b32_dpp v16, v45, v8 row_newbcast:7 row_mask:0xf bank_mask:0xf
    v_and_b32_dpp v17, v45, v9 row_newbcast:7 row_mask:0xf bank_mask:0xf
    v_and_b32_dpp v18, v45, v10 row_newbcast:7 row_mask:0xf bank_mask:0xf
    v_and_b32_dpp v19, v45, v11 row_newbcast:7 row_mask:0xf bank_mask:0xf
    v_mfma_f32_16x16x32_bf16 v[28:31], v[12:15], v[216:219], v[28:31]
    s_cbranch_vccnz Lw478
    s_waitcnt vmcnt(4)
Lw478:
    s_waitcnt vmcnt(6)
    buffer_load_dwordx4 v[248:251], v5, s[12:15], s43 offen offset:2048 nt
    v_and_b32_dpp v12, v45, v8 row_newbcast:8 row_mask:0xf bank_mask:0xf
    v_and_b32_dpp v13, v45, v9 row_newbcast:8 row_mask:0xf bank_mask:0xf
    v_and_b32_dpp v14, v45, v10 row_newbcast:8 row_mask:0xf bank_mask:0xf
    v_and_b32_dpp v15, v45, v11 row_newbcast:8 row_mask:0xf bank_mask:0xf
    v_mfma_f32_16x16x32_bf16 v[28:31], v[16:19], v[220:223], v[28:31]
    s_cbranch_vccnz Lw479
    s_waitcnt vmcnt(4)
Lw479:
    s_waitcnt vmcnt(6)
    buffer_load_dwordx4 v[252:255], v5, s[12:15], s43 offen offset:3072 nt
    v_mov_b32 v59, 118
    ds_write_b32 v60, v59 offset:22528
    v_and_b32_dpp v16, v45, v8 row_newbcast:9 row_mask:0xf bank_mask:0xf
    v_and_b32_dpp v17, v45, v9 row_newbcast:9 row_mask:0xf bank_mask:0xf
    v_and_b32_dpp v18, v45, v10 row_newbcast:9 row_mask:0xf bank_mask:0xf
    v_and_b32_dpp v19, v45, v11 row_newbcast:9 row_mask:0xf bank_mask:0xf
    v_mfma_f32_16x16x32_bf16 v[28:31], v[12:15], v[224:227], v[28:31]
    s_cbranch_vccnz Lw480
    s_waitcnt vmcnt(4)
Lw480:
    s_waitcnt vmcnt(6)
    s_add_u32 s43, s42, 917504
    s_and_b32 s43, s43, 0xfffff
    buffer_load_dwordx4 v[128:131], v5, s[12:15], s43 offen offset:0 nt
    v_and_b32_dpp v12, v45, v8 row_newbcast:10 row_mask:0xf bank_mask:0xf
    v_and_b32_dpp v13, v45, v9 row_newbcast:10 row_mask:0xf bank_mask:0xf
    v_and_b32_dpp v14, v45, v10 row_newbcast:10 row_mask:0xf bank_mask:0xf
    v_and_b32_dpp v15, v45, v11 row_newbcast:10 row_mask:0xf bank_mask:0xf
    v_mfma_f32_16x16x32_bf16 v[28:31], v[16:19], v[228:231], v[28:31]
    s_cbranch_vccnz Lw481
    s_waitcnt vmcnt(4)
Lw481:
    s_waitcnt vmcnt(6)
    buffer_load_dwordx4 v[132:135], v5, s[12:15], s43 offen offset:1024 nt
    ds_read_b32 v61, v62 offset:22544
    v_and_b32_dpp v16, v45, v8 row_newbcast:11 row_mask:0xf bank_mask:0xf
    v_and_b32_dpp v17, v45, v9 row_newbcast:11 row_mask:0xf bank_mask:0xf
    v_and_b32_dpp v18, v45, v10 row_newbcast:11 row_mask:0xf bank_mask:0xf
    v_and_b32_dpp v19, v45, v11 row_newbcast:11 row_mask:0xf bank_mask:0xf
    v_mfma_f32_16x16x32_bf16 v[28:31], v[12:15], v[232:235], v[28:31]
    s_cbranch_vccnz Lw482
    s_waitcnt vmcnt(4)
Lw482:
    s_waitcnt vmcnt(6)
    buffer_load_dwordx4 v[136:139], v5, s[12:15], s43 offen offset:2048 nt
    v_and_b32_dpp v12, v45, v8 row_newbcast:12 row_mask:0xf bank_mask:0xf
    v_and_b32_dpp v13, v45, v9 row_newbcast:12 row_mask:0xf bank_mask:0xf
    v_and_b32_dpp v14, v45, v10 row_newbcast:12 row_mask:0xf bank_mask:0xf
    v_and_b32_dpp v15, v45, v11 row_newbcast:12 row_mask:0xf bank_mask:0xf
    v_mfma_f32_16x16x32_bf16 v[28:31], v[16:19], v[236:239], v[28:31]
    s_cbranch_vccnz Lw483
    s_waitcnt vmcnt(4)
Lw483:
    s_waitcnt vmcnt(6)
    buffer_load_dwordx4 v[140:143], v5, s[12:15], s43 offen offset:3072 nt
    v_mov_b32 v59, 119
    ds_write_b32 v60, v59 offset:22528
    v_and_b32_dpp v16, v45, v8 row_newbcast:13 row_mask:0xf bank_mask:0xf
    v_and_b32_dpp v17, v45, v9 row_newbcast:13 row_mask:0xf bank_mask:0xf
    v_and_b32_dpp v18, v45, v10 row_newbcast:13 row_mask:0xf bank_mask:0xf
    v_and_b32_dpp v19, v45, v11 row_newbcast:13 row_mask:0xf bank_mask:0xf
    v_mfma_f32_16x16x32_bf16 v[28:31], v[12:15], v[240:243], v[28:31]
    s_cbranch_vccnz Lw484
    s_waitcnt vmcnt(4)
Lw484:
    s_waitcnt vmcnt(6)
    s_add_u32 s43, s42, 921600
    s_and_b32 s43, s43, 0xfffff
    buffer_load_dwordx4 v[144:147], v5, s[12:15], s43 offen offset:0 nt
    v_and_b32_dpp v12, v45, v8 row_newbcast:14 row_mask:0xf bank_mask:0xf
    v_and_b32_dpp v13, v45, v9 row_newbcast:14 row_mask:0xf bank_mask:0xf
    v_and_b32_dpp v14, v45, v10 row_newbcast:14 row_mask:0xf bank_mask:0xf
    v_and_b32_dpp v15, v45, v11 row_newbcast:14 row_mask:0xf bank_mask:0xf
    v_mfma_f32_16x16x32_bf16 v[28:31], v[16:19], v[244:247], v[28:31]
    s_cbranch_vccnz Lw485
    s_waitcnt vmcnt(4)
Lw485:
    s_waitcnt vmcnt(6)
    buffer_load_dwordx4 v[148:151], v5, s[12:15], s43 offen offset:1024 nt
    s_waitcnt lgkmcnt(0)
    v_readfirstlane_b32 s67, v61
    s_cmp_lg_u32 s67, 0
    s_cselect_b64 vcc, -1, 0
    v_and_b32_dpp v16, v45, v8 row_newbcast:15 row_mask:0xf bank_mask:0xf
    v_and_b32_dpp v17, v45, v9 row_newbcast:15 row_mask:0xf bank_mask:0xf
    v_and_b32_dpp v18, v45, v10 row_newbcast:15 row_mask:0xf bank_mask:0xf
    v_and_b32_dpp v19, v45, v11 row_newbcast:15 row_mask:0xf bank_mask:0xf
    v_mfma_f32_16x16x32_bf16 v[28:31], v[12:15], v[248:251], v[28:31]
    s_cbranch_vccnz Lw486
    s_waitcnt vmcnt(4)
Lw486:
    s_waitcnt vmcnt(6)
    buffer_load_dwordx4 v[152:155], v5, s[12:15], s43 offen offset:2048 nt
    v_and_b32_dpp v12, v46, v8 row_newbcast:0 row_mask:0xf bank_mask:0xf
    v_and_b32_dpp v13, v46, v9 row_newbcast:0 row_mask:0xf bank_mask:0xf
    v_and_b32_dpp v14, v46, v10 row_newbcast:0 row_mask:0xf bank_mask:0xf
    v_and_b32_dpp v15, v46, v11 row_newbcast:0 row_mask:0xf bank_mask:0xf
    v_mfma_f32_16x16x32_bf16 v[28:31], v[16:19], v[252:255], v[28:31]
    s_cbranch_vccnz Lw487
    s_waitcnt vmcnt(4)
Lw487:
    s_waitcnt vmcnt(6)
    buffer_load_dwordx4 v[156:159], v5, s[12:15], s43 offen offset:3072 nt
    v_mov_b32 v59, 120
    ds_write_b32 v60, v59 offset:22528
    v_and_b32_dpp v16, v46, v8 row_newbcast:1 row_mask:0xf bank_mask:0xf
    v_and_b32_dpp v17, v46, v9 row_newbcast:1 row_mask:0xf bank_mask:0xf
    v_and_b32_dpp v18, v46, v10 row_newbcast:1 row_mask:0xf bank_mask:0xf
    v_and_b32_dpp v19, v46, v11 row_newbcast:1 row_mask:0xf bank_mask:0xf
    v_mfma_f32_16x16x32_bf16 v[28:31], v[12:15], v[128:131], v[28:31]
    s_cbranch_vccnz Lw488
    s_waitcnt vmcnt(4)
Lw488:
    s_waitcnt vmcnt(6)
    s_add_u32 s43, s42, 950272
    s_and_b32 s43, s43, 0xfffff
    buffer_load_dwordx4 v[160:163], v5, s[12:15], s43 offen offset:0 nt
    v_and_b32_dpp v12, v46, v8 row_newbcast:2 row_mask:0xf bank_mask:0xf
    v_and_b32_dpp v13, v46, v9 row_newbcast:2 row_mask:0xf bank_mask:0xf
    v_and_b32_dpp v14, v46, v10 row_newbcast:2 row_mask:0xf bank_mask:0xf
    v_and_b32_dpp v15, v46, v11 row_newbcast:2 row_mask:0xf bank_mask:0xf
    v_mfma_f32_16x16x32_bf16 v[28:31], v[16:19], v[132:135], v[28:31]
    s_cbranch_vccnz Lw489
    s_waitcnt vmcnt(4)
Lw489:
    s_waitcnt vmcnt(6)
    buffer_load_dwordx4 v[164:167], v5, s[12:15], s43 offen offset:1024 nt
    ds_read_b32 v61, v62 offset:22544
    v_and_b32_dpp v16, v46, v8 row_newbcast:3 row_mask:0xf bank_mask:0xf
    v_and_b32_dpp v17, v46, v9 row_newbcast:3 row_mask:0xf bank_mask:0xf
    v_and_b32_dpp v18, v46, v10 row_newbcast:3 row_mask:0xf bank_mask:0xf
    v_and_b32_dpp v19, v46, v11 row_newbcast:3 row_mask:0xf bank_mask:0xf
    v_mfma_f32_16x16x32_bf16 v[28:31], v[12:15], v[136:139], v[28:31]
    s_cbranch_vccnz Lw490
    s_waitcnt vmcnt(4)
Lw490:
    s_waitcnt vmcnt(6)
    buffer_load_dwordx4 v[168:171], v5, s[12:15], s43 offen offset:2048 nt
    v_and_b32_dpp v12, v46, v8 row_newbcast:4 row_mask:0xf bank_mask:0xf
    v_and_b32_dpp v13, v46, v9 row_newbcast:4 row_mask:0xf bank_mask:0xf
    v_and_b32_dpp v14, v46, v10 row_newbcast:4 row_mask:0xf bank_mask:0xf
    v_and_b32_dpp v15, v46, v11 row_newbcast:4 row_mask:0xf bank_mask:0xf
    v_mfma_f32_16x16x32_bf16 v[28:31], v[16:19], v[140:143], v[28:31]
    s_cbranch_vccnz Lw491
    s_waitcnt vmcnt(4)
Lw491:
    s_waitcnt vmcnt(6)
    buffer_load_dwordx4 v[172:175], v5, s[12:15], s43 offen offset:3072 nt
    v_mov_b32 v59, 121
    ds_write_b32 v60, v59 offset:22528
    v_and_b32_dpp v16, v46, v8 row_newbcast:5 row_mask:0xf bank_mask:0xf
    v_and_b32_dpp v17, v46, v9 row_newbcast:5 row_mask:0xf bank_mask:0xf
    v_and_b32_dpp v18, v46, v10 row_newbcast:5 row_mask:0xf bank_mask:0xf
    v_and_b32_dpp v19, v46, v11 row_newbcast:5 row_mask:0xf bank_mask:0xf
    v_mfma_f32_16x16x32_bf16 v[28:31], v[12:15], v[144:147], v[28:31]
    v_sub_f32 v58, v47, v48
    v_mul_f32 v58, 0x3fb8aa3b, v58
    v_exp_f32 v58, v58
    s_nop 0
    v_add_f32 v49, v49, v58
    v_cvt_pk_bf16_f32 v47, v58, v58
    s_cbranch_vccnz Lw492
    s_waitcnt vmcnt(4)
Lw492:
    s_waitcnt vmcnt(6)
    s_add_u32 s43, s42, 954368
    s_and_b32 s43, s43, 0xfffff
    buffer_load_dwordx4 v[176:179], v5, s[12:15], s43 offen offset:0 nt
    v_and_b32_dpp v12, v46, v8 row_newbcast:6 row_mask:0xf bank_mask:0xf
    v_and_b32_dpp v13, v46, v9 row_newbcast:6 row_mask:0xf bank_mask:0xf
    v_and_b32_dpp v14, v46, v10 row_newbcast:6 row_mask:0xf bank_mask:0xf
    v_and_b32_dpp v15, v46, v11 row_newbcast:6 row_mask:0xf bank_mask:0xf
    v_mfma_f32_16x16x32_bf16 v[28:31], v[16:19], v[148:151], v[28:31]
    s_cbranch_vccnz Lw493
    s_waitcnt vmcnt(4)
Lw493:
    s_waitcnt vmcnt(6)
    buffer_load_dwordx4 v[180:183], v5, s[12:15], s43 offen offset:1024 nt
    s_waitcnt lgkmcnt(0)
    v_readfirstlane_b32 s67, v61
    s_cmp_lg_u32 s67, 0
    s_cselect_b64 vcc, -1, 0
    v_and_b32_dpp v16, v46, v8 row_newbcast:7 row_mask:0xf bank_mask:0xf
    v_and_b32_dpp v17, v46, v9 row_newbcast:7 row_mask:0xf bank_mask:0xf
    v_and_b32_dpp v18, v46, v10 row_newbcast:7 row_mask:0xf bank_mask:0xf
    v_and_b32_dpp v19, v46, v11 row_newbcast:7 row_mask:0xf bank_mask:0xf
    v_mfma_f32_16x16x32_bf16 v[28:31], v[12:15], v[152:155], v[28:31]
    s_cbranch_vccnz Lw494
    s_waitcnt vmcnt(4)
Lw494:
    s_waitcnt vmcnt(6)
    buffer_load_dwordx4 v[184:187], v5, s[12:15], s43 offen offset:2048 nt
    v_and_b32_dpp v12, v46, v8 row_newbcast:8 row_mask:0xf bank_mask:0xf
    v_and_b32_dpp v13, v46, v9 row_newbcast:8 row_mask:0xf bank_mask:0xf
    v_and_b32_dpp v14, v46, v10 row_newbcast:8 row_mask:0xf bank_mask:0xf
    v_and_b32_dpp v15, v46, v11 row_newbcast:8 row_mask:0xf bank_mask:0xf
    v_mfma_f32_16x16x32_bf16 v[28:31], v[16:19], v[156:159], v[28:31]
    s_cbranch_vccnz Lw495
    s_waitcnt vmcnt(4)
Lw495:
    s_waitcnt vmcnt(6)
    buffer_load_dwordx4 v[188:191], v5, s[12:15], s43 offen offset:3072 nt
    v_mov_b32 v59, 122
    ds_write_b32 v60, v59 offset:22528
    v_and_b32_dpp v16, v46, v8 row_newbcast:9 row_mask:0xf bank_mask:0xf
    v_and_b32_dpp v17, v46, v9 row_newbcast:9 row_mask:0xf bank_mask:0xf
    v_and_b32_dpp v18, v46, v10 row_newbcast:9 row_mask:0xf bank_mask:0xf
    v_and_b32_dpp v19, v46, v11 row_newbcast:9 row_mask:0xf bank_mask:0xf
    v_mfma_f32_16x16x32_bf16 v[28:31], v[12:15], v[160:163], v[28:31]
    s_cbranch_vccnz Lw496
    s_waitcnt vmcnt(4)
Lw496:
    s_waitcnt vmcnt(6)
    s_add_u32 s43, s42, 983040
    s_and_b32 s43, s43, 0xfffff
    buffer_load_dwordx4 v[192:195], v5, s[12:15], s43 offen offset:0 nt
    v_and_b32_dpp v12, v46, v8 row_newbcast:10 row_mask:0xf bank_mask:0xf
    v_and_b32_dpp v13, v46, v9 row_newbcast:10 row_mask:0xf bank_mask:0xf
    v_and_b32_dpp v14, v46, v10 row_newbcast:10 row_mask:0xf bank_mask:0xf
    v_and_b32_dpp v15, v46, v11 row_newbcast:10 row_mask:0xf bank_mask:0xf
    v_mfma_f32_16x16x32_bf16 v[28:31], v[16:19], v[164:167], v[28:31]
    s_cbranch_vccnz Lw497
    s_waitcnt vmcnt(4)
Lw497:
    s_waitcnt vmcnt(6)
    buffer_load_dwordx4 v[196:199], v5, s[12:15], s43 offen offset:1024 nt
    ds_read_b32 v61, v62 offset:22544
    v_and_b32_dpp v16, v46, v8 row_newbcast:11 row_mask:0xf bank_mask:0xf
    v_and_b32_dpp v17, v46, v9 row_newbcast:11 row_mask:0xf bank_mask:0xf
    v_and_b32_dpp v18, v46, v10 row_newbcast:11 row_mask:0xf bank_mask:0xf
    v_and_b32_dpp v19, v46, v11 row_newbcast:11 row_mask:0xf bank_mask:0xf
    v_mfma_f32_16x16x32_bf16 v[28:31], v[12:15], v[168:171], v[28:31]
    s_cbranch_vccnz Lw498
    s_waitcnt vmcnt(4)
Lw498:
    s_waitcnt vmcnt(6)
    buffer_load_dwordx4 v[200:203], v5, s[12:15], s43 offen offset:2048 nt
    v_and_b32_dpp v12, v46, v8 row_newbcast:12 row_mask:0xf bank_mask:0xf
    v_and_b32_dpp v13, v46, v9 row_newbcast:12 row_mask:0xf bank_mask:0xf
    v_and_b32_dpp v14, v46, v10 row_newbcast:12 row_mask:0xf bank_mask:0xf
    v_and_b32_dpp v15, v46, v11 row_newbcast:12 row_mask:0xf bank_mask:0xf
    v_mfma_f32_16x16x32_bf16 v[28:31], v[16:19], v[172:175], v[28:31]
    s_cbranch_vccnz Lw499
    s_waitcnt vmcnt(4)
Lw499:
    s_waitcnt vmcnt(6)
    buffer_load_dwordx4 v[204:207], v5, s[12:15], s43 offen offset:3072 nt
    v_mov_b32 v59, 123
    ds_write_b32 v60, v59 offset:22528
    v_and_b32_dpp v16, v46, v8 row_newbcast:13 row_mask:0xf bank_mask:0xf
    v_and_b32_dpp v17, v46, v9 row_newbcast:13 row_mask:0xf bank_mask:0xf
    v_and_b32_dpp v18, v46, v10 row_newbcast:13 row_mask:0xf bank_mask:0xf
    v_and_b32_dpp v19, v46, v11 row_newbcast:13 row_mask:0xf bank_mask:0xf
    v_mfma_f32_16x16x32_bf16 v[28:31], v[12:15], v[176:179], v[28:31]
    s_nop 1
    v_add_f32_dpp v49, v49, v49 row_ror:8 row_mask:0xf bank_mask:0xf
    s_nop 1
    v_add_f32_dpp v49, v49, v49 row_ror:4 row_mask:0xf bank_mask:0xf
    s_nop 1
    v_add_f32_dpp v49, v49, v49 row_ror:2 row_mask:0xf bank_mask:0xf
    s_nop 1
    v_add_f32_dpp v49, v49, v49 row_ror:1 row_mask:0xf bank_mask:0xf
    v_mov_b32 v50, v49
    s_nop 1
    v_permlane16_swap_b32 v49, v50
    s_nop 0
    v_add_f32 v49, v49, v50
    v_mov_b32 v50, v49
    s_nop 1
    v_permlane32_swap_b32 v49, v50
    s_nop 0
    v_add_f32 v49, v49, v50
    s_lshl_b32 s44, s3, 3
    v_mov_b32 v7, s44
    v_mov_b32 v50, v48
    v_mov_b32 v51, v49
    s_mov_b64 exec, 1
    ds_write_b64 v7, v[50:51] offset:11264
    s_mov_b64 exec, -1
    v_lshlrev_b32 v6, 5, v2
    v_lshl_add_u32 v6, v3, 4, v6
    s_lshl_b32 s44, s3, 9
    v_add_u32 v6, s44, v6
    s_cbranch_vccnz Lw500
    s_waitcnt vmcnt(4)
Lw500:
    s_waitcnt vmcnt(6)
    s_add_u32 s43, s42, 987136
    s_and_b32 s43, s43, 0xfffff
    buffer_load_dwordx4 v[208:211], v5, s[12:15], s43 offen offset:0 nt
    v_and_b32_dpp v12, v46, v8 row_newbcast:14 row_mask:0xf bank_mask:0xf
    v_and_b32_dpp v13, v46, v9 row_newbcast:14 row_mask:0xf bank_mask:0xf
    v_and_b32_dpp v14, v46, v10 row_newbcast:14 row_mask:0xf bank_mask:0xf
    v_and_b32_dpp v15, v46, v11 row_newbcast:14 row_mask:0xf bank_mask:0xf
    v_mfma_f32_16x16x32_bf16 v[28:31], v[16:19], v[180:183], v[28:31]
    s_cbranch_vccnz Lw501
    s_waitcnt vmcnt(4)
Lw501:
    s_waitcnt vmcnt(6)
    buffer_load_dwordx4 v[212:215], v5, s[12:15], s43 offen offset:1024 nt
    buffer_load_dwordx4 v[216:219], v5, s[12:15], s43 offen offset:2048 nt
    buffer_load_dwordx4 v[220:223], v5, s[12:15], s43 offen offset:3072 nt
    s_add_u32 s43, s42, 1015808
    s_and_b32 s43, s43, 0xfffff
    buffer_load_dwordx4 v[224:227], v5, s[12:15], s43 offen offset:0 nt
    buffer_load_dwordx4 v[228:231], v5, s[12:15], s43 offen offset:1024 nt
    s_waitcnt lgkmcnt(0)
    v_readfirstlane_b32 s67, v61
    s_cmp_lg_u32 s67, 0
    s_cselect_b64 vcc, -1, 0
    v_and_b32_dpp v16, v46, v8 row_newbcast:15 row_mask:0xf bank_mask:0xf
    v_and_b32_dpp v17, v46, v9 row_newbcast:15 row_mask:0xf bank_mask:0xf
    v_and_b32_dpp v18, v46, v10 row_newbcast:15 row_mask:0xf bank_mask:0xf
    v_and_b32_dpp v19, v46, v11 row_newbcast:15 row_mask:0xf bank_mask:0xf
    v_mfma_f32_16x16x32_bf16 v[28:31], v[12:15], v[184:187], v[28:31]
    buffer_load_dwordx4 v[232:235], v5, s[12:15], s43 offen offset:2048 nt
    v_and_b32_dpp v12, v47, v8 row_newbcast:0 row_mask:0xf bank_mask:0xf
    v_and_b32_dpp v13, v47, v9 row_newbcast:0 row_mask:0xf bank_mask:0xf
    v_and_b32_dpp v14, v47, v10 row_newbcast:0 row_mask:0xf bank_mask:0xf
    v_and_b32_dpp v15, v47, v11 row_newbcast:0 row_mask:0xf bank_mask:0xf
    s_waitcnt vmcnt(11)
    v_mfma_f32_16x16x32_bf16 v[28:31], v[16:19], v[188:191], v[28:31]
    buffer_load_dwordx4 v[236:239], v5, s[12:15], s43 offen offset:3072 nt
    v_mov_b32 v59, 124
    ds_write_b32 v60, v59 offset:22528
    v_and_b32_dpp v16, v47, v8 row_newbcast:1 row_mask:0xf bank_mask:0xf
    v_and_b32_dpp v17, v47, v9 row_newbcast:1 row_mask:0xf bank_mask:0xf
    v_and_b32_dpp v18, v47, v10 row_newbcast:1 row_mask:0xf bank_mask:0xf
    v_and_b32_dpp v19, v47, v11 row_newbcast:1 row_mask:0xf bank_mask:0xf
    s_waitcnt vmcnt(11)
    v_mfma_f32_16x16x32_bf16 v[28:31], v[12:15], v[192:195], v[28:31]
    s_add_u32 s43, s42, 1019904
    s_and_b32 s43, s43, 0xfffff
    buffer_load_dwordx4 v[240:243], v5, s[12:15], s43 offen offset:0 nt
    v_and_b32_dpp v12, v47, v8 row_newbcast:2 row_mask:0xf bank_mask:0xf
    v_and_b32_dpp v13, v47, v9 row_newbcast:2 row_mask:0xf bank_mask:0xf
    v_and_b32_dpp v14, v47, v10 row_newbcast:2 row_mask:0xf bank_mask:0xf
    v_and_b32_dpp v15, v47, v11 row_newbcast:2 row_mask:0xf bank_mask:0xf
    s_waitcnt vmcnt(11)
    v_mfma_f32_16x16x32_bf16 v[28:31], v[16:19], v[196:199], v[28:31]
    buffer_load_dwordx4 v[244:247], v5, s[12:15], s43 offen offset:1024 nt
    ds_read_b32 v61, v62 offset:22544
    v_and_b32_dpp v16, v47, v8 row_newbcast:3 row_mask:0xf bank_mask:0xf
    v_and_b32_dpp v17, v47, v9 row_newbcast:3 row_mask:0xf bank_mask:0xf
    v_and_b32_dpp v18, v47, v10 row_newbcast:3 row_mask:0xf bank_mask:0xf
    v_and_b32_dpp v19, v47, v11 row_newbcast:3 row_mask:0xf bank_mask:0xf
    s_waitcnt vmcnt(11)
    v_mfma_f32_16x16x32_bf16 v[28:31], v[12:15], v[200:203], v[28:31]
    buffer_load_dwordx4 v[248:251], v5, s[12:15], s43 offen offset:2048 nt
    v_and_b32_dpp v12, v47, v8 row_newbcast:4 row_mask:0xf bank_mask:0xf
    v_and_b32_dpp v13, v47, v9 row_newbcast:4 row_mask:0xf bank_mask:0xf
    v_and_b32_dpp v14, v47, v10 row_newbcast:4 row_mask:0xf bank_mask:0xf
    v_and_b32_dpp v15, v47, v11 row_newbcast:4 row_mask:0xf bank_mask:0xf
    s_waitcnt vmcnt(11)
    v_mfma_f32_16x16x32_bf16 v[28:31], v[16:19], v[204:207], v[28:31]
    buffer_load_dwordx4 v[252:255], v5, s[12:15], s43 offen offset:3072 nt
    v_mov_b32 v59, 125
    ds_write_b32 v60, v59 offset:22528
    v_and_b32_dpp v16, v47, v8 row_newbcast:5 row_mask:0xf bank_mask:0xf
    v_and_b32_dpp v17, v47, v9 row_newbcast:5 row_mask:0xf bank_mask:0xf
    v_and_b32_dpp v18, v47, v10 row_newbcast:5 row_mask:0xf bank_mask:0xf
    v_and_b32_dpp v19, v47, v11 row_newbcast:5 row_mask:0xf bank_mask:0xf
    s_waitcnt vmcnt(11)
    v_mfma_f32_16x16x32_bf16 v[28:31], v[12:15], v[208:211], v[28:31]
    v_and_b32_dpp v12, v47, v8 row_newbcast:6 row_mask:0xf bank_mask:0xf
    v_and_b32_dpp v13, v47, v9 row_newbcast:6 row_mask:0xf bank_mask:0xf
    v_and_b32_dpp v14, v47, v10 row_newbcast:6 row_mask:0xf bank_mask:0xf
    v_and_b32_dpp v15, v47, v11 row_newbcast:6 row_mask:0xf bank_mask:0xf
    s_waitcnt vmcnt(10)
    v_mfma_f32_16x16x32_bf16 v[28:31], v[16:19], v[212:215], v[28:31]
    s_waitcnt lgkmcnt(0)
    v_readfirstlane_b32 s67, v61
    s_cmp_lg_u32 s67, 0
    s_cselect_b64 vcc, -1, 0
    v_and_b32_dpp v16, v47, v8 row_newbcast:7 row_mask:0xf bank_mask:0xf
    v_and_b32_dpp v17, v47, v9 row_newbcast:7 row_mask:0xf bank_mask:0xf
    v_and_b32_dpp v18, v47, v10 row_newbcast:7 row_mask:0xf bank_mask:0xf
    v_and_b32_dpp v19, v47, v11 row_newbcast:7 row_mask:0xf bank_mask:0xf
    s_waitcnt vmcnt(9)
    v_mfma_f32_16x16x32_bf16 v[28:31], v[12:15], v[216:219], v[28:31]
    v_and_b32_dpp v12, v47, v8 row_newbcast:8 row_mask:0xf bank_mask:0xf
    v_and_b32_dpp v13, v47, v9 row_newbcast:8 row_mask:0xf bank_mask:0xf
    v_and_b32_dpp v14, v47, v10 row_newbcast:8 row_mask:0xf bank_mask:0xf
    v_and_b32_dpp v15, v47, v11 row_newbcast:8 row_mask:0xf bank_mask:0xf
    s_waitcnt vmcnt(8)
    v_mfma_f32_16x16x32_bf16 v[28:31], v[16:19], v[220:223], v[28:31]
    v_mov_b32 v59, 126
    ds_write_b32 v60, v59 offset:22528
    v_and_b32_dpp v16, v47, v8 row_newbcast:9 row_mask:0xf bank_mask:0xf
    v_and_b32_dpp v17, v47, v9 row_newbcast:9 row_mask:0xf bank_mask:0xf
    v_and_b32_dpp v18, v47, v10 row_newbcast:9 row_mask:0xf bank_mask:0xf
    v_and_b32_dpp v19, v47, v11 row_newbcast:9 row_mask:0xf bank_mask:0xf
    s_waitcnt vmcnt(7)
    v_mfma_f32_16x16x32_bf16 v[28:31], v[12:15], v[224:227], v[28:31]
    v_and_b32_dpp v12, v47, v8 row_newbcast:10 row_mask:0xf bank_mask:0xf
    v_and_b32_dpp v13, v47, v9 row_newbcast:10 row_mask:0xf bank_mask:0xf
    v_and_b32_dpp v14, v47, v10 row_newbcast:10 row_mask:0xf bank_mask:0xf
    v_and_b32_dpp v15, v47, v11 row_newbcast:10 row_mask:0xf bank_mask:0xf
    s_waitcnt vmcnt(6)
    v_mfma_f32_16x16x32_bf16 v[28:31], v[16:19], v[228:231], v[28:31]
    ds_read_b32 v61, v62 offset:22544
    v_and_b32_dpp v16, v47, v8 row_newbcast:11 row_mask:0xf bank_mask:0xf
    v_and_b32_dpp v17, v47, v9 row_newbcast:11 row_mask:0xf bank_mask:0xf
    v_and_b32_dpp v18, v47, v10 row_newbcast:11 row_mask:0xf bank_mask:0xf
    v_and_b32_dpp v19, v47, v11 row_newbcast:11 row_mask:0xf bank_mask:0xf
    s_waitcnt vmcnt(5)
    v_mfma_f32_16x16x32_bf16 v[28:31], v[12:15], v[232:235], v[28:31]
    v_and_b32_dpp v12, v47, v8 row_newbcast:12 row_mask:0xf bank_mask:0xf
    v_and_b32_dpp v13, v47, v9 row_newbcast:12 row_mask:0xf bank_mask:0xf
    v_and_b32_dpp v14, v47, v10 row_newbcast:12 row_mask:0xf bank_mask:0xf
    v_and_b32_dpp v15, v47, v11 row_newbcast:12 row_mask:0xf bank_mask:0xf
    s_waitcnt vmcnt(4)
    v_mfma_f32_16x16x32_bf16 v[28:31], v[16:19], v[236:239], v[28:31]
    v_mov_b32 v59, 127
    ds_write_b32 v60, v59 offset:22528
    v_and_b32_dpp v16, v47, v8 row_newbcast:13 row_mask:0xf bank_mask:0xf
    v_and_b32_dpp v17, v47, v9 row_newbcast:13 row_mask:0xf bank_mask:0xf
    v_and_b32_dpp v18, v47, v10 row_newbcast:13 row_mask:0xf bank_mask:0xf
    v_and_b32_dpp v19, v47, v11 row_newbcast:13 row_mask:0xf bank_mask:0xf
    s_waitcnt vmcnt(3)
    v_mfma_f32_16x16x32_bf16 v[28:31], v[12:15], v[240:243], v[28:31]
    v_and_b32_dpp v12, v47, v8 row_newbcast:14 row_mask:0xf bank_mask:0xf
    v_and_b32_dpp v13, v47, v9 row_newbcast:14 row_mask:0xf bank_mask:0xf
    v_and_b32_dpp v14, v47, v10 row_newbcast:14 row_mask:0xf bank_mask:0xf
    v_and_b32_dpp v15, v47, v11 row_newbcast:14 row_mask:0xf bank_mask:0xf
    s_waitcnt vmcnt(2)
    v_mfma_f32_16x16x32_bf16 v[28:31], v[16:19], v[244:247], v[28:31]
    s_waitcnt lgkmcnt(0)
    v_readfirstlane_b32 s67, v61
    s_cmp_lg_u32 s67, 0
    s_cselect_b64 vcc, -1, 0
    v_and_b32_dpp v16, v47, v8 row_newbcast:15 row_mask:0xf bank_mask:0xf
    v_and_b32_dpp v17, v47, v9 row_newbcast:15 row_mask:0xf bank_mask:0xf
    v_and_b32_dpp v18, v47, v10 row_newbcast:15 row_mask:0xf bank_mask:0xf
    v_and_b32_dpp v19, v47, v11 row_newbcast:15 row_mask:0xf bank_mask:0xf
    s_waitcnt vmcnt(1)
    v_mfma_f32_16x16x32_bf16 v[28:31], v[12:15], v[248:251], v[28:31]
    s_nop 1
    s_waitcnt vmcnt(0)
    v_mfma_f32_16x16x32_bf16 v[28:31], v[16:19], v[252:255], v[28:31]
    s_mov_b32 exec_hi, 0
    s_nop 6
    ds_write_b128 v6, v[28:31] offset:9216
    s_waitcnt lgkmcnt(0)
    s_barrier
    s_endpgm
L_aux:
    s_sub_u32 s42, s3, 4
    s_mul_i32 s43, s42, 160
    v_mul_u32_u24 v4, 40, v3
    v_add_u32 v4, s43, v4
    v_lshlrev_b32 v4, 13, v4
    v_lshl_add_u32 v4, v2, 4, v4
    v_lshlrev_b32 v5, 2, v0
    s_mul_i32 s6, s4, 1280
    s_lshl_b32 s7, s5, 8
    s_sub_u32 s44, 5242880, s7
    s_waitcnt lgkmcnt(0)
    s_add_u32 s8, s16, s6
    s_addc_u32 s9, s17, 0
    s_mov_b32 s10, 1280
    s_mov_b32 s11, 0x20000
    s_add_u32 s12, s22, s7
    s_addc_u32 s13, s23, 0
    s_mov_b32 s14, s44
    s_mov_b32 s15, 0x20000
    v_lshlrev_b32 v6, 3, v0
    buffer_load_dwordx2 v[48:49], v6, s[8:11], 0 offen
    buffer_load_dwordx2 v[50:51], v6, s[8:11], 0 offen offset:512
    buffer_load_dword v52, v5, s[8:11], 0 offen offset:1024
    s_lshl_b32 s45, s4, 15
    buffer_load_dwordx4 v[96:99], v4, s[12:15], s45 offen nt
    s_add_u32 s45, s45, 8192
    s_cmp_eq_u32 s45, 327680
    s_cselect_b32 s45, 0, s45
    buffer_load_dwordx4 v[100:103], v4, s[12:15], s45 offen nt
    s_add_u32 s45, s45, 8192
    s_cmp_eq_u32 s45, 327680
    s_cselect_b32 s45, 0, s45
    buffer_load_dwordx4 v[104:107], v4, s[12:15], s45 offen nt
    s_add_u32 s45, s45, 8192
    s_cmp_eq_u32 s45, 327680
    s_cselect_b32 s45, 0, s45
    buffer_load_dwordx4 v[108:111], v4, s[12:15], s45 offen nt
    s_add_u32 s45, s45, 8192
    s_cmp_eq_u32 s45, 327680
    s_cselect_b32 s45, 0, s45
    buffer_load_dwordx4 v[112:115], v4, s[12:15], s45 offen nt
    s_add_u32 s45, s45, 8192
    s_cmp_eq_u32 s45, 327680
    s_cselect_b32 s45, 0, s45
    buffer_load_dwordx4 v[116:119], v4, s[12:15], s45 offen nt
    s_add_u32 s45, s45, 8192
    s_cmp_eq_u32 s45, 327680
    s_cselect_b32 s45, 0, s45
    buffer_load_dwordx4 v[120:123], v4, s[12:15], s45 offen nt
    s_add_u32 s45, s45, 8192
    s_cmp_eq_u32 s45, 327680
    s_cselect_b32 s45, 0, s45
    buffer_load_dwordx4 v[124:127], v4, s[12:15], s45 offen nt
    s_add_u32 s45, s45, 8192
    s_cmp_eq_u32 s45, 327680
    s_cselect_b32 s45, 0, s45
    buffer_load_dwordx4 v[128:131], v4, s[12:15], s45 offen nt
    s_add_u32 s45, s45, 8192
    s_cmp_eq_u32 s45, 327680
    s_cselect_b32 s45, 0, s45
    buffer_load_dwordx4 v[132:135], v4, s[12:15], s45 offen nt
    s_add_u32 s45, s45, 8192
    s_cmp_eq_u32 s45, 327680
    s_cselect_b32 s45, 0, s45
    buffer_load_dwordx4 v[136:139], v4, s[12:15], s45 offen nt
    s_add_u32 s45, s45, 8192
    s_cmp_eq_u32 s45, 327680
    s_cselect_b32 s45, 0, s45
    buffer_load_dwordx4 v[140:143], v4, s[12:15], s45 offen nt
    s_add_u32 s45, s45, 8192
    s_cmp_eq_u32 s45, 327680
    s_cselect_b32 s45, 0, s45
    v_and_b32 v6, 1, v2
    v_cmp_eq_u32 vcc, 0, v6
    v_mov_b32 v60, 0x01000c0c
    v_mov_b32 v61, 0x0c0c0100
    v_cndmask_b32 v60, v60, v61, vcc
    v_mov_b32 v6, 0x03020c0c
    v_mov_b32 v61, 0x0c0c0302
    v_cndmask_b32 v61, v6, v61, vcc
    v_bfe_u32 v6, v2, 1, 2
    v_mov_b32 v7, 0x0c0c0c0c
    v_cmp_eq_u32 vcc, 0, v6
    s_nop 1
    v_cndmask_b32 v8, v7, v60, vcc
    v_cndmask_b32 v12, v7, v61, vcc
    v_cmp_eq_u32 vcc, 1, v6
    s_nop 1
    v_cndmask_b32 v9, v7, v60, vcc
    v_cndmask_b32 v13, v7, v61, vcc
    v_cmp_eq_u32 vcc, 2, v6
    s_nop 1
    v_cndmask_b32 v10, v7, v60, vcc
    v_cndmask_b32 v14, v7, v61, vcc
    v_cmp_eq_u32 vcc, 3, v6
    s_nop 1
    v_cndmask_b32 v11, v7, v60, vcc
    v_cndmask_b32 v15, v7, v61, vcc
    v_mov_b32 v24, 0
    v_mov_b32 v25, 0
    v_mov_b32 v26, 0
    v_mov_b32 v27, 0
    v_mov_b32 v28, 0
    v_mov_b32 v29, 0
    v_mov_b32 v30, 0
    v_mov_b32 v31, 0
    v_mov_b32 v32, 0
    v_mov_b32 v33, 0
    v_mov_b32 v34, 0
    v_mov_b32 v35, 0
    v_mov_b32 v36, 0
    v_mov_b32 v37, 0
    v_mov_b32 v38, 0
    v_mov_b32 v39, 0
    v_mov_b32 v40, 0
    v_mov_b32 v41, 0
    v_mov_b32 v42, 0
    v_mov_b32 v43, 0
    s_waitcnt vmcnt(12)
    v_lshlrev_b32 v53, 16, v48
    v_and_b32 v54, 0xffff0000, v48
    v_lshlrev_b32 v55, 16, v49
    v_and_b32 v56, 0xffff0000, v49
    buffer_load_dwordx4 v[144:147], v4, s[12:15], s45 offen nt
    s_add_u32 s45, s45, 8192
    s_cmp_eq_u32 s45, 327680
    s_cselect_b32 s45, 0, s45
    v_lshlrev_b32 v57, 16, v50
    v_and_b32 v58, 0xffff0000, v50
    v_lshlrev_b32 v59, 16, v51
    v_and_b32 v60, 0xffff0000, v51
    buffer_load_dwordx4 v[148:151], v4, s[12:15], s45 offen nt
    s_add_u32 s45, s45, 8192
    s_cmp_eq_u32 s45, 327680
    s_cselect_b32 s45, 0, s45
    v_lshlrev_b32 v61, 16, v52
    v_and_b32 v62, 0xffff0000, v52
    v_add_f32 v84, v53, v54
    v_add_f32 v84, v84, v55
    buffer_load_dwordx4 v[152:155], v4, s[12:15], s45 offen nt
    s_add_u32 s45, s45, 8192
    s_cmp_eq_u32 s45, 327680
    s_cselect_b32 s45, 0, s45
    v_add_f32 v84, v84, v56
    v_add_f32 v84, v84, v57
    v_add_f32 v84, v84, v58
    v_add_f32 v84, v84, v59
    buffer_load_dwordx4 v[156:159], v4, s[12:15], s45 offen nt
    s_add_u32 s45, s45, 8192
    s_cmp_eq_u32 s45, 327680
    s_cselect_b32 s45, 0, s45
    v_add_f32 v84, v84, v60
    v_add_f32 v84, v84, v61
    v_add_f32 v84, v84, v62
    s_nop 1
    buffer_load_dwordx4 v[160:163], v4, s[12:15], s45 offen nt
    s_add_u32 s45, s45, 8192
    s_cmp_eq_u32 s45, 327680
    s_cselect_b32 s45, 0, s45
    v_add_f32_dpp v84, v84, v84 row_ror:8 row_mask:0xf bank_mask:0xf
    s_nop 1
    v_add_f32_dpp v84, v84, v84 row_ror:4 row_mask:0xf bank_mask:0xf
    s_nop 1
    buffer_load_dwordx4 v[164:167], v4, s[12:15], s45 offen nt
    s_add_u32 s45, s45, 8192
    s_cmp_eq_u32 s45, 327680
    s_cselect_b32 s45, 0, s45
    v_add_f32_dpp v84, v84, v84 row_ror:2 row_mask:0xf bank_mask:0xf
    s_nop 1
    v_add_f32_dpp v84, v84, v84 row_ror:1 row_mask:0xf bank_mask:0xf
    v_mov_b32 v85, v84
    buffer_load_dwordx4 v[168:171], v4, s[12:15], s45 offen nt
    s_add_u32 s45, s45, 8192
    s_cmp_eq_u32 s45, 327680
    s_cselect_b32 s45, 0, s45
    s_nop 1
    v_permlane16_swap_b32 v84, v85
    s_nop 0
    v_add_f32 v84, v84, v85
    buffer_load_dwordx4 v[172:175], v4, s[12:15], s45 offen nt
    s_add_u32 s45, s45, 8192
    s_cmp_eq_u32 s45, 327680
    s_cselect_b32 s45, 0, s45
    v_mov_b32 v85, v84
    s_nop 1
    v_permlane32_swap_b32 v84, v85
    s_nop 0
    buffer_load_dwordx4 v[176:179], v4, s[12:15], s45 offen nt
    s_add_u32 s45, s45, 8192
    s_cmp_eq_u32 s45, 327680
    s_cselect_b32 s45, 0, s45
    v_add_f32 v84, v84, v85
    v_mul_f32 v86, 0x3acccccd, v84
    v_sub_f32 v85, v53, v86
    v_mul_f32 v84, v85, v85
    buffer_load_dwordx4 v[180:183], v4, s[12:15], s45 offen nt
    s_add_u32 s45, s45, 8192
    s_cmp_eq_u32 s45, 327680
    s_cselect_b32 s45, 0, s45
    v_sub_f32 v85, v54, v86
    v_fmac_f32 v84, v85, v85
    v_sub_f32 v85, v55, v86
    v_fmac_f32 v84, v85, v85
    buffer_load_dwordx4 v[184:187], v4, s[12:15], s45 offen nt
    s_add_u32 s45, s45, 8192
    s_cmp_eq_u32 s45, 327680
    s_cselect_b32 s45, 0, s45
    v_sub_f32 v85, v56, v86
    v_fmac_f32 v84, v85, v85
    v_sub_f32 v85, v57, v86
    v_fmac_f32 v84, v85, v85
    buffer_load_dwordx4 v[188:191], v4, s[12:15], s45 offen nt
    s_add_u32 s45, s45, 8192
    s_cmp_eq_u32 s45, 327680
    s_cselect_b32 s45, 0, s45
    v_sub_f32 v85, v58, v86
    v_fmac_f32 v84, v85, v85
    v_sub_f32 v85, v59, v86
    v_fmac_f32 v84, v85, v85
    buffer_load_dwordx4 v[192:195], v4, s[12:15], s45 offen nt
    s_add_u32 s45, s45, 8192
    s_cmp_eq_u32 s45, 327680
    s_cselect_b32 s45, 0, s45
    v_sub_f32 v85, v60, v86
    v_fmac_f32 v84, v85, v85
    v_sub_f32 v85, v61, v86
    v_fmac_f32 v84, v85, v85
    buffer_load_dwordx4 v[196:199], v4, s[12:15], s45 offen nt
    s_add_u32 s45, s45, 8192
    s_cmp_eq_u32 s45, 327680
    s_cselect_b32 s45, 0, s45
    v_sub_f32 v85, v62, v86
    v_fmac_f32 v84, v85, v85
    s_nop 1
    v_add_f32_dpp v84, v84, v84 row_ror:8 row_mask:0xf bank_mask:0xf
    buffer_load_dwordx4 v[200:203], v4, s[12:15], s45 offen nt
    s_add_u32 s45, s45, 8192
    s_cmp_eq_u32 s45, 327680
    s_cselect_b32 s45, 0, s45
    s_nop 1
    v_add_f32_dpp v84, v84, v84 row_ror:4 row_mask:0xf bank_mask:0xf
    s_nop 1
    v_add_f32_dpp v84, v84, v84 row_ror:2 row_mask:0xf bank_mask:0xf
    buffer_load_dwordx4 v[204:207], v4, s[12:15], s45 offen nt
    s_add_u32 s45, s45, 8192
    s_cmp_eq_u32 s45, 327680
    s_cselect_b32 s45, 0, s45
    s_nop 1
    v_add_f32_dpp v84, v84, v84 row_ror:1 row_mask:0xf bank_mask:0xf
    v_mov_b32 v85, v84
    s_nop 1
    buffer_load_dwordx4 v[208:211], v4, s[12:15], s45 offen nt
    s_add_u32 s45, s45, 8192
    s_cmp_eq_u32 s45, 327680
    s_cselect_b32 s45, 0, s45
    v_permlane16_swap_b32 v84, v85
    s_nop 0
    v_add_f32 v84, v84, v85
    v_mov_b32 v85, v84
    buffer_load_dwordx4 v[212:215], v4, s[12:15], s45 offen nt
    s_add_u32 s45, s45, 8192
    s_cmp_eq_u32 s45, 327680
    s_cselect_b32 s45, 0, s45
    s_nop 1
    v_permlane32_swap_b32 v84, v85
    s_nop 0
    v_add_f32 v84, v84, v85
    buffer_load_dwordx4 v[216:219], v4, s[12:15], s45 offen nt
    s_add_u32 s45, s45, 8192
    s_cmp_eq_u32 s45, 327680
    s_cselect_b32 s45, 0, s45
    v_mul_f32 v84, 0x3acccccd, v84
    v_cvt_pk_bf16_f32 v84, v84, v84
    v_and_b32 v84, 0xffff0000, v84
    v_add_f32 v84, 0x3727c5ac, v84
    buffer_load_dwordx4 v[220:223], v4, s[12:15], s45 offen nt
    s_add_u32 s45, s45, 8192
    s_cmp_eq_u32 s45, 327680
    s_cselect_b32 s45, 0, s45
    v_cvt_pk_bf16_f32 v84, v84, v84
    v_and_b32 v84, 0xffff0000, v84
    v_sqrt_f32 v84, v84
    s_nop 0
    buffer_load_dwordx4 v[224:227], v4, s[12:15], s45 offen nt
    s_add_u32 s45, s45, 8192
    s_cmp_eq_u32 s45, 327680
    s_cselect_b32 s45, 0, s45
    v_cvt_pk_bf16_f32 v84, v84, v84
    v_and_b32 v84, 0xffff0000, v84
    v_rcp_f32 v87, v84
    v_cvt_pk_bf16_f32 v86, v86, v86
    buffer_load_dwordx4 v[228:231], v4, s[12:15], s45 offen nt
    s_add_u32 s45, s45, 8192
    s_cmp_eq_u32 s45, 327680
    s_cselect_b32 s45, 0, s45
    v_and_b32 v86, 0xffff0000, v86
    v_sub_f32 v53, v53, v86
    v_sub_f32 v54, v54, v86
    v_cvt_pk_bf16_f32 v85, v53, v54
    buffer_load_dwordx4 v[232:235], v4, s[12:15], s45 offen nt
    s_add_u32 s45, s45, 8192
    s_cmp_eq_u32 s45, 327680
    s_cselect_b32 s45, 0, s45
    v_lshlrev_b32 v53, 16, v85
    v_and_b32 v54, 0xffff0000, v85
    v_mul_f32 v53, v53, v87
    v_mul_f32 v54, v54, v87
    buffer_load_dwordx4 v[236:239], v4, s[12:15], s45 offen nt
    s_add_u32 s45, s45, 8192
    s_cmp_eq_u32 s45, 327680
    s_cselect_b32 s45, 0, s45
    v_cvt_pk_bf16_f32 v48, v53, v54
    v_sub_f32 v55, v55, v86
    v_sub_f32 v56, v56, v86
    v_cvt_pk_bf16_f32 v85, v55, v56
    buffer_load_dwordx4 v[240:243], v4, s[12:15], s45 offen nt
    s_add_u32 s45, s45, 8192
    s_cmp_eq_u32 s45, 327680
    s_cselect_b32 s45, 0, s45
    v_lshlrev_b32 v55, 16, v85
    v_and_b32 v56, 0xffff0000, v85
    v_mul_f32 v55, v55, v87
    v_mul_f32 v56, v56, v87
    buffer_load_dwordx4 v[244:247], v4, s[12:15], s45 offen nt
    s_add_u32 s45, s45, 8192
    s_cmp_eq_u32 s45, 327680
    s_cselect_b32 s45, 0, s45
    v_cvt_pk_bf16_f32 v49, v55, v56
    v_sub_f32 v57, v57, v86
    v_sub_f32 v58, v58, v86
    v_cvt_pk_bf16_f32 v85, v57, v58
    buffer_load_dwordx4 v[248:251], v4, s[12:15], s45 offen nt
    s_add_u32 s45, s45, 8192
    s_cmp_eq_u32 s45, 327680
    s_cselect_b32 s45, 0, s45
    v_lshlrev_b32 v57, 16, v85
    v_and_b32 v58, 0xffff0000, v85
    v_mul_f32 v57, v57, v87
    v_mul_f32 v58, v58, v87
    buffer_load_dwordx4 v[252:255], v4, s[12:15], s45 offen nt
    v_cvt_pk_bf16_f32 v50, v57, v58
    v_sub_f32 v59, v59, v86
    v_sub_f32 v60, v60, v86
    v_cvt_pk_bf16_f32 v85, v59, v60
    v_lshlrev_b32 v59, 16, v85
    v_and_b32 v60, 0xffff0000, v85
    v_mul_f32 v59, v59, v87
    v_mul_f32 v60, v60, v87
    v_cvt_pk_bf16_f32 v51, v59, v60
    v_sub_f32 v61, v61, v86
    v_sub_f32 v62, v62, v86
    v_cvt_pk_bf16_f32 v85, v61, v62
    v_lshlrev_b32 v61, 16, v85
    v_and_b32 v62, 0xffff0000, v85
    v_mul_f32 v61, v61, v87
    v_mul_f32 v62, v62, v87
    v_cvt_pk_bf16_f32 v52, v61, v62
    s_barrier
    s_mul_i32 s43, s42, 1280
    v_lshlrev_b32 v5, 2, v0
    v_add_u32 v5, s43, v5
    v_lshlrev_b32 v6, 3, v0
    v_add_u32 v6, s43, v6
    ds_write_b64 v6, v[48:49] offset:0
    ds_write_b64 v6, v[50:51] offset:512
    ds_write_b32 v5, v52 offset:1024
    s_mul_i32 s43, s42, 1600
    v_mul_u32_u24 v5, 80, v3
    v_add_u32 v5, s43, v5
    s_lshl_b32 s46, s4, 3
    s_waitcnt lgkmcnt(0)
    v_add_u32 v6, s46, v5
    ds_read_b64 v[64:65], v6 offset:0
    s_add_u32 s46, s46, 8
    s_cmp_eq_u32 s46, 80
    s_cselect_b32 s46, 0, s46
    v_add_u32 v6, s46, v5
    ds_read_b64 v[66:67], v6 offset:0
    s_add_u32 s46, s46, 8
    s_cmp_eq_u32 s46, 80
    s_cselect_b32 s46, 0, s46
    v_add_u32 v6, s46, v5
    ds_read_b64 v[68:69], v6 offset:0
    s_add_u32 s46, s46, 8
    s_cmp_eq_u32 s46, 80
    s_cselect_b32 s46, 0, s46
    v_add_u32 v6, s46, v5
    ds_read_b64 v[70:71], v6 offset:0
    s_add_u32 s46, s46, 8
    s_cmp_eq_u32 s46, 80
    s_cselect_b32 s46, 0, s46
    v_add_u32 v6, s46, v5
    ds_read_b64 v[72:73], v6 offset:0
    s_add_u32 s46, s46, 8
    s_cmp_eq_u32 s46, 80
    s_cselect_b32 s46, 0, s46
    v_add_u32 v6, s46, v5
    ds_read_b64 v[74:75], v6 offset:0
    s_add_u32 s46, s46, 8
    s_cmp_eq_u32 s46, 80
    s_cselect_b32 s46, 0, s46
    v_add_u32 v6, s46, v5
    ds_read_b64 v[76:77], v6 offset:0
    s_add_u32 s46, s46, 8
    s_cmp_eq_u32 s46, 80
    s_cselect_b32 s46, 0, s46
    v_add_u32 v6, s46, v5
    ds_read_b64 v[78:79], v6 offset:0
    s_add_u32 s46, s46, 8
    s_cmp_eq_u32 s46, 80
    s_cselect_b32 s46, 0, s46
    v_add_u32 v6, s46, v5
    ds_read_b64 v[80:81], v6 offset:0
    s_add_u32 s46, s46, 8
    s_cmp_eq_u32 s46, 80
    s_cselect_b32 s46, 0, s46
    v_add_u32 v6, s46, v5
    ds_read_b64 v[82:83], v6 offset:0
    s_add_u32 s46, s46, 8
    s_cmp_eq_u32 s46, 80
    s_cselect_b32 s46, 0, s46
    s_waitcnt lgkmcnt(0)
    v_perm_b32 v16, v64, v64, v8
    v_perm_b32 v17, v64, v64, v9
    v_perm_b32 v18, v64, v64, v10
    v_perm_b32 v19, v64, v64, v11
    v_perm_b32 v20, v64, v64, v12
    v_perm_b32 v21, v64, v64, v13
    v_perm_b32 v22, v64, v64, v14
    v_perm_b32 v23, v64, v64, v15
    s_waitcnt vmcnt(39)
    v_mfma_f32_16x16x32_bf16 v[44:47], v[16:19], v[96:99], 0
    v_perm_b32 v16, v65, v65, v8
    v_perm_b32 v17, v65, v65, v9
    v_perm_b32 v18, v65, v65, v10
    v_perm_b32 v19, v65, v65, v11
    s_waitcnt vmcnt(38)
    v_mfma_f32_16x16x32_bf16 v[44:47], v[20:23], v[100:103], v[44:47]
    v_perm_b32 v20, v65, v65, v12
    v_perm_b32 v21, v65, v65, v13
    v_perm_b32 v22, v65, v65, v14
    v_perm_b32 v23, v65, v65, v15
    s_waitcnt vmcnt(37)
    v_mfma_f32_16x16x32_bf16 v[44:47], v[16:19], v[104:107], v[44:47]
    v_perm_b32 v16, v66, v66, v8
    v_perm_b32 v17, v66, v66, v9
    v_perm_b32 v18, v66, v66, v10
    v_perm_b32 v19, v66, v66, v11
    s_waitcnt vmcnt(36)
    v_mfma_f32_16x16x32_bf16 v[44:47], v[20:23], v[108:111], v[44:47]
    v_perm_b32 v20, v66, v66, v12
    v_perm_b32 v21, v66, v66, v13
    v_perm_b32 v22, v66, v66, v14
    v_perm_b32 v23, v66, v66, v15
    s_waitcnt vmcnt(35)
    v_mfma_f32_16x16x32_bf16 v[44:47], v[16:19], v[112:115], v[44:47]
    v_perm_b32 v16, v67, v67, v8
    v_perm_b32 v17, v67, v67, v9
    v_perm_b32 v18, v67, v67, v10
    v_perm_b32 v19, v67, v67, v11
    s_waitcnt vmcnt(34)
    v_mfma_f32_16x16x32_bf16 v[44:47], v[20:23], v[116:119], v[44:47]
    v_perm_b32 v20, v67, v67, v12
    v_perm_b32 v21, v67, v67, v13
    v_perm_b32 v22, v67, v67, v14
    v_perm_b32 v23, v67, v67, v15
    s_waitcnt vmcnt(33)
    v_mfma_f32_16x16x32_bf16 v[44:47], v[16:19], v[120:123], v[44:47]
    v_perm_b32 v16, v68, v68, v8
    v_perm_b32 v17, v68, v68, v9
    v_perm_b32 v18, v68, v68, v10
    v_perm_b32 v19, v68, v68, v11
    s_waitcnt vmcnt(32)
    v_mfma_f32_16x16x32_bf16 v[44:47], v[20:23], v[124:127], v[44:47]
    v_perm_b32 v20, v68, v68, v12
    v_perm_b32 v21, v68, v68, v13
    v_perm_b32 v22, v68, v68, v14
    v_perm_b32 v23, v68, v68, v15
    s_waitcnt vmcnt(31)
    v_mfma_f32_16x16x32_bf16 v[44:47], v[16:19], v[128:131], v[44:47]
    v_perm_b32 v16, v69, v69, v8
    v_perm_b32 v17, v69, v69, v9
    v_perm_b32 v18, v69, v69, v10
    v_perm_b32 v19, v69, v69, v11
    s_waitcnt vmcnt(30)
    v_mfma_f32_16x16x32_bf16 v[44:47], v[20:23], v[132:135], v[44:47]
    v_perm_b32 v20, v69, v69, v12
    v_perm_b32 v21, v69, v69, v13
    v_perm_b32 v22, v69, v69, v14
    v_perm_b32 v23, v69, v69, v15
    s_waitcnt vmcnt(29)
    v_mfma_f32_16x16x32_bf16 v[44:47], v[16:19], v[136:139], v[44:47]
    v_perm_b32 v16, v70, v70, v8
    v_perm_b32 v17, v70, v70, v9
    v_perm_b32 v18, v70, v70, v10
    v_perm_b32 v19, v70, v70, v11
    s_waitcnt vmcnt(28)
    v_mfma_f32_16x16x32_bf16 v[44:47], v[20:23], v[140:143], v[44:47]
    v_perm_b32 v20, v70, v70, v12
    v_perm_b32 v21, v70, v70, v13
    v_perm_b32 v22, v70, v70, v14
    v_perm_b32 v23, v70, v70, v15
    s_waitcnt vmcnt(27)
    v_mfma_f32_16x16x32_bf16 v[44:47], v[16:19], v[144:147], v[44:47]
    v_perm_b32 v16, v71, v71, v8
    v_perm_b32 v17, v71, v71, v9
    v_perm_b32 v18, v71, v71, v10
    v_perm_b32 v19, v71, v71, v11
    s_waitcnt vmcnt(26)
    v_mfma_f32_16x16x32_bf16 v[44:47], v[20:23], v[148:151], v[44:47]
    v_perm_b32 v20, v71, v71, v12
    v_perm_b32 v21, v71, v71, v13
    v_perm_b32 v22, v71, v71, v14
    v_perm_b32 v23, v71, v71, v15
    s_waitcnt vmcnt(25)
    v_mfma_f32_16x16x32_bf16 v[44:47], v[16:19], v[152:155], v[44:47]
    v_perm_b32 v16, v72, v72, v8
    v_perm_b32 v17, v72, v72, v9
    v_perm_b32 v18, v72, v72, v10
    v_perm_b32 v19, v72, v72, v11
    s_waitcnt vmcnt(24)
    v_mfma_f32_16x16x32_bf16 v[44:47], v[20:23], v[156:159], v[44:47]
    v_perm_b32 v20, v72, v72, v12
    v_perm_b32 v21, v72, v72, v13
    v_perm_b32 v22, v72, v72, v14
    v_perm_b32 v23, v72, v72, v15
    s_waitcnt vmcnt(23)
    v_mfma_f32_16x16x32_bf16 v[44:47], v[16:19], v[160:163], v[44:47]
    v_perm_b32 v16, v73, v73, v8
    v_perm_b32 v17, v73, v73, v9
    v_perm_b32 v18, v73, v73, v10
    v_perm_b32 v19, v73, v73, v11
    s_waitcnt vmcnt(22)
    v_mfma_f32_16x16x32_bf16 v[44:47], v[20:23], v[164:167], v[44:47]
    v_perm_b32 v20, v73, v73, v12
    v_perm_b32 v21, v73, v73, v13
    v_perm_b32 v22, v73, v73, v14
    v_perm_b32 v23, v73, v73, v15
    s_waitcnt vmcnt(21)
    v_mfma_f32_16x16x32_bf16 v[44:47], v[16:19], v[168:171], v[44:47]
    v_perm_b32 v16, v74, v74, v8
    v_perm_b32 v17, v74, v74, v9
    v_perm_b32 v18, v74, v74, v10
    v_perm_b32 v19, v74, v74, v11
    s_waitcnt vmcnt(20)
    v_mfma_f32_16x16x32_bf16 v[44:47], v[20:23], v[172:175], v[44:47]
    v_perm_b32 v20, v74, v74, v12
    v_perm_b32 v21, v74, v74, v13
    v_perm_b32 v22, v74, v74, v14
    v_perm_b32 v23, v74, v74, v15
    s_waitcnt vmcnt(19)
    v_mfma_f32_16x16x32_bf16 v[44:47], v[16:19], v[176:179], v[44:47]
    v_perm_b32 v16, v75, v75, v8
    v_perm_b32 v17, v75, v75, v9
    v_perm_b32 v18, v75, v75, v10
    v_perm_b32 v19, v75, v75, v11
    s_waitcnt vmcnt(18)
    v_mfma_f32_16x16x32_bf16 v[44:47], v[20:23], v[180:183], v[44:47]
    v_perm_b32 v20, v75, v75, v12
    v_perm_b32 v21, v75, v75, v13
    v_perm_b32 v22, v75, v75, v14
    v_perm_b32 v23, v75, v75, v15
    s_waitcnt vmcnt(17)
    v_mfma_f32_16x16x32_bf16 v[44:47], v[16:19], v[184:187], v[44:47]
    v_perm_b32 v16, v76, v76, v8
    v_perm_b32 v17, v76, v76, v9
    v_perm_b32 v18, v76, v76, v10
    v_perm_b32 v19, v76, v76, v11
    s_waitcnt vmcnt(16)
    v_mfma_f32_16x16x32_bf16 v[44:47], v[20:23], v[188:191], v[44:47]
    v_perm_b32 v20, v76, v76, v12
    v_perm_b32 v21, v76, v76, v13
    v_perm_b32 v22, v76, v76, v14
    v_perm_b32 v23, v76, v76, v15
    s_waitcnt vmcnt(15)
    v_mfma_f32_16x16x32_bf16 v[44:47], v[16:19], v[192:195], v[44:47]
    v_perm_b32 v16, v77, v77, v8
    v_perm_b32 v17, v77, v77, v9
    v_perm_b32 v18, v77, v77, v10
    v_perm_b32 v19, v77, v77, v11
    s_waitcnt vmcnt(14)
    v_mfma_f32_16x16x32_bf16 v[44:47], v[20:23], v[196:199], v[44:47]
    v_perm_b32 v20, v77, v77, v12
    v_perm_b32 v21, v77, v77, v13
    v_perm_b32 v22, v77, v77, v14
    v_perm_b32 v23, v77, v77, v15
    s_waitcnt vmcnt(13)
    v_mfma_f32_16x16x32_bf16 v[44:47], v[16:19], v[200:203], v[44:47]
    v_perm_b32 v16, v78, v78, v8
    v_perm_b32 v17, v78, v78, v9
    v_perm_b32 v18, v78, v78, v10
    v_perm_b32 v19, v78, v78, v11
    s_waitcnt vmcnt(12)
    v_mfma_f32_16x16x32_bf16 v[44:47], v[20:23], v[204:207], v[44:47]
    v_perm_b32 v20, v78, v78, v12
    v_perm_b32 v21, v78, v78, v13
    v_perm_b32 v22, v78, v78, v14
    v_perm_b32 v23, v78, v78, v15
    s_waitcnt vmcnt(11)
    v_mfma_f32_16x16x32_bf16 v[44:47], v[16:19], v[208:211], v[44:47]
    v_perm_b32 v16, v79, v79, v8
    v_perm_b32 v17, v79, v79, v9
    v_perm_b32 v18, v79, v79, v10
    v_perm_b32 v19, v79, v79, v11
    s_waitcnt vmcnt(10)
    v_mfma_f32_16x16x32_bf16 v[44:47], v[20:23], v[212:215], v[44:47]
    v_perm_b32 v20, v79, v79, v12
    v_perm_b32 v21, v79, v79, v13
    v_perm_b32 v22, v79, v79, v14
    v_perm_b32 v23, v79, v79, v15
    s_waitcnt vmcnt(9)
    v_mfma_f32_16x16x32_bf16 v[44:47], v[16:19], v[216:219], v[44:47]
    v_perm_b32 v16, v80, v80, v8
    v_perm_b32 v17, v80, v80, v9
    v_perm_b32 v18, v80, v80, v10
    v_perm_b32 v19, v80, v80, v11
    s_waitcnt vmcnt(8)
    v_mfma_f32_16x16x32_bf16 v[44:47], v[20:23], v[220:223], v[44:47]
    v_perm_b32 v20, v80, v80, v12
    v_perm_b32 v21, v80, v80, v13
    v_perm_b32 v22, v80, v80, v14
    v_perm_b32 v23, v80, v80, v15
    s_waitcnt vmcnt(7)
    v_mfma_f32_16x16x32_bf16 v[44:47], v[16:19], v[224:227], v[44:47]
    v_perm_b32 v16, v81, v81, v8
    v_perm_b32 v17, v81, v81, v9
    v_perm_b32 v18, v81, v81, v10
    v_perm_b32 v19, v81, v81, v11
    s_waitcnt vmcnt(6)
    v_mfma_f32_16x16x32_bf16 v[44:47], v[20:23], v[228:231], v[44:47]
    v_perm_b32 v20, v81, v81, v12
    v_perm_b32 v21, v81, v81, v13
    v_perm_b32 v22, v81, v81, v14
    v_perm_b32 v23, v81, v81, v15
    s_waitcnt vmcnt(5)
    v_mfma_f32_16x16x32_bf16 v[44:47], v[16:19], v[232:235], v[44:47]
    v_perm_b32 v16, v82, v82, v8
    v_perm_b32 v17, v82, v82, v9
    v_perm_b32 v18, v82, v82, v10
    v_perm_b32 v19, v82, v82, v11
    s_waitcnt vmcnt(4)
    v_mfma_f32_16x16x32_bf16 v[44:47], v[20:23], v[236:239], v[44:47]
    v_perm_b32 v20, v82, v82, v12
    v_perm_b32 v21, v82, v82, v13
    v_perm_b32 v22, v82, v82, v14
    v_perm_b32 v23, v82, v82, v15
    s_waitcnt vmcnt(3)
    v_mfma_f32_16x16x32_bf16 v[44:47], v[16:19], v[240:243], v[44:47]
    v_perm_b32 v16, v83, v83, v8
    v_perm_b32 v17, v83, v83, v9
    v_perm_b32 v18, v83, v83, v10
    v_perm_b32 v19, v83, v83, v11
    s_waitcnt vmcnt(2)
    v_mfma_f32_16x16x32_bf16 v[44:47], v[20:23], v[244:247], v[44:47]
    v_perm_b32 v20, v83, v83, v12
    v_perm_b32 v21, v83, v83, v13
    v_perm_b32 v22, v83, v83, v14
    v_perm_b32 v23, v83, v83, v15
    s_waitcnt vmcnt(1)
    v_mfma_f32_16x16x32_bf16 v[44:47], v[16:19], v[248:251], v[44:47]
    s_nop 1
    s_waitcnt vmcnt(0)
    v_mfma_f32_16x16x32_bf16 v[44:47], v[20:23], v[252:255], v[44:47]
    v_lshlrev_b32 v6, 5, v2
    v_lshl_add_u32 v6, v3, 4, v6
    s_lshl_b32 s43, s42, 9
    v_add_u32 v7, s43, v6
    s_nop 5
    s_mov_b32 exec_hi, 0
    ds_write_b128 v7, v[44:47] offset:6400
    s_mov_b32 exec_hi, -1
    v_lshlrev_b32 v6, 2, v0
    v_mov_b32 v7, 0
    s_mov_b64 exec, 0xff
    ds_write_b32 v6, v7 offset:22528
    s_mov_b64 exec, -1
    s_waitcnt lgkmcnt(0)
    s_barrier
    s_cmp_lg_u32 s42, 0
    s_cbranch_scc1 L_wo
    s_cmp_ge_u32 s5, 27
    s_cbranch_scc1 L_wo
    v_lshlrev_b32 v53, 16, v48
    v_and_b32 v54, 0xffff0000, v48
    v_lshlrev_b32 v55, 16, v49
    v_and_b32 v56, 0xffff0000, v49
    v_lshlrev_b32 v57, 16, v50
    v_and_b32 v58, 0xffff0000, v50
    v_lshlrev_b32 v59, 16, v51
    v_and_b32 v60, 0xffff0000, v51
    v_lshlrev_b32 v61, 16, v52
    v_and_b32 v62, 0xffff0000, v52
    v_add_f32 v4, v53, v54
    v_add_f32 v4, v4, v55
    v_add_f32 v4, v4, v56
    v_add_f32 v4, v4, v57
    v_add_f32 v4, v4, v58
    v_add_f32 v4, v4, v59
    v_add_f32 v4, v4, v60
    v_add_f32 v4, v4, v61
    v_add_f32 v4, v4, v62
    s_nop 1
    v_add_f32_dpp v4, v4, v4 row_ror:8 row_mask:0xf bank_mask:0xf
    s_nop 1
    v_add_f32_dpp v4, v4, v4 row_ror:4 row_mask:0xf bank_mask:0xf
    s_nop 1
    v_add_f32_dpp v4, v4, v4 row_ror:2 row_mask:0xf bank_mask:0xf
    s_nop 1
    v_add_f32_dpp v4, v4, v4 row_ror:1 row_mask:0xf bank_mask:0xf
    v_mov_b32 v5, v4
    s_nop 1
    v_permlane16_swap_b32 v4, v5
    s_nop 0
    v_add_f32 v4, v4, v5
    v_mov_b32 v5, v4
    s_nop 1
    v_permlane32_swap_b32 v4, v5
    s_nop 0
    v_add_f32 v4, v4, v5
    v_mul_f32 v6, 0x3acccccd, v4
    v_sub_f32 v5, v53, v6
    v_mul_f32 v4, v5, v5
    v_sub_f32 v5, v54, v6
    v_fmac_f32 v4, v5, v5
    v_sub_f32 v5, v55, v6
    v_fmac_f32 v4, v5, v5
    v_sub_f32 v5, v56, v6
    v_fmac_f32 v4, v5, v5
    v_sub_f32 v5, v57, v6
    v_fmac_f32 v4, v5, v5
    v_sub_f32 v5, v58, v6
    v_fmac_f32 v4, v5, v5
    v_sub_f32 v5, v59, v6
    v_fmac_f32 v4, v5, v5
    v_sub_f32 v5, v60, v6
    v_fmac_f32 v4, v5, v5
    v_sub_f32 v5, v61, v6
    v_fmac_f32 v4, v5, v5
    v_sub_f32 v5, v62, v6
    v_fmac_f32 v4, v5, v5
    s_nop 1
    v_add_f32_dpp v4, v4, v4 row_ror:8 row_mask:0xf bank_mask:0xf
    s_nop 1
    v_add_f32_dpp v4, v4, v4 row_ror:4 row_mask:0xf bank_mask:0xf
    s_nop 1
    v_add_f32_dpp v4, v4, v4 row_ror:2 row_mask:0xf bank_mask:0xf
    s_nop 1
    v_add_f32_dpp v4, v4, v4 row_ror:1 row_mask:0xf bank_mask:0xf
    v_mov_b32 v5, v4
    s_nop 1
    v_permlane16_swap_b32 v4, v5
    s_nop 0
    v_add_f32 v4, v4, v5
    v_mov_b32 v5, v4
    s_nop 1
    v_permlane32_swap_b32 v4, v5
    s_nop 0
    v_add_f32 v4, v4, v5
    v_mul_f32 v4, 0x3acccccd, v4
    v_cvt_pk_bf16_f32 v4, v4, v4
    v_and_b32 v4, 0xffff0000, v4
    v_add_f32 v4, 0x3727c5ac, v4
    v_cvt_pk_bf16_f32 v4, v4, v4
    v_and_b32 v4, 0xffff0000, v4
    v_sqrt_f32 v4, v4
    s_nop 0
    v_cvt_pk_bf16_f32 v4, v4, v4
    v_and_b32 v4, 0xffff0000, v4
    v_rcp_f32 v7, v4
    v_cvt_pk_bf16_f32 v6, v6, v6
    v_and_b32 v6, 0xffff0000, v6
    v_sub_f32 v53, v53, v6
    v_sub_f32 v54, v54, v6
    v_cvt_pk_bf16_f32 v5, v53, v54
    v_lshlrev_b32 v53, 16, v5
    v_and_b32 v54, 0xffff0000, v5
    v_mul_f32 v53, v53, v7
    v_mul_f32 v54, v54, v7
    v_cvt_pk_bf16_f32 v48, v53, v54
    v_sub_f32 v55, v55, v6
    v_sub_f32 v56, v56, v6
    v_cvt_pk_bf16_f32 v5, v55, v56
    v_lshlrev_b32 v55, 16, v5
    v_and_b32 v56, 0xffff0000, v5
    v_mul_f32 v55, v55, v7
    v_mul_f32 v56, v56, v7
    v_cvt_pk_bf16_f32 v49, v55, v56
    v_sub_f32 v57, v57, v6
    v_sub_f32 v58, v58, v6
    v_cvt_pk_bf16_f32 v5, v57, v58
    v_lshlrev_b32 v57, 16, v5
    v_and_b32 v58, 0xffff0000, v5
    v_mul_f32 v57, v57, v7
    v_mul_f32 v58, v58, v7
    v_cvt_pk_bf16_f32 v50, v57, v58
    v_sub_f32 v59, v59, v6
    v_sub_f32 v60, v60, v6
    v_cvt_pk_bf16_f32 v5, v59, v60
    v_lshlrev_b32 v59, 16, v5
    v_and_b32 v60, 0xffff0000, v5
    v_mul_f32 v59, v59, v7
    v_mul_f32 v60, v60, v7
    v_cvt_pk_bf16_f32 v51, v59, v60
    v_sub_f32 v61, v61, v6
    v_sub_f32 v62, v62, v6
    v_cvt_pk_bf16_f32 v5, v61, v62
    v_lshlrev_b32 v61, 16, v5
    v_and_b32 v62, 0xffff0000, v5
    v_mul_f32 v61, v61, v7
    v_mul_f32 v62, v62, v7
    v_cvt_pk_bf16_f32 v52, v61, v62
    v_lshlrev_b32 v4, 2, v0
    v_lshlrev_b32 v5, 3, v0
    ds_write_b64 v5, v[48:49] offset:5120
    ds_write_b64 v5, v[50:51] offset:5632
    ds_write_b32 v4, v52 offset:6144
    s_lshl_b32 s6, s5, 7
    s_sub_u32 s44, 2211840, s6
    s_add_u32 s8, s28, s6
    s_addc_u32 s9, s29, 0
    s_mov_b32 s10, s44
    s_mov_b32 s11, 0x20000
    s_add_u32 s12, s30, s6
    s_addc_u32 s13, s31, 0
    s_mov_b32 s14, 128
    s_mov_b32 s15, 0x20000
    v_lshlrev_b32 v5, 1, v0
    buffer_load_ushort v53, v5, s[12:15], 0 offen
    v_lshrrev_b32 v5, 3, v2
    v_lshl_add_u32 v5, v3, 1, v5
    v_mul_u32_u24 v6, 160, v5
    s_mov_b32 s45, 276480
    v_mul_lo_u32 v5, s45, v5
    v_and_b32 v7, 7, v2
    v_lshl_add_u32 v5, v7, 4, v5
    s_waitcnt lgkmcnt(0)
    ds_read_b128 v[96:99], v6 offset:5120
    ds_read_b128 v[100:103], v6 offset:5136
    ds_read_b128 v[104:107], v6 offset:5152
    ds_read_b128 v[108:111], v6 offset:5168
    ds_read_b128 v[112:115], v6 offset:5184
    ds_read_b128 v[116:119], v6 offset:5200
    ds_read_b128 v[120:123], v6 offset:5216
    ds_read_b128 v[124:127], v6 offset:5232
    ds_read_b128 v[128:131], v6 offset:5248
    ds_read_b128 v[132:135], v6 offset:5264
    s_mov_b32 s45, 0
    buffer_load_dwordx4 v[136:139], v5, s[8:11], s45 offen nt
    s_mov_b32 s45, 3456
    buffer_load_dwordx4 v[140:143], v5, s[8:11], s45 offen nt
    s_mov_b32 s45, 6912
    buffer_load_dwordx4 v[144:147], v5, s[8:11], s45 offen nt
    s_mov_b32 s45, 10368
    buffer_load_dwordx4 v[148:151], v5, s[8:11], s45 offen nt
    s_waitcnt lgkmcnt(0)
    v_perm_b32 v16, v96, v96, v8
    v_perm_b32 v17, v96, v96, v9
    v_perm_b32 v18, v96, v96, v10
    v_perm_b32 v19, v96, v96, v11
    v_perm_b32 v20, v96, v96, v12
    v_perm_b32 v21, v96, v96, v13
    v_perm_b32 v22, v96, v96, v14
    v_perm_b32 v23, v96, v96, v15
    s_waitcnt vmcnt(3)
    v_mfma_f32_16x16x32_bf16 v[44:47], v[16:19], v[136:139], 0
    s_mov_b32 s45, 13824
    buffer_load_dwordx4 v[152:155], v5, s[8:11], s45 offen nt
    v_perm_b32 v16, v97, v97, v8
    v_perm_b32 v17, v97, v97, v9
    v_perm_b32 v18, v97, v97, v10
    v_perm_b32 v19, v97, v97, v11
    s_waitcnt vmcnt(3)
    v_mfma_f32_16x16x32_bf16 v[44:47], v[20:23], v[140:143], v[44:47]
    s_mov_b32 s45, 17280
    buffer_load_dwordx4 v[156:159], v5, s[8:11], s45 offen nt
    v_perm_b32 v20, v97, v97, v12
    v_perm_b32 v21, v97, v97, v13
    v_perm_b32 v22, v97, v97, v14
    v_perm_b32 v23, v97, v97, v15
    s_waitcnt vmcnt(3)
    v_mfma_f32_16x16x32_bf16 v[44:47], v[16:19], v[144:147], v[44:47]
    s_mov_b32 s45, 20736
    buffer_load_dwordx4 v[160:163], v5, s[8:11], s45 offen nt
    v_perm_b32 v16, v98, v98, v8
    v_perm_b32 v17, v98, v98, v9
    v_perm_b32 v18, v98, v98, v10
    v_perm_b32 v19, v98, v98, v11
    s_waitcnt vmcnt(3)
    v_mfma_f32_16x16x32_bf16 v[44:47], v[20:23], v[148:151], v[44:47]
    s_mov_b32 s45, 24192
    buffer_load_dwordx4 v[164:167], v5, s[8:11], s45 offen nt
    v_perm_b32 v20, v98, v98, v12
    v_perm_b32 v21, v98, v98, v13
    v_perm_b32 v22, v98, v98, v14
    v_perm_b32 v23, v98, v98, v15
    s_waitcnt vmcnt(3)
    v_mfma_f32_16x16x32_bf16 v[44:47], v[16:19], v[152:155], v[44:47]
    s_mov_b32 s45, 27648
    buffer_load_dwordx4 v[168:171], v5, s[8:11], s45 offen nt
    v_perm_b32 v16, v99, v99, v8
    v_perm_b32 v17, v99, v99, v9
    v_perm_b32 v18, v99, v99, v10
    v_perm_b32 v19, v99, v99, v11
    s_waitcnt vmcnt(3)
    v_mfma_f32_16x16x32_bf16 v[44:47], v[20:23], v[156:159], v[44:47]
    s_mov_b32 s45, 31104
    buffer_load_dwordx4 v[172:175], v5, s[8:11], s45 offen nt
    v_perm_b32 v20, v99, v99, v12
    v_perm_b32 v21, v99, v99, v13
    v_perm_b32 v22, v99, v99, v14
    v_perm_b32 v23, v99, v99, v15
    s_waitcnt vmcnt(3)
    v_mfma_f32_16x16x32_bf16 v[44:47], v[16:19], v[160:163], v[44:47]
    s_mov_b32 s45, 34560
    buffer_load_dwordx4 v[176:179], v5, s[8:11], s45 offen nt
    v_perm_b32 v16, v100, v100, v8
    v_perm_b32 v17, v100, v100, v9
    v_perm_b32 v18, v100, v100, v10
    v_perm_b32 v19, v100, v100, v11
    s_waitcnt vmcnt(3)
    v_mfma_f32_16x16x32_bf16 v[44:47], v[20:23], v[164:167], v[44:47]
    s_mov_b32 s45, 38016
    buffer_load_dwordx4 v[180:183], v5, s[8:11], s45 offen nt
    v_perm_b32 v20, v100, v100, v12
    v_perm_b32 v21, v100, v100, v13
    v_perm_b32 v22, v100, v100, v14
    v_perm_b32 v23, v100, v100, v15
    s_waitcnt vmcnt(3)
    v_mfma_f32_16x16x32_bf16 v[44:47], v[16:19], v[168:171], v[44:47]
    s_mov_b32 s45, 41472
    buffer_load_dwordx4 v[184:187], v5, s[8:11], s45 offen nt
    v_perm_b32 v16, v101, v101, v8
    v_perm_b32 v17, v101, v101, v9
    v_perm_b32 v18, v101, v101, v10
    v_perm_b32 v19, v101, v101, v11
    s_waitcnt vmcnt(3)
    v_mfma_f32_16x16x32_bf16 v[44:47], v[20:23], v[172:175], v[44:47]
    s_mov_b32 s45, 44928
    buffer_load_dwordx4 v[188:191], v5, s[8:11], s45 offen nt
    v_perm_b32 v20, v101, v101, v12
    v_perm_b32 v21, v101, v101, v13
    v_perm_b32 v22, v101, v101, v14
    v_perm_b32 v23, v101, v101, v15
    s_waitcnt vmcnt(3)
    v_mfma_f32_16x16x32_bf16 v[44:47], v[16:19], v[176:179], v[44:47]
    s_mov_b32 s45, 48384
    buffer_load_dwordx4 v[192:195], v5, s[8:11], s45 offen nt
    v_perm_b32 v16, v102, v102, v8
    v_perm_b32 v17, v102, v102, v9
    v_perm_b32 v18, v102, v102, v10
    v_perm_b32 v19, v102, v102, v11
    s_waitcnt vmcnt(3)
    v_mfma_f32_16x16x32_bf16 v[44:47], v[20:23], v[180:183], v[44:47]
    s_mov_b32 s45, 51840
    buffer_load_dwordx4 v[196:199], v5, s[8:11], s45 offen nt
    v_perm_b32 v20, v102, v102, v12
    v_perm_b32 v21, v102, v102, v13
    v_perm_b32 v22, v102, v102, v14
    v_perm_b32 v23, v102, v102, v15
    s_waitcnt vmcnt(3)
    v_mfma_f32_16x16x32_bf16 v[44:47], v[16:19], v[184:187], v[44:47]
    s_mov_b32 s45, 55296
    buffer_load_dwordx4 v[200:203], v5, s[8:11], s45 offen nt
    v_perm_b32 v16, v103, v103, v8
    v_perm_b32 v17, v103, v103, v9
    v_perm_b32 v18, v103, v103, v10
    v_perm_b32 v19, v103, v103, v11
    s_waitcnt vmcnt(3)
    v_mfma_f32_16x16x32_bf16 v[44:47], v[20:23], v[188:191], v[44:47]
    s_mov_b32 s45, 58752
    buffer_load_dwordx4 v[204:207], v5, s[8:11], s45 offen nt
    v_perm_b32 v20, v103, v103, v12
    v_perm_b32 v21, v103, v103, v13
    v_perm_b32 v22, v103, v103, v14
    v_perm_b32 v23, v103, v103, v15
    s_waitcnt vmcnt(3)
    v_mfma_f32_16x16x32_bf16 v[44:47], v[16:19], v[192:195], v[44:47]
    s_mov_b32 s45, 62208
    buffer_load_dwordx4 v[208:211], v5, s[8:11], s45 offen nt
    v_perm_b32 v16, v104, v104, v8
    v_perm_b32 v17, v104, v104, v9
    v_perm_b32 v18, v104, v104, v10
    v_perm_b32 v19, v104, v104, v11
    s_waitcnt vmcnt(3)
    v_mfma_f32_16x16x32_bf16 v[44:47], v[20:23], v[196:199], v[44:47]
    s_mov_b32 s45, 65664
    buffer_load_dwordx4 v[212:215], v5, s[8:11], s45 offen nt
    v_perm_b32 v20, v104, v104, v12
    v_perm_b32 v21, v104, v104, v13
    v_perm_b32 v22, v104, v104, v14
    v_perm_b32 v23, v104, v104, v15
    s_waitcnt vmcnt(3)
    v_mfma_f32_16x16x32_bf16 v[44:47], v[16:19], v[200:203], v[44:47]
    s_mov_b32 s45, 69120
    buffer_load_dwordx4 v[216:219], v5, s[8:11], s45 offen nt
    v_perm_b32 v16, v105, v105, v8
    v_perm_b32 v17, v105, v105, v9
    v_perm_b32 v18, v105, v105, v10
    v_perm_b32 v19, v105, v105, v11
    s_waitcnt vmcnt(3)
    v_mfma_f32_16x16x32_bf16 v[44:47], v[20:23], v[204:207], v[44:47]
    s_mov_b32 s45, 72576
    buffer_load_dwordx4 v[220:223], v5, s[8:11], s45 offen nt
    v_perm_b32 v20, v105, v105, v12
    v_perm_b32 v21, v105, v105, v13
    v_perm_b32 v22, v105, v105, v14
    v_perm_b32 v23, v105, v105, v15
    s_waitcnt vmcnt(3)
    v_mfma_f32_16x16x32_bf16 v[44:47], v[16:19], v[208:211], v[44:47]
    s_mov_b32 s45, 76032
    buffer_load_dwordx4 v[224:227], v5, s[8:11], s45 offen nt
    v_perm_b32 v16, v106, v106, v8
    v_perm_b32 v17, v106, v106, v9
    v_perm_b32 v18, v106, v106, v10
    v_perm_b32 v19, v106, v106, v11
    s_waitcnt vmcnt(3)
    v_mfma_f32_16x16x32_bf16 v[44:47], v[20:23], v[212:215], v[44:47]
    s_mov_b32 s45, 79488
    buffer_load_dwordx4 v[228:231], v5, s[8:11], s45 offen nt
    v_perm_b32 v20, v106, v106, v12
    v_perm_b32 v21, v106, v106, v13
    v_perm_b32 v22, v106, v106, v14
    v_perm_b32 v23, v106, v106, v15
    s_waitcnt vmcnt(3)
    v_mfma_f32_16x16x32_bf16 v[44:47], v[16:19], v[216:219], v[44:47]
    s_mov_b32 s45, 82944
    buffer_load_dwordx4 v[232:235], v5, s[8:11], s45 offen nt
    v_perm_b32 v16, v107, v107, v8
    v_perm_b32 v17, v107, v107, v9
    v_perm_b32 v18, v107, v107, v10
    v_perm_b32 v19, v107, v107, v11
    s_waitcnt vmcnt(3)
    v_mfma_f32_16x16x32_bf16 v[44:47], v[20:23], v[220:223], v[44:47]
    s_mov_b32 s45, 86400
    buffer_load_dwordx4 v[236:239], v5, s[8:11], s45 offen nt
    v_perm_b32 v20, v107, v107, v12
    v_perm_b32 v21, v107, v107, v13
    v_perm_b32 v22, v107, v107, v14
    v_perm_b32 v23, v107, v107, v15
    s_waitcnt vmcnt(3)
    v_mfma_f32_16x16x32_bf16 v[44:47], v[16:19], v[224:227], v[44:47]
    s_mov_b32 s45, 89856
    buffer_load_dwordx4 v[240:243], v5, s[8:11], s45 offen nt
    v_perm_b32 v16, v108, v108, v8
    v_perm_b32 v17, v108, v108, v9
    v_perm_b32 v18, v108, v108, v10
    v_perm_b32 v19, v108, v108, v11
    s_waitcnt vmcnt(3)
    v_mfma_f32_16x16x32_bf16 v[44:47], v[20:23], v[228:231], v[44:47]
    s_mov_b32 s45, 93312
    buffer_load_dwordx4 v[244:247], v5, s[8:11], s45 offen nt
    v_perm_b32 v20, v108, v108, v12
    v_perm_b32 v21, v108, v108, v13
    v_perm_b32 v22, v108, v108, v14
    v_perm_b32 v23, v108, v108, v15
    s_waitcnt vmcnt(3)
    v_mfma_f32_16x16x32_bf16 v[44:47], v[16:19], v[232:235], v[44:47]
    s_mov_b32 s45, 96768
    buffer_load_dwordx4 v[248:251], v5, s[8:11], s45 offen nt
    v_perm_b32 v16, v109, v109, v8
    v_perm_b32 v17, v109, v109, v9
    v_perm_b32 v18, v109, v109, v10
    v_perm_b32 v19, v109, v109, v11
    s_waitcnt vmcnt(3)
    v_mfma_f32_16x16x32_bf16 v[44:47], v[20:23], v[236:239], v[44:47]
    s_mov_b32 s45, 100224
    buffer_load_dwordx4 v[252:255], v5, s[8:11], s45 offen nt
    v_perm_b32 v20, v109, v109, v12
    v_perm_b32 v21, v109, v109, v13
    v_perm_b32 v22, v109, v109, v14
    v_perm_b32 v23, v109, v109, v15
    s_waitcnt vmcnt(3)
    v_mfma_f32_16x16x32_bf16 v[44:47], v[16:19], v[240:243], v[44:47]
    s_mov_b32 s45, 103680
    buffer_load_dwordx4 v[136:139], v5, s[8:11], s45 offen nt
    v_perm_b32 v16, v110, v110, v8
    v_perm_b32 v17, v110, v110, v9
    v_perm_b32 v18, v110, v110, v10
    v_perm_b32 v19, v110, v110, v11
    s_waitcnt vmcnt(3)
    v_mfma_f32_16x16x32_bf16 v[44:47], v[20:23], v[244:247], v[44:47]
    s_mov_b32 s45, 107136
    buffer_load_dwordx4 v[140:143], v5, s[8:11], s45 offen nt
    v_perm_b32 v20, v110, v110, v12
    v_perm_b32 v21, v110, v110, v13
    v_perm_b32 v22, v110, v110, v14
    v_perm_b32 v23, v110, v110, v15
    s_waitcnt vmcnt(3)
    v_mfma_f32_16x16x32_bf16 v[44:47], v[16:19], v[248:251], v[44:47]
    s_mov_b32 s45, 110592
    buffer_load_dwordx4 v[144:147], v5, s[8:11], s45 offen nt
    v_perm_b32 v16, v111, v111, v8
    v_perm_b32 v17, v111, v111, v9
    v_perm_b32 v18, v111, v111, v10
    v_perm_b32 v19, v111, v111, v11
    s_waitcnt vmcnt(3)
    v_mfma_f32_16x16x32_bf16 v[44:47], v[20:23], v[252:255], v[44:47]
    s_mov_b32 s45, 114048
    buffer_load_dwordx4 v[148:151], v5, s[8:11], s45 offen nt
    v_perm_b32 v20, v111, v111, v12
    v_perm_b32 v21, v111, v111, v13
    v_perm_b32 v22, v111, v111, v14
    v_perm_b32 v23, v111, v111, v15
    s_waitcnt vmcnt(3)
    v_mfma_f32_16x16x32_bf16 v[44:47], v[16:19], v[136:139], v[44:47]
    s_mov_b32 s45, 117504
    buffer_load_dwordx4 v[152:155], v5, s[8:11], s45 offen nt
    v_perm_b32 v16, v112, v112, v8
    v_perm_b32 v17, v112, v112, v9
    v_perm_b32 v18, v112, v112, v10
    v_perm_b32 v19, v112, v112, v11
    s_waitcnt vmcnt(3)
    v_mfma_f32_16x16x32_bf16 v[44:47], v[20:23], v[140:143], v[44:47]
    s_mov_b32 s45, 120960
    buffer_load_dwordx4 v[156:159], v5, s[8:11], s45 offen nt
    v_perm_b32 v20, v112, v112, v12
    v_perm_b32 v21, v112, v112, v13
    v_perm_b32 v22, v112, v112, v14
    v_perm_b32 v23, v112, v112, v15
    s_waitcnt vmcnt(3)
    v_mfma_f32_16x16x32_bf16 v[44:47], v[16:19], v[144:147], v[44:47]
    s_mov_b32 s45, 124416
    buffer_load_dwordx4 v[160:163], v5, s[8:11], s45 offen nt
    v_perm_b32 v16, v113, v113, v8
    v_perm_b32 v17, v113, v113, v9
    v_perm_b32 v18, v113, v113, v10
    v_perm_b32 v19, v113, v113, v11
    s_waitcnt vmcnt(3)
    v_mfma_f32_16x16x32_bf16 v[44:47], v[20:23], v[148:151], v[44:47]
    s_mov_b32 s45, 127872
    buffer_load_dwordx4 v[164:167], v5, s[8:11], s45 offen nt
    v_perm_b32 v20, v113, v113, v12
    v_perm_b32 v21, v113, v113, v13
    v_perm_b32 v22, v113, v113, v14
    v_perm_b32 v23, v113, v113, v15
    s_waitcnt vmcnt(3)
    v_mfma_f32_16x16x32_bf16 v[44:47], v[16:19], v[152:155], v[44:47]
    s_mov_b32 s45, 131328
    buffer_load_dwordx4 v[168:171], v5, s[8:11], s45 offen nt
    v_perm_b32 v16, v114, v114, v8
    v_perm_b32 v17, v114, v114, v9
    v_perm_b32 v18, v114, v114, v10
    v_perm_b32 v19, v114, v114, v11
    s_waitcnt vmcnt(3)
    v_mfma_f32_16x16x32_bf16 v[44:47], v[20:23], v[156:159], v[44:47]
    s_mov_b32 s45, 134784
    buffer_load_dwordx4 v[172:175], v5, s[8:11], s45 offen nt
    v_perm_b32 v20, v114, v114, v12
    v_perm_b32 v21, v114, v114, v13
    v_perm_b32 v22, v114, v114, v14
    v_perm_b32 v23, v114, v114, v15
    s_waitcnt vmcnt(3)
    v_mfma_f32_16x16x32_bf16 v[44:47], v[16:19], v[160:163], v[44:47]
    s_mov_b32 s45, 138240
    buffer_load_dwordx4 v[176:179], v5, s[8:11], s45 offen nt
    v_perm_b32 v16, v115, v115, v8
    v_perm_b32 v17, v115, v115, v9
    v_perm_b32 v18, v115, v115, v10
    v_perm_b32 v19, v115, v115, v11
    s_waitcnt vmcnt(3)
    v_mfma_f32_16x16x32_bf16 v[44:47], v[20:23], v[164:167], v[44:47]
    s_mov_b32 s45, 141696
    buffer_load_dwordx4 v[180:183], v5, s[8:11], s45 offen nt
    v_perm_b32 v20, v115, v115, v12
    v_perm_b32 v21, v115, v115, v13
    v_perm_b32 v22, v115, v115, v14
    v_perm_b32 v23, v115, v115, v15
    s_waitcnt vmcnt(3)
    v_mfma_f32_16x16x32_bf16 v[44:47], v[16:19], v[168:171], v[44:47]
    s_mov_b32 s45, 145152
    buffer_load_dwordx4 v[184:187], v5, s[8:11], s45 offen nt
    v_perm_b32 v16, v116, v116, v8
    v_perm_b32 v17, v116, v116, v9
    v_perm_b32 v18, v116, v116, v10
    v_perm_b32 v19, v116, v116, v11
    s_waitcnt vmcnt(3)
    v_mfma_f32_16x16x32_bf16 v[44:47], v[20:23], v[172:175], v[44:47]
    s_mov_b32 s45, 148608
    buffer_load_dwordx4 v[188:191], v5, s[8:11], s45 offen nt
    v_perm_b32 v20, v116, v116, v12
    v_perm_b32 v21, v116, v116, v13
    v_perm_b32 v22, v116, v116, v14
    v_perm_b32 v23, v116, v116, v15
    s_waitcnt vmcnt(3)
    v_mfma_f32_16x16x32_bf16 v[44:47], v[16:19], v[176:179], v[44:47]
    s_mov_b32 s45, 152064
    buffer_load_dwordx4 v[192:195], v5, s[8:11], s45 offen nt
    v_perm_b32 v16, v117, v117, v8
    v_perm_b32 v17, v117, v117, v9
    v_perm_b32 v18, v117, v117, v10
    v_perm_b32 v19, v117, v117, v11
    s_waitcnt vmcnt(3)
    v_mfma_f32_16x16x32_bf16 v[44:47], v[20:23], v[180:183], v[44:47]
    s_mov_b32 s45, 155520
    buffer_load_dwordx4 v[196:199], v5, s[8:11], s45 offen nt
    v_perm_b32 v20, v117, v117, v12
    v_perm_b32 v21, v117, v117, v13
    v_perm_b32 v22, v117, v117, v14
    v_perm_b32 v23, v117, v117, v15
    s_waitcnt vmcnt(3)
    v_mfma_f32_16x16x32_bf16 v[44:47], v[16:19], v[184:187], v[44:47]
    s_mov_b32 s45, 158976
    buffer_load_dwordx4 v[200:203], v5, s[8:11], s45 offen nt
    v_perm_b32 v16, v118, v118, v8
    v_perm_b32 v17, v118, v118, v9
    v_perm_b32 v18, v118, v118, v10
    v_perm_b32 v19, v118, v118, v11
    s_waitcnt vmcnt(3)
    v_mfma_f32_16x16x32_bf16 v[44:47], v[20:23], v[188:191], v[44:47]
    s_mov_b32 s45, 162432
    buffer_load_dwordx4 v[204:207], v5, s[8:11], s45 offen nt
    v_perm_b32 v20, v118, v118, v12
    v_perm_b32 v21, v118, v118, v13
    v_perm_b32 v22, v118, v118, v14
    v_perm_b32 v23, v118, v118, v15
    s_waitcnt vmcnt(3)
    v_mfma_f32_16x16x32_bf16 v[44:47], v[16:19], v[192:195], v[44:47]
    s_mov_b32 s45, 165888
    buffer_load_dwordx4 v[208:211], v5, s[8:11], s45 offen nt
    v_perm_b32 v16, v119, v119, v8
    v_perm_b32 v17, v119, v119, v9
    v_perm_b32 v18, v119, v119, v10
    v_perm_b32 v19, v119, v119, v11
    s_waitcnt vmcnt(3)
    v_mfma_f32_16x16x32_bf16 v[44:47], v[20:23], v[196:199], v[44:47]
    s_mov_b32 s45, 169344
    buffer_load_dwordx4 v[212:215], v5, s[8:11], s45 offen nt
    v_perm_b32 v20, v119, v119, v12
    v_perm_b32 v21, v119, v119, v13
    v_perm_b32 v22, v119, v119, v14
    v_perm_b32 v23, v119, v119, v15
    s_waitcnt vmcnt(3)
    v_mfma_f32_16x16x32_bf16 v[44:47], v[16:19], v[200:203], v[44:47]
    s_mov_b32 s45, 172800
    buffer_load_dwordx4 v[216:219], v5, s[8:11], s45 offen nt
    v_perm_b32 v16, v120, v120, v8
    v_perm_b32 v17, v120, v120, v9
    v_perm_b32 v18, v120, v120, v10
    v_perm_b32 v19, v120, v120, v11
    s_waitcnt vmcnt(3)
    v_mfma_f32_16x16x32_bf16 v[44:47], v[20:23], v[204:207], v[44:47]
    s_mov_b32 s45, 176256
    buffer_load_dwordx4 v[220:223], v5, s[8:11], s45 offen nt
    v_perm_b32 v20, v120, v120, v12
    v_perm_b32 v21, v120, v120, v13
    v_perm_b32 v22, v120, v120, v14
    v_perm_b32 v23, v120, v120, v15
    s_waitcnt vmcnt(3)
    v_mfma_f32_16x16x32_bf16 v[44:47], v[16:19], v[208:211], v[44:47]
    s_mov_b32 s45, 179712
    buffer_load_dwordx4 v[224:227], v5, s[8:11], s45 offen nt
    v_perm_b32 v16, v121, v121, v8
    v_perm_b32 v17, v121, v121, v9
    v_perm_b32 v18, v121, v121, v10
    v_perm_b32 v19, v121, v121, v11
    s_waitcnt vmcnt(3)
    v_mfma_f32_16x16x32_bf16 v[44:47], v[20:23], v[212:215], v[44:47]
    s_mov_b32 s45, 183168
    buffer_load_dwordx4 v[228:231], v5, s[8:11], s45 offen nt
    v_perm_b32 v20, v121, v121, v12
    v_perm_b32 v21, v121, v121, v13
    v_perm_b32 v22, v121, v121, v14
    v_perm_b32 v23, v121, v121, v15
    s_waitcnt vmcnt(3)
    v_mfma_f32_16x16x32_bf16 v[44:47], v[16:19], v[216:219], v[44:47]
    s_mov_b32 s45, 186624
    buffer_load_dwordx4 v[232:235], v5, s[8:11], s45 offen nt
    v_perm_b32 v16, v122, v122, v8
    v_perm_b32 v17, v122, v122, v9
    v_perm_b32 v18, v122, v122, v10
    v_perm_b32 v19, v122, v122, v11
    s_waitcnt vmcnt(3)
    v_mfma_f32_16x16x32_bf16 v[44:47], v[20:23], v[220:223], v[44:47]
    s_mov_b32 s45, 190080
    buffer_load_dwordx4 v[236:239], v5, s[8:11], s45 offen nt
    v_perm_b32 v20, v122, v122, v12
    v_perm_b32 v21, v122, v122, v13
    v_perm_b32 v22, v122, v122, v14
    v_perm_b32 v23, v122, v122, v15
    s_waitcnt vmcnt(3)
    v_mfma_f32_16x16x32_bf16 v[44:47], v[16:19], v[224:227], v[44:47]
    s_mov_b32 s45, 193536
    buffer_load_dwordx4 v[240:243], v5, s[8:11], s45 offen nt
    v_perm_b32 v16, v123, v123, v8
    v_perm_b32 v17, v123, v123, v9
    v_perm_b32 v18, v123, v123, v10
    v_perm_b32 v19, v123, v123, v11
    s_waitcnt vmcnt(3)
    v_mfma_f32_16x16x32_bf16 v[44:47], v[20:23], v[228:231], v[44:47]
    s_mov_b32 s45, 196992
    buffer_load_dwordx4 v[244:247], v5, s[8:11], s45 offen nt
    v_perm_b32 v20, v123, v123, v12
    v_perm_b32 v21, v123, v123, v13
    v_perm_b32 v22, v123, v123, v14
    v_perm_b32 v23, v123, v123, v15
    s_waitcnt vmcnt(3)
    v_mfma_f32_16x16x32_bf16 v[44:47], v[16:19], v[232:235], v[44:47]
    s_mov_b32 s45, 200448
    buffer_load_dwordx4 v[248:251], v5, s[8:11], s45 offen nt
    v_perm_b32 v16, v124, v124, v8
    v_perm_b32 v17, v124, v124, v9
    v_perm_b32 v18, v124, v124, v10
    v_perm_b32 v19, v124, v124, v11
    s_waitcnt vmcnt(3)
    v_mfma_f32_16x16x32_bf16 v[44:47], v[20:23], v[236:239], v[44:47]
    s_mov_b32 s45, 203904
    buffer_load_dwordx4 v[252:255], v5, s[8:11], s45 offen nt
    v_perm_b32 v20, v124, v124, v12
    v_perm_b32 v21, v124, v124, v13
    v_perm_b32 v22, v124, v124, v14
    v_perm_b32 v23, v124, v124, v15
    s_waitcnt vmcnt(3)
    v_mfma_f32_16x16x32_bf16 v[44:47], v[16:19], v[240:243], v[44:47]
    s_mov_b32 s45, 207360
    buffer_load_dwordx4 v[136:139], v5, s[8:11], s45 offen nt
    v_perm_b32 v16, v125, v125, v8
    v_perm_b32 v17, v125, v125, v9
    v_perm_b32 v18, v125, v125, v10
    v_perm_b32 v19, v125, v125, v11
    s_waitcnt vmcnt(3)
    v_mfma_f32_16x16x32_bf16 v[44:47], v[20:23], v[244:247], v[44:47]
    s_mov_b32 s45, 210816
    buffer_load_dwordx4 v[140:143], v5, s[8:11], s45 offen nt
    v_perm_b32 v20, v125, v125, v12
    v_perm_b32 v21, v125, v125, v13
    v_perm_b32 v22, v125, v125, v14
    v_perm_b32 v23, v125, v125, v15
    s_waitcnt vmcnt(3)
    v_mfma_f32_16x16x32_bf16 v[44:47], v[16:19], v[248:251], v[44:47]
    s_mov_b32 s45, 214272
    buffer_load_dwordx4 v[144:147], v5, s[8:11], s45 offen nt
    v_perm_b32 v16, v126, v126, v8
    v_perm_b32 v17, v126, v126, v9
    v_perm_b32 v18, v126, v126, v10
    v_perm_b32 v19, v126, v126, v11
    s_waitcnt vmcnt(3)
    v_mfma_f32_16x16x32_bf16 v[44:47], v[20:23], v[252:255], v[44:47]
    s_mov_b32 s45, 217728
    buffer_load_dwordx4 v[148:151], v5, s[8:11], s45 offen nt
    v_perm_b32 v20, v126, v126, v12
    v_perm_b32 v21, v126, v126, v13
    v_perm_b32 v22, v126, v126, v14
    v_perm_b32 v23, v126, v126, v15
    s_waitcnt vmcnt(3)
    v_mfma_f32_16x16x32_bf16 v[44:47], v[16:19], v[136:139], v[44:47]
    s_mov_b32 s45, 221184
    buffer_load_dwordx4 v[152:155], v5, s[8:11], s45 offen nt
    v_perm_b32 v16, v127, v127, v8
    v_perm_b32 v17, v127, v127, v9
    v_perm_b32 v18, v127, v127, v10
    v_perm_b32 v19, v127, v127, v11
    s_waitcnt vmcnt(3)
    v_mfma_f32_16x16x32_bf16 v[44:47], v[20:23], v[140:143], v[44:47]
    s_mov_b32 s45, 224640
    buffer_load_dwordx4 v[156:159], v5, s[8:11], s45 offen nt
    v_perm_b32 v20, v127, v127, v12
    v_perm_b32 v21, v127, v127, v13
    v_perm_b32 v22, v127, v127, v14
    v_perm_b32 v23, v127, v127, v15
    s_waitcnt vmcnt(3)
    v_mfma_f32_16x16x32_bf16 v[44:47], v[16:19], v[144:147], v[44:47]
    s_mov_b32 s45, 228096
    buffer_load_dwordx4 v[160:163], v5, s[8:11], s45 offen nt
    v_perm_b32 v16, v128, v128, v8
    v_perm_b32 v17, v128, v128, v9
    v_perm_b32 v18, v128, v128, v10
    v_perm_b32 v19, v128, v128, v11
    s_waitcnt vmcnt(3)
    v_mfma_f32_16x16x32_bf16 v[44:47], v[20:23], v[148:151], v[44:47]
    s_mov_b32 s45, 231552
    buffer_load_dwordx4 v[164:167], v5, s[8:11], s45 offen nt
    v_perm_b32 v20, v128, v128, v12
    v_perm_b32 v21, v128, v128, v13
    v_perm_b32 v22, v128, v128, v14
    v_perm_b32 v23, v128, v128, v15
    s_waitcnt vmcnt(3)
    v_mfma_f32_16x16x32_bf16 v[44:47], v[16:19], v[152:155], v[44:47]
    s_mov_b32 s45, 235008
    buffer_load_dwordx4 v[168:171], v5, s[8:11], s45 offen nt
    v_perm_b32 v16, v129, v129, v8
    v_perm_b32 v17, v129, v129, v9
    v_perm_b32 v18, v129, v129, v10
    v_perm_b32 v19, v129, v129, v11
    s_waitcnt vmcnt(3)
    v_mfma_f32_16x16x32_bf16 v[44:47], v[20:23], v[156:159], v[44:47]
    s_mov_b32 s45, 238464
    buffer_load_dwordx4 v[172:175], v5, s[8:11], s45 offen nt
    v_perm_b32 v20, v129, v129, v12
    v_perm_b32 v21, v129, v129, v13
    v_perm_b32 v22, v129, v129, v14
    v_perm_b32 v23, v129, v129, v15
    s_waitcnt vmcnt(3)
    v_mfma_f32_16x16x32_bf16 v[44:47], v[16:19], v[160:163], v[44:47]
    s_mov_b32 s45, 241920
    buffer_load_dwordx4 v[176:179], v5, s[8:11], s45 offen nt
    v_perm_b32 v16, v130, v130, v8
    v_perm_b32 v17, v130, v130, v9
    v_perm_b32 v18, v130, v130, v10
    v_perm_b32 v19, v130, v130, v11
    s_waitcnt vmcnt(3)
    v_mfma_f32_16x16x32_bf16 v[44:47], v[20:23], v[164:167], v[44:47]
    s_mov_b32 s45, 245376
    buffer_load_dwordx4 v[180:183], v5, s[8:11], s45 offen nt
    v_perm_b32 v20, v130, v130, v12
    v_perm_b32 v21, v130, v130, v13
    v_perm_b32 v22, v130, v130, v14
    v_perm_b32 v23, v130, v130, v15
    s_waitcnt vmcnt(3)
    v_mfma_f32_16x16x32_bf16 v[44:47], v[16:19], v[168:171], v[44:47]
    s_mov_b32 s45, 248832
    buffer_load_dwordx4 v[184:187], v5, s[8:11], s45 offen nt
    v_perm_b32 v16, v131, v131, v8
    v_perm_b32 v17, v131, v131, v9
    v_perm_b32 v18, v131, v131, v10
    v_perm_b32 v19, v131, v131, v11
    s_waitcnt vmcnt(3)
    v_mfma_f32_16x16x32_bf16 v[44:47], v[20:23], v[172:175], v[44:47]
    s_mov_b32 s45, 252288
    buffer_load_dwordx4 v[188:191], v5, s[8:11], s45 offen nt
    v_perm_b32 v20, v131, v131, v12
    v_perm_b32 v21, v131, v131, v13
    v_perm_b32 v22, v131, v131, v14
    v_perm_b32 v23, v131, v131, v15
    s_waitcnt vmcnt(3)
    v_mfma_f32_16x16x32_bf16 v[44:47], v[16:19], v[176:179], v[44:47]
    s_mov_b32 s45, 255744
    buffer_load_dwordx4 v[192:195], v5, s[8:11], s45 offen nt
    v_perm_b32 v16, v132, v132, v8
    v_perm_b32 v17, v132, v132, v9
    v_perm_b32 v18, v132, v132, v10
    v_perm_b32 v19, v132, v132, v11
    s_waitcnt vmcnt(3)
    v_mfma_f32_16x16x32_bf16 v[44:47], v[20:23], v[180:183], v[44:47]
    s_mov_b32 s45, 259200
    buffer_load_dwordx4 v[196:199], v5, s[8:11], s45 offen nt
    v_perm_b32 v20, v132, v132, v12
    v_perm_b32 v21, v132, v132, v13
    v_perm_b32 v22, v132, v132, v14
    v_perm_b32 v23, v132, v132, v15
    s_waitcnt vmcnt(3)
    v_mfma_f32_16x16x32_bf16 v[44:47], v[16:19], v[184:187], v[44:47]
    s_mov_b32 s45, 262656
    buffer_load_dwordx4 v[200:203], v5, s[8:11], s45 offen nt
    v_perm_b32 v16, v133, v133, v8
    v_perm_b32 v17, v133, v133, v9
    v_perm_b32 v18, v133, v133, v10
    v_perm_b32 v19, v133, v133, v11
    s_waitcnt vmcnt(3)
    v_mfma_f32_16x16x32_bf16 v[44:47], v[20:23], v[188:191], v[44:47]
    s_mov_b32 s45, 266112
    buffer_load_dwordx4 v[204:207], v5, s[8:11], s45 offen nt
    v_perm_b32 v20, v133, v133, v12
    v_perm_b32 v21, v133, v133, v13
    v_perm_b32 v22, v133, v133, v14
    v_perm_b32 v23, v133, v133, v15
    s_waitcnt vmcnt(3)
    v_mfma_f32_16x16x32_bf16 v[44:47], v[16:19], v[192:195], v[44:47]
    s_mov_b32 s45, 269568
    buffer_load_dwordx4 v[208:211], v5, s[8:11], s45 offen nt
    v_perm_b32 v16, v134, v134, v8
    v_perm_b32 v17, v134, v134, v9
    v_perm_b32 v18, v134, v134, v10
    v_perm_b32 v19, v134, v134, v11
    s_waitcnt vmcnt(3)
    v_mfma_f32_16x16x32_bf16 v[44:47], v[20:23], v[196:199], v[44:47]
    s_mov_b32 s45, 273024
    buffer_load_dwordx4 v[212:215], v5, s[8:11], s45 offen nt
    v_perm_b32 v20, v134, v134, v12
    v_perm_b32 v21, v134, v134, v13
    v_perm_b32 v22, v134, v134, v14
    v_perm_b32 v23, v134, v134, v15
    s_waitcnt vmcnt(3)
    v_mfma_f32_16x16x32_bf16 v[44:47], v[16:19], v[200:203], v[44:47]
    v_perm_b32 v16, v135, v135, v8
    v_perm_b32 v17, v135, v135, v9
    v_perm_b32 v18, v135, v135, v10
    v_perm_b32 v19, v135, v135, v11
    s_waitcnt vmcnt(2)
    v_mfma_f32_16x16x32_bf16 v[44:47], v[20:23], v[204:207], v[44:47]
    v_perm_b32 v20, v135, v135, v12
    v_perm_b32 v21, v135, v135, v13
    v_perm_b32 v22, v135, v135, v14
    v_perm_b32 v23, v135, v135, v15
    s_waitcnt vmcnt(1)
    v_mfma_f32_16x16x32_bf16 v[44:47], v[16:19], v[208:211], v[44:47]
    s_nop 1
    s_waitcnt vmcnt(0)
    v_mfma_f32_16x16x32_bf16 v[44:47], v[20:23], v[212:215], v[44:47]
    s_mul_i32 s6, s5, 81920
    s_sub_u32 s44, 2211840, s6
    s_add_u32 s8, s32, s6
    s_addc_u32 s9, s33, 0
    s_mov_b32 s10, s44
    s_mov_b32 s11, 0x20000
    v_mul_u32_u24 v5, 20480, v3
    v_lshl_add_u32 v5, v2, 4, v5
    s_mov_b32 s45, 0
    buffer_load_dwordx4 v[136:139], v5, s[8:11], s45 offen offset:0 nt
    buffer_load_dwordx4 v[140:143], v5, s[8:11], s45 offen offset:256 nt
    buffer_load_dwordx4 v[144:147], v5, s[8:11], s45 offen offset:512 nt
    buffer_load_dwordx4 v[148:151], v5, s[8:11], s45 offen offset:768 nt
    buffer_load_dwordx4 v[152:155], v5, s[8:11], s45 offen offset:1024 nt
    s_mov_b32 s45, 1280
    buffer_load_dwordx4 v[156:159], v5, s[8:11], s45 offen offset:0 nt
    buffer_load_dwordx4 v[160:163], v5, s[8:11], s45 offen offset:256 nt
    buffer_load_dwordx4 v[164:167], v5, s[8:11], s45 offen offset:512 nt
    buffer_load_dwordx4 v[168:171], v5, s[8:11], s45 offen offset:768 nt
    buffer_load_dwordx4 v[172:175], v5, s[8:11], s45 offen offset:1024 nt
    v_lshrrev_b32 v6, 1, v3
    v_lshrrev_b32 v7, 3, v2
    v_cmp_eq_u32 vcc, v6, v7
    v_lshlrev_b32 v6, 8, v6
    v_and_b32 v7, 7, v2
    v_lshl_add_u32 v6, v7, 5, v6
    v_and_b32 v7, 1, v3
    v_lshl_add_u32 v6, v7, 4, v6
    s_and_saveexec_b64 s[46:47], vcc
    ds_write_b128 v6, v[44:47] offset:8448
    s_mov_b64 exec, s[46:47]
    v_lshlrev_b32 v6, 2, v0
    s_waitcnt lgkmcnt(0)
    ds_read_b32 v54, v6 offset:8448
    ds_read_b32 v55, v6 offset:8704
    s_waitcnt lgkmcnt(0)
    v_add_f32 v54, v54, v55
    v_cvt_pk_bf16_f32 v54, v54, v54
    v_and_b32 v54, 0xffff0000, v54
    v_lshlrev_b32 v53, 16, v53
    v_add_f32 v54, v54, v53
    v_cvt_pk_bf16_f32 v54, v54, v54
    v_and_b32 v54, 0xffff0000, v54
    v_mul_f32 v55, v54, v54
    v_mul_f32 v55, v55, v54
    v_mov_b32 v56, 0x3d372713
    v_fma_f32 v55, v55, v56, v54
    v_mul_f32 v55, 0xc0135761, v55
    v_exp_f32 v55, v55
    s_nop 0
    v_add_f32 v55, 1.0, v55
    v_rcp_f32 v55, v55
    s_nop 0
    v_mul_f32 v55, v54, v55
    v_cvt_pk_bf16_f32 v55, v55, v55
    v_lshlrev_b32 v6, 1, v0
    ds_write_b16 v6, v55 offset:8960
    v_lshlrev_b32 v6, 5, v3
    s_waitcnt lgkmcnt(0)
    ds_read_b128 v[64:67], v6 offset:8960
    ds_read_b128 v[68:71], v6 offset:8976
    s_waitcnt lgkmcnt(0)
    v_perm_b32 v16, v64, v64, v8
    v_perm_b32 v17, v64, v64, v9
    v_perm_b32 v18, v64, v64, v10
    v_perm_b32 v19, v64, v64, v11
    v_perm_b32 v20, v64, v64, v12
    v_perm_b32 v21, v64, v64, v13
    v_perm_b32 v22, v64, v64, v14
    v_perm_b32 v23, v64, v64, v15
    s_waitcnt vmcnt(9)
    v_mfma_f32_16x16x32_bf16 v[24:27], v[16:19], v[136:139], v[24:27]
    s_mov_b32 s45, 2560
    buffer_load_dwordx4 v[176:179], v5, s[8:11], s45 offen offset:0 nt
    s_waitcnt vmcnt(9)
    v_mfma_f32_16x16x32_bf16 v[28:31], v[16:19], v[140:143], v[28:31]
    buffer_load_dwordx4 v[180:183], v5, s[8:11], s45 offen offset:256 nt
    s_waitcnt vmcnt(9)
    v_mfma_f32_16x16x32_bf16 v[32:35], v[16:19], v[144:147], v[32:35]
    buffer_load_dwordx4 v[184:187], v5, s[8:11], s45 offen offset:512 nt
    s_waitcnt vmcnt(9)
    v_mfma_f32_16x16x32_bf16 v[36:39], v[16:19], v[148:151], v[36:39]
    buffer_load_dwordx4 v[188:191], v5, s[8:11], s45 offen offset:768 nt
    s_waitcnt vmcnt(9)
    v_mfma_f32_16x16x32_bf16 v[40:43], v[16:19], v[152:155], v[40:43]
    buffer_load_dwordx4 v[192:195], v5, s[8:11], s45 offen offset:1024 nt
    v_perm_b32 v16, v65, v65, v8
    v_perm_b32 v17, v65, v65, v9
    v_perm_b32 v18, v65, v65, v10
    v_perm_b32 v19, v65, v65, v11
    s_waitcnt vmcnt(9)
    v_mfma_f32_16x16x32_bf16 v[24:27], v[20:23], v[156:159], v[24:27]
    s_mov_b32 s45, 3840
    buffer_load_dwordx4 v[196:199], v5, s[8:11], s45 offen offset:0 nt
    s_waitcnt vmcnt(9)
    v_mfma_f32_16x16x32_bf16 v[28:31], v[20:23], v[160:163], v[28:31]
    buffer_load_dwordx4 v[200:203], v5, s[8:11], s45 offen offset:256 nt
    s_waitcnt vmcnt(9)
    v_mfma_f32_16x16x32_bf16 v[32:35], v[20:23], v[164:167], v[32:35]
    buffer_load_dwordx4 v[204:207], v5, s[8:11], s45 offen offset:512 nt
    s_waitcnt vmcnt(9)
    v_mfma_f32_16x16x32_bf16 v[36:39], v[20:23], v[168:171], v[36:39]
    buffer_load_dwordx4 v[208:211], v5, s[8:11], s45 offen offset:768 nt
    s_waitcnt vmcnt(9)
    v_mfma_f32_16x16x32_bf16 v[40:43], v[20:23], v[172:175], v[40:43]
    buffer_load_dwordx4 v[212:215], v5, s[8:11], s45 offen offset:1024 nt
    v_perm_b32 v20, v65, v65, v12
    v_perm_b32 v21, v65, v65, v13
    v_perm_b32 v22, v65, v65, v14
    v_perm_b32 v23, v65, v65, v15
    s_waitcnt vmcnt(9)
    v_mfma_f32_16x16x32_bf16 v[24:27], v[16:19], v[176:179], v[24:27]
    s_mov_b32 s45, 5120
    buffer_load_dwordx4 v[216:219], v5, s[8:11], s45 offen offset:0 nt
    s_waitcnt vmcnt(9)
    v_mfma_f32_16x16x32_bf16 v[28:31], v[16:19], v[180:183], v[28:31]
    buffer_load_dwordx4 v[220:223], v5, s[8:11], s45 offen offset:256 nt
    s_waitcnt vmcnt(9)
    v_mfma_f32_16x16x32_bf16 v[32:35], v[16:19], v[184:187], v[32:35]
    buffer_load_dwordx4 v[224:227], v5, s[8:11], s45 offen offset:512 nt
    s_waitcnt vmcnt(9)
    v_mfma_f32_16x16x32_bf16 v[36:39], v[16:19], v[188:191], v[36:39]
    buffer_load_dwordx4 v[228:231], v5, s[8:11], s45 offen offset:768 nt
    s_waitcnt vmcnt(9)
    v_mfma_f32_16x16x32_bf16 v[40:43], v[16:19], v[192:195], v[40:43]
    buffer_load_dwordx4 v[232:235], v5, s[8:11], s45 offen offset:1024 nt
    v_perm_b32 v16, v66, v66, v8
    v_perm_b32 v17, v66, v66, v9
    v_perm_b32 v18, v66, v66, v10
    v_perm_b32 v19, v66, v66, v11
    s_waitcnt vmcnt(9)
    v_mfma_f32_16x16x32_bf16 v[24:27], v[20:23], v[196:199], v[24:27]
    s_mov_b32 s45, 6400
    buffer_load_dwordx4 v[236:239], v5, s[8:11], s45 offen offset:0 nt
    s_waitcnt vmcnt(9)
    v_mfma_f32_16x16x32_bf16 v[28:31], v[20:23], v[200:203], v[28:31]
    buffer_load_dwordx4 v[240:243], v5, s[8:11], s45 offen offset:256 nt
    s_waitcnt vmcnt(9)
    v_mfma_f32_16x16x32_bf16 v[32:35], v[20:23], v[204:207], v[32:35]
    buffer_load_dwordx4 v[244:247], v5, s[8:11], s45 offen offset:512 nt
    s_waitcnt vmcnt(9)
    v_mfma_f32_16x16x32_bf16 v[36:39], v[20:23], v[208:211], v[36:39]
    buffer_load_dwordx4 v[248:251], v5, s[8:11], s45 offen offset:768 nt
    s_waitcnt vmcnt(9)
    v_mfma_f32_16x16x32_bf16 v[40:43], v[20:23], v[212:215], v[40:43]
    buffer_load_dwordx4 v[252:255], v5, s[8:11], s45 offen offset:1024 nt
    v_perm_b32 v20, v66, v66, v12
    v_perm_b32 v21, v66, v66, v13
    v_perm_b32 v22, v66, v66, v14
    v_perm_b32 v23, v66, v66, v15
    s_waitcnt vmcnt(9)
    v_mfma_f32_16x16x32_bf16 v[24:27], v[16:19], v[216:219], v[24:27]
    s_mov_b32 s45, 7680
    buffer_load_dwordx4 v[136:139], v5, s[8:11], s45 offen offset:0 nt
    s_waitcnt vmcnt(9)
    v_mfma_f32_16x16x32_bf16 v[28:31], v[16:19], v[220:223], v[28:31]
    buffer_load_dwordx4 v[140:143], v5, s[8:11], s45 offen offset:256 nt
    s_waitcnt vmcnt(9)
    v_mfma_f32_16x16x32_bf16 v[32:35], v[16:19], v[224:227], v[32:35]
    buffer_load_dwordx4 v[144:147], v5, s[8:11], s45 offen offset:512 nt
    s_waitcnt vmcnt(9)
    v_mfma_f32_16x16x32_bf16 v[36:39], v[16:19], v[228:231], v[36:39]
    buffer_load_dwordx4 v[148:151], v5, s[8:11], s45 offen offset:768 nt
    s_waitcnt vmcnt(9)
    v_mfma_f32_16x16x32_bf16 v[40:43], v[16:19], v[232:235], v[40:43]
    buffer_load_dwordx4 v[152:155], v5, s[8:11], s45 offen offset:1024 nt
    v_perm_b32 v16, v67, v67, v8
    v_perm_b32 v17, v67, v67, v9
    v_perm_b32 v18, v67, v67, v10
    v_perm_b32 v19, v67, v67, v11
    s_waitcnt vmcnt(9)
    v_mfma_f32_16x16x32_bf16 v[24:27], v[20:23], v[236:239], v[24:27]
    s_mov_b32 s45, 8960
    buffer_load_dwordx4 v[156:159], v5, s[8:11], s45 offen offset:0 nt
    s_waitcnt vmcnt(9)
    v_mfma_f32_16x16x32_bf16 v[28:31], v[20:23], v[240:243], v[28:31]
    buffer_load_dwordx4 v[160:163], v5, s[8:11], s45 offen offset:256 nt
    s_waitcnt vmcnt(9)
    v_mfma_f32_16x16x32_bf16 v[32:35], v[20:23], v[244:247], v[32:35]
    buffer_load_dwordx4 v[164:167], v5, s[8:11], s45 offen offset:512 nt
    s_waitcnt vmcnt(9)
    v_mfma_f32_16x16x32_bf16 v[36:39], v[20:23], v[248:251], v[36:39]
    buffer_load_dwordx4 v[168:171], v5, s[8:11], s45 offen offset:768 nt
    s_waitcnt vmcnt(9)
    v_mfma_f32_16x16x32_bf16 v[40:43], v[20:23], v[252:255], v[40:43]
    buffer_load_dwordx4 v[172:175], v5, s[8:11], s45 offen offset:1024 nt
    v_perm_b32 v20, v67, v67, v12
    v_perm_b32 v21, v67, v67, v13
    v_perm_b32 v22, v67, v67, v14
    v_perm_b32 v23, v67, v67, v15
    s_waitcnt vmcnt(9)
    v_mfma_f32_16x16x32_bf16 v[24:27], v[16:19], v[136:139], v[24:27]
    s_mov_b32 s45, 10240
    buffer_load_dwordx4 v[176:179], v5, s[8:11], s45 offen offset:0 nt
    s_waitcnt vmcnt(9)
    v_mfma_f32_16x16x32_bf16 v[28:31], v[16:19], v[140:143], v[28:31]
    buffer_load_dwordx4 v[180:183], v5, s[8:11], s45 offen offset:256 nt
    s_waitcnt vmcnt(9)
    v_mfma_f32_16x16x32_bf16 v[32:35], v[16:19], v[144:147], v[32:35]
    buffer_load_dwordx4 v[184:187], v5, s[8:11], s45 offen offset:512 nt
    s_waitcnt vmcnt(9)
    v_mfma_f32_16x16x32_bf16 v[36:39], v[16:19], v[148:151], v[36:39]
    buffer_load_dwordx4 v[188:191], v5, s[8:11], s45 offen offset:768 nt
    s_waitcnt vmcnt(9)
    v_mfma_f32_16x16x32_bf16 v[40:43], v[16:19], v[152:155], v[40:43]
    buffer_load_dwordx4 v[192:195], v5, s[8:11], s45 offen offset:1024 nt
    v_perm_b32 v16, v68, v68, v8
    v_perm_b32 v17, v68, v68, v9
    v_perm_b32 v18, v68, v68, v10
    v_perm_b32 v19, v68, v68, v11
    s_waitcnt vmcnt(9)
    v_mfma_f32_16x16x32_bf16 v[24:27], v[20:23], v[156:159], v[24:27]
    s_mov_b32 s45, 11520
    buffer_load_dwordx4 v[196:199], v5, s[8:11], s45 offen offset:0 nt
    s_waitcnt vmcnt(9)
    v_mfma_f32_16x16x32_bf16 v[28:31], v[20:23], v[160:163], v[28:31]
    buffer_load_dwordx4 v[200:203], v5, s[8:11], s45 offen offset:256 nt
    s_waitcnt vmcnt(9)
    v_mfma_f32_16x16x32_bf16 v[32:35], v[20:23], v[164:167], v[32:35]
    buffer_load_dwordx4 v[204:207], v5, s[8:11], s45 offen offset:512 nt
    s_waitcnt vmcnt(9)
    v_mfma_f32_16x16x32_bf16 v[36:39], v[20:23], v[168:171], v[36:39]
    buffer_load_dwordx4 v[208:211], v5, s[8:11], s45 offen offset:768 nt
    s_waitcnt vmcnt(9)
    v_mfma_f32_16x16x32_bf16 v[40:43], v[20:23], v[172:175], v[40:43]
    buffer_load_dwordx4 v[212:215], v5, s[8:11], s45 offen offset:1024 nt
    v_perm_b32 v20, v68, v68, v12
    v_perm_b32 v21, v68, v68, v13
    v_perm_b32 v22, v68, v68, v14
    v_perm_b32 v23, v68, v68, v15
    s_waitcnt vmcnt(9)
    v_mfma_f32_16x16x32_bf16 v[24:27], v[16:19], v[176:179], v[24:27]
    s_mov_b32 s45, 12800
    buffer_load_dwordx4 v[216:219], v5, s[8:11], s45 offen offset:0 nt
    s_waitcnt vmcnt(9)
    v_mfma_f32_16x16x32_bf16 v[28:31], v[16:19], v[180:183], v[28:31]
    buffer_load_dwordx4 v[220:223], v5, s[8:11], s45 offen offset:256 nt
    s_waitcnt vmcnt(9)
    v_mfma_f32_16x16x32_bf16 v[32:35], v[16:19], v[184:187], v[32:35]
    buffer_load_dwordx4 v[224:227], v5, s[8:11], s45 offen offset:512 nt
    s_waitcnt vmcnt(9)
    v_mfma_f32_16x16x32_bf16 v[36:39], v[16:19], v[188:191], v[36:39]
    buffer_load_dwordx4 v[228:231], v5, s[8:11], s45 offen offset:768 nt
    s_waitcnt vmcnt(9)
    v_mfma_f32_16x16x32_bf16 v[40:43], v[16:19], v[192:195], v[40:43]
    buffer_load_dwordx4 v[232:235], v5, s[8:11], s45 offen offset:1024 nt
    v_perm_b32 v16, v69, v69, v8
    v_perm_b32 v17, v69, v69, v9
    v_perm_b32 v18, v69, v69, v10
    v_perm_b32 v19, v69, v69, v11
    s_waitcnt vmcnt(9)
    v_mfma_f32_16x16x32_bf16 v[24:27], v[20:23], v[196:199], v[24:27]
    s_mov_b32 s45, 14080
    buffer_load_dwordx4 v[236:239], v5, s[8:11], s45 offen offset:0 nt
    s_waitcnt vmcnt(9)
    v_mfma_f32_16x16x32_bf16 v[28:31], v[20:23], v[200:203], v[28:31]
    buffer_load_dwordx4 v[240:243], v5, s[8:11], s45 offen offset:256 nt
    s_waitcnt vmcnt(9)
    v_mfma_f32_16x16x32_bf16 v[32:35], v[20:23], v[204:207], v[32:35]
    buffer_load_dwordx4 v[244:247], v5, s[8:11], s45 offen offset:512 nt
    s_waitcnt vmcnt(9)
    v_mfma_f32_16x16x32_bf16 v[36:39], v[20:23], v[208:211], v[36:39]
    buffer_load_dwordx4 v[248:251], v5, s[8:11], s45 offen offset:768 nt
    s_waitcnt vmcnt(9)
    v_mfma_f32_16x16x32_bf16 v[40:43], v[20:23], v[212:215], v[40:43]
    buffer_load_dwordx4 v[252:255], v5, s[8:11], s45 offen offset:1024 nt
    v_perm_b32 v20, v69, v69, v12
    v_perm_b32 v21, v69, v69, v13
    v_perm_b32 v22, v69, v69, v14
    v_perm_b32 v23, v69, v69, v15
    s_waitcnt vmcnt(9)
    v_mfma_f32_16x16x32_bf16 v[24:27], v[16:19], v[216:219], v[24:27]
    s_mov_b32 s45, 15360
    buffer_load_dwordx4 v[136:139], v5, s[8:11], s45 offen offset:0 nt
    s_waitcnt vmcnt(9)
    v_mfma_f32_16x16x32_bf16 v[28:31], v[16:19], v[220:223], v[28:31]
    buffer_load_dwordx4 v[140:143], v5, s[8:11], s45 offen offset:256 nt
    s_waitcnt vmcnt(9)
    v_mfma_f32_16x16x32_bf16 v[32:35], v[16:19], v[224:227], v[32:35]
    buffer_load_dwordx4 v[144:147], v5, s[8:11], s45 offen offset:512 nt
    s_waitcnt vmcnt(9)
    v_mfma_f32_16x16x32_bf16 v[36:39], v[16:19], v[228:231], v[36:39]
    buffer_load_dwordx4 v[148:151], v5, s[8:11], s45 offen offset:768 nt
    s_waitcnt vmcnt(9)
    v_mfma_f32_16x16x32_bf16 v[40:43], v[16:19], v[232:235], v[40:43]
    buffer_load_dwordx4 v[152:155], v5, s[8:11], s45 offen offset:1024 nt
    v_perm_b32 v16, v70, v70, v8
    v_perm_b32 v17, v70, v70, v9
    v_perm_b32 v18, v70, v70, v10
    v_perm_b32 v19, v70, v70, v11
    s_waitcnt vmcnt(9)
    v_mfma_f32_16x16x32_bf16 v[24:27], v[20:23], v[236:239], v[24:27]
    s_mov_b32 s45, 16640
    buffer_load_dwordx4 v[156:159], v5, s[8:11], s45 offen offset:0 nt
    s_waitcnt vmcnt(9)
    v_mfma_f32_16x16x32_bf16 v[28:31], v[20:23], v[240:243], v[28:31]
    buffer_load_dwordx4 v[160:163], v5, s[8:11], s45 offen offset:256 nt
    s_waitcnt vmcnt(9)
    v_mfma_f32_16x16x32_bf16 v[32:35], v[20:23], v[244:247], v[32:35]
    buffer_load_dwordx4 v[164:167], v5, s[8:11], s45 offen offset:512 nt
    s_waitcnt vmcnt(9)
    v_mfma_f32_16x16x32_bf16 v[36:39], v[20:23], v[248:251], v[36:39]
    buffer_load_dwordx4 v[168:171], v5, s[8:11], s45 offen offset:768 nt
    s_waitcnt vmcnt(9)
    v_mfma_f32_16x16x32_bf16 v[40:43], v[20:23], v[252:255], v[40:43]
    buffer_load_dwordx4 v[172:175], v5, s[8:11], s45 offen offset:1024 nt
    v_perm_b32 v20, v70, v70, v12
    v_perm_b32 v21, v70, v70, v13
    v_perm_b32 v22, v70, v70, v14
    v_perm_b32 v23, v70, v70, v15
    s_waitcnt vmcnt(9)
    v_mfma_f32_16x16x32_bf16 v[24:27], v[16:19], v[136:139], v[24:27]
    s_mov_b32 s45, 17920
    buffer_load_dwordx4 v[176:179], v5, s[8:11], s45 offen offset:0 nt
    s_waitcnt vmcnt(9)
    v_mfma_f32_16x16x32_bf16 v[28:31], v[16:19], v[140:143], v[28:31]
    buffer_load_dwordx4 v[180:183], v5, s[8:11], s45 offen offset:256 nt
    s_waitcnt vmcnt(9)
    v_mfma_f32_16x16x32_bf16 v[32:35], v[16:19], v[144:147], v[32:35]
    buffer_load_dwordx4 v[184:187], v5, s[8:11], s45 offen offset:512 nt
    s_waitcnt vmcnt(9)
    v_mfma_f32_16x16x32_bf16 v[36:39], v[16:19], v[148:151], v[36:39]
    buffer_load_dwordx4 v[188:191], v5, s[8:11], s45 offen offset:768 nt
    s_waitcnt vmcnt(9)
    v_mfma_f32_16x16x32_bf16 v[40:43], v[16:19], v[152:155], v[40:43]
    buffer_load_dwordx4 v[192:195], v5, s[8:11], s45 offen offset:1024 nt
    v_perm_b32 v16, v71, v71, v8
    v_perm_b32 v17, v71, v71, v9
    v_perm_b32 v18, v71, v71, v10
    v_perm_b32 v19, v71, v71, v11
    s_waitcnt vmcnt(9)
    v_mfma_f32_16x16x32_bf16 v[24:27], v[20:23], v[156:159], v[24:27]
    s_mov_b32 s45, 19200
    buffer_load_dwordx4 v[196:199], v5, s[8:11], s45 offen offset:0 nt
    s_waitcnt vmcnt(9)
    v_mfma_f32_16x16x32_bf16 v[28:31], v[20:23], v[160:163], v[28:31]
    buffer_load_dwordx4 v[200:203], v5, s[8:11], s45 offen offset:256 nt
    s_waitcnt vmcnt(9)
    v_mfma_f32_16x16x32_bf16 v[32:35], v[20:23], v[164:167], v[32:35]
    buffer_load_dwordx4 v[204:207], v5, s[8:11], s45 offen offset:512 nt
    s_waitcnt vmcnt(9)
    v_mfma_f32_16x16x32_bf16 v[36:39], v[20:23], v[168:171], v[36:39]
    buffer_load_dwordx4 v[208:211], v5, s[8:11], s45 offen offset:768 nt
    s_waitcnt vmcnt(9)
    v_mfma_f32_16x16x32_bf16 v[40:43], v[20:23], v[172:175], v[40:43]
    buffer_load_dwordx4 v[212:215], v5, s[8:11], s45 offen offset:1024 nt
    v_perm_b32 v20, v71, v71, v12
    v_perm_b32 v21, v71, v71, v13
    v_perm_b32 v22, v71, v71, v14
    v_perm_b32 v23, v71, v71, v15
    s_waitcnt vmcnt(9)
    v_mfma_f32_16x16x32_bf16 v[24:27], v[16:19], v[176:179], v[24:27]
    s_waitcnt vmcnt(8)
    v_mfma_f32_16x16x32_bf16 v[28:31], v[16:19], v[180:183], v[28:31]
    s_waitcnt vmcnt(7)
    v_mfma_f32_16x16x32_bf16 v[32:35], v[16:19], v[184:187], v[32:35]
    s_waitcnt vmcnt(6)
    v_mfma_f32_16x16x32_bf16 v[36:39], v[16:19], v[188:191], v[36:39]
    s_waitcnt vmcnt(5)
    v_mfma_f32_16x16x32_bf16 v[40:43], v[16:19], v[192:195], v[40:43]
    s_nop 1
    s_waitcnt vmcnt(4)
    v_mfma_f32_16x16x32_bf16 v[24:27], v[20:23], v[196:199], v[24:27]
    s_waitcnt vmcnt(3)
    v_mfma_f32_16x16x32_bf16 v[28:31], v[20:23], v[200:203], v[28:31]
    s_waitcnt vmcnt(2)
    v_mfma_f32_16x16x32_bf16 v[32:35], v[20:23], v[204:207], v[32:35]
    s_waitcnt vmcnt(1)
    v_mfma_f32_16x16x32_bf16 v[36:39], v[20:23], v[208:211], v[36:39]
    s_waitcnt vmcnt(0)
    v_mfma_f32_16x16x32_bf16 v[40:43], v[20:23], v[212:215], v[40:43]
L_wo:
    s_cmp_lg_u32 s42, 1
    s_cbranch_scc1 L_zero_done
    s_mul_i32 s6, s4, 2560
    s_mul_i32 s43, s5, 80
    s_add_u32 s6, s6, s43
    s_add_u32 s6, s6, 0x100000
    s_add_u32 s8, s40, s6
    s_addc_u32 s9, s41, 0
    s_mov_b32 s10, 80
    s_mov_b32 s11, 0x20000
    v_lshlrev_b32 v6, 2, v0
    v_mov_b32 v7, 0
    buffer_store_dword v7, v6, s[8:11], 0 offen sc1
    s_lshl_b32 s6, s4, 5
    v_mov_b32 v6, s6
    v_mov_b32 v7, 1
    s_waitcnt vmcnt(0)
    s_mov_b64 exec, 1
    global_atomic_add v6, v7, s[38:39] offset:4
    s_mov_b64 exec, -1
L_zero_done:
    s_getreg_b32 s76, hwreg(HW_REG_XCC_ID)
    s_and_b32 s76, s76, 7
    s_lshl_b32 s76, s76, 8
    s_add_u32 s76, s76, 0x200000
    s_getreg_b32 s77, hwreg(HW_REG_HW_ID)
    s_bfe_u32 s78, s77, 0x2000d
    s_bfe_u32 s77, s77, 0x40008
    s_lshl_b32 s78, s78, 4
    s_add_u32 s77, s77, s78
    s_lshl_b32 s77, s77, 2
    s_add_u32 s77, s77, s76
    s_cmp_lg_u32 s42, 3
    s_cbranch_scc1 L_slot_done
    v_lshlrev_b32 v6, 2, v0
    v_add_u32 v6, s76, v6
    v_bfrev_b32 v7, 1
    global_store_dword v6, v7, s[40:41]
L_slot_done:
    s_mul_i32 s6, s5, 163840
    s_add_u32 s8, s24, s6
    s_addc_u32 s9, s25, 0
    s_mov_b32 s10, 163840
    s_mov_b32 s11, 0x20000
    s_lshl_b32 s43, s42, 5
    v_lshlrev_b32 v5, 3, v3
    v_add_u32 v5, s43, v5
    v_mul_u32_u24 v5, 1280, v5
    v_lshl_add_u32 v5, v2, 4, v5
    s_mov_b32 s45, 0
    buffer_load_dwordx4 v[96:99], v5, s[8:11], s45 offen offset:0 nt
    buffer_load_dwordx4 v[100:103], v5, s[8:11], s45 offen offset:256 nt
    s_waitcnt vmcnt(1)
    buffer_load_dwordx4 v[104:107], v5, s[8:11], s45 offen offset:512 nt
    s_waitcnt vmcnt(1)
    buffer_load_dwordx4 v[108:111], v5, s[8:11], s45 offen offset:768 nt
    s_waitcnt vmcnt(1)
    buffer_load_dwordx4 v[112:115], v5, s[8:11], s45 offen offset:1024 nt
    s_mov_b32 s45, 1280
    s_waitcnt vmcnt(1)
    buffer_load_dwordx4 v[116:119], v5, s[8:11], s45 offen offset:0 nt
    s_waitcnt vmcnt(1)
    buffer_load_dwordx4 v[120:123], v5, s[8:11], s45 offen offset:256 nt
    s_waitcnt vmcnt(1)
    buffer_load_dwordx4 v[124:127], v5, s[8:11], s45 offen offset:512 nt
    s_waitcnt vmcnt(1)
    buffer_load_dwordx4 v[128:131], v5, s[8:11], s45 offen offset:768 nt
    s_waitcnt vmcnt(1)
    buffer_load_dwordx4 v[132:135], v5, s[8:11], s45 offen offset:1024 nt
    s_mov_b32 s45, 2560
    s_waitcnt vmcnt(1)
    buffer_load_dwordx4 v[136:139], v5, s[8:11], s45 offen offset:0 nt
    s_waitcnt vmcnt(1)
    buffer_load_dwordx4 v[140:143], v5, s[8:11], s45 offen offset:256 nt
    s_waitcnt vmcnt(1)
    buffer_load_dwordx4 v[144:147], v5, s[8:11], s45 offen offset:512 nt
    s_waitcnt vmcnt(1)
    buffer_load_dwordx4 v[148:151], v5, s[8:11], s45 offen offset:768 nt
    s_waitcnt vmcnt(1)
    buffer_load_dwordx4 v[152:155], v5, s[8:11], s45 offen offset:1024 nt
    s_mov_b32 s45, 3840
    s_waitcnt vmcnt(1)
    buffer_load_dwordx4 v[156:159], v5, s[8:11], s45 offen offset:0 nt
    s_waitcnt vmcnt(1)
    buffer_load_dwordx4 v[160:163], v5, s[8:11], s45 offen offset:256 nt
    s_waitcnt vmcnt(1)
    buffer_load_dwordx4 v[164:167], v5, s[8:11], s45 offen offset:512 nt
    s_waitcnt vmcnt(1)
    buffer_load_dwordx4 v[168:171], v5, s[8:11], s45 offen offset:768 nt
    s_waitcnt vmcnt(1)
    buffer_load_dwordx4 v[172:175], v5, s[8:11], s45 offen offset:1024 nt
    s_mov_b32 s45, 5120
    s_waitcnt vmcnt(1)
    buffer_load_dwordx4 v[176:179], v5, s[8:11], s45 offen offset:0 nt
    s_waitcnt vmcnt(1)
    buffer_load_dwordx4 v[180:183], v5, s[8:11], s45 offen offset:256 nt
    s_waitcnt vmcnt(1)
    buffer_load_dwordx4 v[184:187], v5, s[8:11], s45 offen offset:512 nt
    s_waitcnt vmcnt(1)
    buffer_load_dwordx4 v[188:191], v5, s[8:11], s45 offen offset:768 nt
    s_waitcnt vmcnt(1)
    buffer_load_dwordx4 v[192:195], v5, s[8:11], s45 offen offset:1024 nt
    s_mov_b32 s45, 6400
    s_waitcnt vmcnt(1)
    buffer_load_dwordx4 v[196:199], v5, s[8:11], s45 offen offset:0 nt
    s_waitcnt vmcnt(1)
    buffer_load_dwordx4 v[200:203], v5, s[8:11], s45 offen offset:256 nt
    s_waitcnt vmcnt(1)
    buffer_load_dwordx4 v[204:207], v5, s[8:11], s45 offen offset:512 nt
    s_waitcnt vmcnt(1)
    buffer_load_dwordx4 v[208:211], v5, s[8:11], s45 offen offset:768 nt
    s_waitcnt vmcnt(1)
    buffer_load_dwordx4 v[212:215], v5, s[8:11], s45 offen offset:1024 nt
    s_mov_b32 s45, 7680
    s_waitcnt vmcnt(1)
    buffer_load_dwordx4 v[216:219], v5, s[8:11], s45 offen offset:0 nt
    s_waitcnt vmcnt(1)
    buffer_load_dwordx4 v[220:223], v5, s[8:11], s45 offen offset:256 nt
    s_waitcnt vmcnt(1)
    buffer_load_dwordx4 v[224:227], v5, s[8:11], s45 offen offset:512 nt
    s_waitcnt vmcnt(1)
    buffer_load_dwordx4 v[228:231], v5, s[8:11], s45 offen offset:768 nt
    s_waitcnt vmcnt(1)
    buffer_load_dwordx4 v[232:235], v5, s[8:11], s45 offen offset:1024 nt
    s_mov_b32 s45, 8960
    s_waitcnt vmcnt(1)
    buffer_load_dwordx4 v[236:239], v5, s[8:11], s45 offen offset:0 nt
    s_waitcnt vmcnt(1)
    buffer_load_dwordx4 v[240:243], v5, s[8:11], s45 offen offset:256 nt
    s_waitcnt vmcnt(1)
    buffer_load_dwordx4 v[244:247], v5, s[8:11], s45 offen offset:512 nt
    s_waitcnt vmcnt(1)
    buffer_load_dwordx4 v[248:251], v5, s[8:11], s45 offen offset:768 nt
    s_waitcnt vmcnt(1)
    buffer_load_dwordx4 v[252:255], v5, s[8:11], s45 offen offset:1024 nt
    s_cmp_lg_u32 s42, 3
    s_cbranch_scc1 L_c8_done
    v_mov_b32 v6, 0
    v_mov_b32 v4, s77
    v_lshlrev_b32 v5, 2, v0
    v_add_u32 v5, s76, v5
    s_mov_b32 s78, -1
    s_mov_b32 s79, 0
L_c8:
    ds_read_b32 v7, v6 offset:22528
    s_waitcnt lgkmcnt(0)
    v_readfirstlane_b32 s80, v7
    s_cmp_ge_u32 s80, 122
    s_cbranch_scc1 L_c8_exit
    s_cmp_eq_u32 s80, s78
    s_cbranch_scc1 L_c8_sleep
    s_mov_b32 s78, s80
    s_mov_b64 exec, 1
    global_store_dword v4, v7, s[40:41]
    s_mov_b64 exec, -1
    global_load_dword v72, v5, s[40:41] sc1
    s_waitcnt vmcnt(0)
    v_cmp_gt_i32 vcc, 0, v72
    v_sub_u32 v72, v72, v7
    v_med3_i32 v72, v72, -8, 8
    v_cndmask_b32 v72, v72, v6, vcc
    s_nop 1
    v_add_u32_dpp v72, v72, v72 row_ror:8 row_mask:0xf bank_mask:0xf
    s_nop 1
    v_add_u32_dpp v72, v72, v72 row_ror:4 row_mask:0xf bank_mask:0xf
    s_nop 1
    v_add_u32_dpp v72, v72, v72 row_ror:2 row_mask:0xf bank_mask:0xf
    s_nop 1
    v_add_u32_dpp v72, v72, v72 row_ror:1 row_mask:0xf bank_mask:0xf
    s_nop 0
    v_readlane_b32 s81, v72, 0
    v_readlane_b32 s82, v72, 16
    v_readlane_b32 s84, v72, 32
    v_readlane_b32 s85, v72, 48
    s_add_i32 s81, s81, s82
    s_add_i32 s84, s84, s85
    s_add_i32 s81, s81, s84
    s_mov_b32 s83, s79
    s_cmp_ge_i32 s81, 16
    s_cselect_b32 s83, 1, s83
    s_cmp_le_i32 s81, 0
    s_cselect_b32 s83, 0, s83
    s_cmp_eq_u32 s83, s79
    s_cbranch_scc1 L_c8_sleep
    s_mov_b32 s79, s83
    v_mov_b32 v73, s83
    ds_write_b32 v6, v73 offset:22544
L_c8_sleep:
    s_sleep 2
    s_branch L_c8
L_c8_exit:
    s_mov_b64 exec, -1
L_c8_done:
    s_lshl_b32 s6, s4, 5
    v_mov_b32 v90, s6
    v_mov_b32 v91, 1
    s_cmp_lg_u32 s42, 0
    s_cbranch_scc1 L_zchk_done
L_zchk:
    s_mov_b64 exec, 1
    global_load_dword v89, v90, s[38:39] offset:4 sc1
    s_waitcnt vmcnt(0)
    v_readfirstlane_b32 s51, v89
    s_mov_b64 exec, -1
    s_cmp_ge_u32 s51, 32
    s_cbranch_scc1 L_zchk_done
    s_sleep 8
    s_branch L_zchk
L_zchk_done:
    v_lshlrev_b32 v4, 3, v0
    s_mul_i32 s6, s4, 1280
    s_add_u32 s12, s16, s6
    s_addc_u32 s13, s17, 0
    s_mov_b32 s14, 1280
    s_mov_b32 s15, 0x20000
    s_mov_b32 s68, s34
    s_mov_b32 s69, s35
    s_mov_b32 s70, 1280
    s_mov_b32 s71, 0x20000
    buffer_load_dwordx2 v[92:93], v4, s[12:15], 0 offen offset:0
    buffer_load_dwordx2 v[44:45], v4, s[68:71], 0 offen offset:0
    buffer_load_dwordx2 v[94:95], v4, s[12:15], 0 offen offset:512
    buffer_load_dwordx2 v[46:47], v4, s[68:71], 0 offen offset:512
    buffer_load_dwordx2 v[88:89], v4, s[12:15], 0 offen offset:1024
    buffer_load_dwordx2 v[60:61], v4, s[68:71], 0 offen offset:1024
    v_lshlrev_b32 v4, 5, v3
    s_lshl_b32 s43, s42, 7
    v_add_u32 v4, s43, v4
    v_mov_b32 v5, 0
    s_waitcnt vmcnt(0)
    s_barrier
    ds_read_b128 v[64:67], v5 offset:11264
    ds_read_b128 v[68:71], v5 offset:11280
    ds_read_b128 v[72:75], v4 offset:9216
    ds_read_b128 v[76:79], v4 offset:9232
    ds_read_b128 v[80:83], v4 offset:9728
    ds_read_b128 v[84:87], v4 offset:9744
    ds_read_b128 v[48:51], v4 offset:10240
    ds_read_b128 v[52:55], v4 offset:10256
    ds_read_b128 v[16:19], v4 offset:10752
    ds_read_b128 v[20:23], v4 offset:10768
    s_waitcnt lgkmcnt(8)
    v_max3_f32 v6, v64, v66, v68
    v_max_f32 v6, v6, v70
    v_sub_f32 v64, v64, v6
    v_mul_f32 v64, 0x3fb8aa3b, v64
    v_exp_f32 v64, v64
    v_sub_f32 v66, v66, v6
    v_mul_f32 v66, 0x3fb8aa3b, v66
    v_exp_f32 v66, v66
    v_sub_f32 v68, v68, v6
    v_mul_f32 v68, 0x3fb8aa3b, v68
    v_exp_f32 v68, v68
    v_sub_f32 v70, v70, v6
    v_mul_f32 v70, 0x3fb8aa3b, v70
    v_exp_f32 v70, v70
    s_nop 0
    v_mul_f32 v7, v64, v65
    v_fmac_f32 v7, v66, v67
    v_fmac_f32 v7, v68, v69
    v_fmac_f32 v7, v70, v71
    v_rcp_f32 v7, v7
    s_nop 0
    s_waitcnt lgkmcnt(0)
    v_mul_f32 v72, v72, v64
    v_fmac_f32 v72, v80, v66
    v_fmac_f32 v72, v48, v68
    v_fmac_f32 v72, v16, v70
    v_mul_f32 v72, v72, v7
    v_mul_f32 v73, v73, v64
    v_fmac_f32 v73, v81, v66
    v_fmac_f32 v73, v49, v68
    v_fmac_f32 v73, v17, v70
    v_mul_f32 v73, v73, v7
    v_mul_f32 v74, v74, v64
    v_fmac_f32 v74, v82, v66
    v_fmac_f32 v74, v50, v68
    v_fmac_f32 v74, v18, v70
    v_mul_f32 v74, v74, v7
    v_mul_f32 v75, v75, v64
    v_fmac_f32 v75, v83, v66
    v_fmac_f32 v75, v51, v68
    v_fmac_f32 v75, v19, v70
    v_mul_f32 v75, v75, v7
    v_mul_f32 v76, v76, v64
    v_fmac_f32 v76, v84, v66
    v_fmac_f32 v76, v52, v68
    v_fmac_f32 v76, v20, v70
    v_mul_f32 v76, v76, v7
    v_mul_f32 v77, v77, v64
    v_fmac_f32 v77, v85, v66
    v_fmac_f32 v77, v53, v68
    v_fmac_f32 v77, v21, v70
    v_mul_f32 v77, v77, v7
    v_mul_f32 v78, v78, v64
    v_fmac_f32 v78, v86, v66
    v_fmac_f32 v78, v54, v68
    v_fmac_f32 v78, v22, v70
    v_mul_f32 v78, v78, v7
    v_mul_f32 v79, v79, v64
    v_fmac_f32 v79, v87, v66
    v_fmac_f32 v79, v55, v68
    v_fmac_f32 v79, v23, v70
    v_mul_f32 v79, v79, v7
    v_cvt_pk_bf16_f32 v56, v72, v73
    v_cvt_pk_bf16_f32 v57, v74, v75
    v_cvt_pk_bf16_f32 v58, v76, v77
    v_cvt_pk_bf16_f32 v59, v78, v79
    v_perm_b32 v16, v56, v56, v8
    v_perm_b32 v17, v56, v56, v9
    v_perm_b32 v18, v56, v56, v10
    v_perm_b32 v19, v56, v56, v11
    v_perm_b32 v20, v56, v56, v12
    v_perm_b32 v21, v56, v56, v13
    v_perm_b32 v22, v56, v56, v14
    v_perm_b32 v23, v56, v56, v15
    s_nop 1
    v_mfma_f32_16x16x32_bf16 v[24:27], v[16:19], v[96:99], v[24:27]
    v_mfma_f32_16x16x32_bf16 v[28:31], v[16:19], v[100:103], v[28:31]
    v_mfma_f32_16x16x32_bf16 v[32:35], v[16:19], v[104:107], v[32:35]
    v_mfma_f32_16x16x32_bf16 v[36:39], v[16:19], v[108:111], v[36:39]
    v_mfma_f32_16x16x32_bf16 v[40:43], v[16:19], v[112:115], v[40:43]
    v_perm_b32 v16, v57, v57, v8
    v_perm_b32 v17, v57, v57, v9
    v_perm_b32 v18, v57, v57, v10
    v_perm_b32 v19, v57, v57, v11
    v_mfma_f32_16x16x32_bf16 v[24:27], v[20:23], v[116:119], v[24:27]
    v_mfma_f32_16x16x32_bf16 v[28:31], v[20:23], v[120:123], v[28:31]
    v_mfma_f32_16x16x32_bf16 v[32:35], v[20:23], v[124:127], v[32:35]
    v_mfma_f32_16x16x32_bf16 v[36:39], v[20:23], v[128:131], v[36:39]
    v_mfma_f32_16x16x32_bf16 v[40:43], v[20:23], v[132:135], v[40:43]
    v_perm_b32 v20, v57, v57, v12
    v_perm_b32 v21, v57, v57, v13
    v_perm_b32 v22, v57, v57, v14
    v_perm_b32 v23, v57, v57, v15
    v_mfma_f32_16x16x32_bf16 v[24:27], v[16:19], v[136:139], v[24:27]
    v_mfma_f32_16x16x32_bf16 v[28:31], v[16:19], v[140:143], v[28:31]
    v_mfma_f32_16x16x32_bf16 v[32:35], v[16:19], v[144:147], v[32:35]
    v_mfma_f32_16x16x32_bf16 v[36:39], v[16:19], v[148:151], v[36:39]
    v_mfma_f32_16x16x32_bf16 v[40:43], v[16:19], v[152:155], v[40:43]
    v_perm_b32 v16, v58, v58, v8
    v_perm_b32 v17, v58, v58, v9
    v_perm_b32 v18, v58, v58, v10
    v_perm_b32 v19, v58, v58, v11
    v_mfma_f32_16x16x32_bf16 v[24:27], v[20:23], v[156:159], v[24:27]
    v_mfma_f32_16x16x32_bf16 v[28:31], v[20:23], v[160:163], v[28:31]
    v_mfma_f32_16x16x32_bf16 v[32:35], v[20:23], v[164:167], v[32:35]
    v_mfma_f32_16x16x32_bf16 v[36:39], v[20:23], v[168:171], v[36:39]
    v_mfma_f32_16x16x32_bf16 v[40:43], v[20:23], v[172:175], v[40:43]
    v_perm_b32 v20, v58, v58, v12
    v_perm_b32 v21, v58, v58, v13
    v_perm_b32 v22, v58, v58, v14
    v_perm_b32 v23, v58, v58, v15
    v_mfma_f32_16x16x32_bf16 v[24:27], v[16:19], v[176:179], v[24:27]
    v_mfma_f32_16x16x32_bf16 v[28:31], v[16:19], v[180:183], v[28:31]
    v_mfma_f32_16x16x32_bf16 v[32:35], v[16:19], v[184:187], v[32:35]
    v_mfma_f32_16x16x32_bf16 v[36:39], v[16:19], v[188:191], v[36:39]
    v_mfma_f32_16x16x32_bf16 v[40:43], v[16:19], v[192:195], v[40:43]
    v_perm_b32 v16, v59, v59, v8
    v_perm_b32 v17, v59, v59, v9
    v_perm_b32 v18, v59, v59, v10
    v_perm_b32 v19, v59, v59, v11
    v_mfma_f32_16x16x32_bf16 v[24:27], v[20:23], v[196:199], v[24:27]
    v_mfma_f32_16x16x32_bf16 v[28:31], v[20:23], v[200:203], v[28:31]
    v_mfma_f32_16x16x32_bf16 v[32:35], v[20:23], v[204:207], v[32:35]
    v_mfma_f32_16x16x32_bf16 v[36:39], v[20:23], v[208:211], v[36:39]
    v_mfma_f32_16x16x32_bf16 v[40:43], v[20:23], v[212:215], v[40:43]
    v_perm_b32 v20, v59, v59, v12
    v_perm_b32 v21, v59, v59, v13
    v_perm_b32 v22, v59, v59, v14
    v_perm_b32 v23, v59, v59, v15
    v_mfma_f32_16x16x32_bf16 v[24:27], v[16:19], v[216:219], v[24:27]
    v_mfma_f32_16x16x32_bf16 v[28:31], v[16:19], v[220:223], v[28:31]
    v_mfma_f32_16x16x32_bf16 v[32:35], v[16:19], v[224:227], v[32:35]
    v_mfma_f32_16x16x32_bf16 v[36:39], v[16:19], v[228:231], v[36:39]
    v_mfma_f32_16x16x32_bf16 v[40:43], v[16:19], v[232:235], v[40:43]
    s_nop 1
    v_mfma_f32_16x16x32_bf16 v[24:27], v[20:23], v[236:239], v[24:27]
    v_mfma_f32_16x16x32_bf16 v[28:31], v[20:23], v[240:243], v[28:31]
    v_mfma_f32_16x16x32_bf16 v[32:35], v[20:23], v[244:247], v[32:35]
    v_mfma_f32_16x16x32_bf16 v[36:39], v[20:23], v[248:251], v[36:39]
    v_mfma_f32_16x16x32_bf16 v[40:43], v[20:23], v[252:255], v[40:43]
    v_lshlrev_b32 v6, 5, v2
    v_lshl_add_u32 v6, v3, 4, v6
    s_mul_i32 s43, s42, 2560
    v_add_u32 v6, s43, v6
    s_nop 3
    s_mov_b32 exec_hi, 0
    ds_write_b128 v6, v[24:27] offset:11520
    ds_write_b128 v6, v[28:31] offset:12032
    ds_write_b128 v6, v[32:35] offset:12544
    ds_write_b128 v6, v[36:39] offset:13056
    ds_write_b128 v6, v[40:43] offset:13568
    s_mov_b32 exec_hi, -1
    s_mul_i32 s6, s4, 2560
    s_add_u32 s6, s6, 0x100000
    s_add_u32 s8, s40, s6
    s_addc_u32 s9, s41, 0
    s_mov_b32 s10, 2560
    s_mov_b32 s11, 0x20000
    s_waitcnt lgkmcnt(0)
L_b3:
    s_barrier
    s_mul_i32 s43, s42, 640
    v_lshlrev_b32 v4, 2, v0
    v_add_u32 v4, s43, v4
    ds_read_b32 v72, v4 offset:11520
    ds_read_b32 v73, v4 offset:14080
    ds_read_b32 v74, v4 offset:16640
    ds_read_b32 v75, v4 offset:19200
    ds_read_b32 v76, v4 offset:11776
    ds_read_b32 v77, v4 offset:14336
    ds_read_b32 v78, v4 offset:16896
    ds_read_b32 v79, v4 offset:19456
    ds_read_b32 v80, v4 offset:12032
    ds_read_b32 v81, v4 offset:14592
    ds_read_b32 v82, v4 offset:17152
    ds_read_b32 v83, v4 offset:19712
    s_waitcnt lgkmcnt(8)
    v_add_f32 v72, v72, v73
    v_add_f32 v74, v74, v75
    v_add_f32 v72, v72, v74
    buffer_atomic_add_f32 v72, v4, s[8:11], 0 offen offset:0
    s_waitcnt lgkmcnt(4)
    v_add_f32 v76, v76, v77
    v_add_f32 v78, v78, v79
    v_add_f32 v76, v76, v78
    buffer_atomic_add_f32 v76, v4, s[8:11], 0 offen offset:256
    s_waitcnt lgkmcnt(0)
    v_add_f32 v80, v80, v81
    v_add_f32 v82, v82, v83
    v_add_f32 v80, v80, v82
    s_mov_b32 exec_hi, 0
    buffer_atomic_add_f32 v80, v4, s[8:11], 0 offen offset:512
    s_mov_b32 exec_hi, -1
    v_lshlrev_b32 v96, 16, v44
    v_and_b32 v97, 0xffff0000, v44
    v_lshlrev_b32 v84, 16, v92
    v_and_b32 v85, 0xffff0000, v92
    v_add_f32 v96, v96, v84
    v_add_f32 v97, v97, v85
    v_lshlrev_b32 v98, 16, v45
    v_and_b32 v99, 0xffff0000, v45
    v_lshlrev_b32 v84, 16, v93
    v_and_b32 v85, 0xffff0000, v93
    v_add_f32 v98, v98, v84
    v_add_f32 v99, v99, v85
    v_lshlrev_b32 v100, 16, v46
    v_and_b32 v101, 0xffff0000, v46
    v_lshlrev_b32 v84, 16, v94
    v_and_b32 v85, 0xffff0000, v94
    v_add_f32 v100, v100, v84
    v_add_f32 v101, v101, v85
    v_lshlrev_b32 v102, 16, v47
    v_and_b32 v103, 0xffff0000, v47
    v_lshlrev_b32 v84, 16, v95
    v_and_b32 v85, 0xffff0000, v95
    v_add_f32 v102, v102, v84
    v_add_f32 v103, v103, v85
    v_lshlrev_b32 v104, 16, v60
    v_and_b32 v105, 0xffff0000, v60
    v_lshlrev_b32 v84, 16, v88
    v_and_b32 v85, 0xffff0000, v88
    v_add_f32 v104, v104, v84
    v_add_f32 v105, v105, v85
    v_lshlrev_b32 v106, 16, v61
    v_and_b32 v107, 0xffff0000, v61
    v_lshlrev_b32 v84, 16, v89
    v_and_b32 v85, 0xffff0000, v89
    v_add_f32 v106, v106, v84
    v_add_f32 v107, v107, v85
    v_lshlrev_b32 v4, 4, v0
    v_lshlrev_b32 v7, 3, v0
    s_mul_i32 s6, s4, 1280
    s_add_u32 s12, s36, s6
    s_addc_u32 s13, s37, 0
    s_mov_b32 s14, 1280
    s_mov_b32 s15, 0x20000
    s_waitcnt vmcnt(0)
    s_barrier
    s_cmp_lg_u32 s42, 0
    s_cbranch_scc1 L_aux_done
    s_mov_b64 exec, 1
    global_atomic_add v5, v90, v91, s[38:39] offset:8 sc0
    s_waitcnt vmcnt(0)
    v_readfirstlane_b32 s43, v5
    s_mov_b64 exec, -1
    s_cmp_lg_u32 s43, 31
    s_cbranch_scc1 L_aux_done
    buffer_load_dwordx4 v[72:75], v4, s[8:11], 0 offen offset:0 sc1
    buffer_load_dwordx4 v[76:79], v4, s[8:11], 0 offen offset:1024 sc1
    buffer_load_dwordx4 v[80:83], v4, s[8:11], 0 offen offset:2048 sc1
    s_waitcnt vmcnt(2)
    v_add_f32 v72, v72, v96
    v_add_f32 v73, v73, v97
    v_add_f32 v74, v74, v98
    v_add_f32 v75, v75, v99
    v_cvt_pk_bf16_f32 v72, v72, v73
    v_cvt_pk_bf16_f32 v73, v74, v75
    s_waitcnt vmcnt(1)
    v_add_f32 v76, v76, v100
    v_add_f32 v77, v77, v101
    v_add_f32 v78, v78, v102
    v_add_f32 v79, v79, v103
    v_cvt_pk_bf16_f32 v76, v76, v77
    v_cvt_pk_bf16_f32 v77, v78, v79
    s_waitcnt vmcnt(0)
    v_add_f32 v80, v80, v104
    v_add_f32 v81, v81, v105
    v_add_f32 v82, v82, v106
    v_add_f32 v83, v83, v107
    v_cvt_pk_bf16_f32 v80, v80, v81
    v_cvt_pk_bf16_f32 v81, v82, v83
    buffer_store_dwordx2 v[72:73], v7, s[12:15], 0 offen offset:0
    buffer_store_dwordx2 v[76:77], v7, s[12:15], 0 offen offset:512
    buffer_store_dwordx2 v[80:81], v7, s[12:15], 0 offen offset:1024
L_aux_done:
L_end:
    s_endpgm
.section .rodata,"a"
.p2align 6
.amdhsa_kernel parallel_sum__gqa_block_cached__mixer_channel_mlp__decode_kernel
  .amdhsa_next_free_vgpr 256
  .amdhsa_next_free_sgpr 102
  .amdhsa_accum_offset 256
  .amdhsa_group_segment_fixed_size 0
  .amdhsa_kernarg_size 104
  .amdhsa_user_sgpr_count 2
  .amdhsa_user_sgpr_kernarg_segment_ptr 1
  .amdhsa_system_sgpr_workgroup_id_x 1
  .amdhsa_float_denorm_mode_32 3
.end_amdhsa_kernel
```
